```python
import torch

def _softmax(x, axis=-1):
    return torch.softmax(x, dim=axis)
def _gelu(x):
    return torch.nn.functional.gelu(x, approximate="tanh")
def _silu(x):
    return torch.nn.functional.silu(x)
def _sigmoid(x):
    return torch.sigmoid(x)
def _layernorm(x, axis=-1, eps=1e-5):
    m = x.mean(dim=axis, keepdim=True)
    v = x.var(dim=axis, keepdim=True, unbiased=False)
    return (x - m) / torch.sqrt(v + eps)
def _scatter_add(tgt, idx, src, axis=0):
    return tgt.clone().index_add_(axis, idx, src)
def _segment_sum(src, seg, n):
    out = torch.zeros((n,) + src.shape[1:], dtype=src.dtype)
    return out.index_add_(0, seg, src)
def _pad(x, pw):
    flat = tuple(v for pair in reversed(pw) for v in pair)
    return torch.nn.functional.pad(x, flat)

kernel_name = 'interleave_layers__mha_block__dense_activation_relu__prompt'

def setup_inputs():

    _w = (lambda a: (lambda t: t.to(torch.bfloat16) if t.is_floating_point() else t)(torch.as_tensor(a)))
    def _A_setup():
        B, S, D, H = 1, 2048, 512, 32
        return {
            "x": _w((lambda *s: torch.randn(*s, dtype=torch.bfloat16) * 0.05)(B, S, D)),
            "wqkv": _w((lambda *s: torch.randn(*s, dtype=torch.bfloat16) * 0.05)(D, 3 * D)),
            "wo": _w((lambda *s: torch.randn(*s, dtype=torch.bfloat16) * 0.05)(D, D)),
        }
    _A_in = _A_setup()

    def _B_setup():
        B, S, D, Dff = 1, 2048, 512, 1792
        return {
            "x": _w((lambda *s: torch.randn(*s, dtype=torch.bfloat16) * 0.05)(B, S, D)),
            "w1": _w((lambda *s: torch.randn(*s, dtype=torch.bfloat16) * 0.05)(D, Dff)),
            "w2": _w((lambda *s: torch.randn(*s, dtype=torch.bfloat16) * 0.05)(Dff, D)),
        }
    _B_in = _B_setup()

    return {
        "A_x": _A_in["x"],
        "A_wqkv": _A_in["wqkv"],
        "A_wo": _A_in["wo"],
        "B_x": _B_in["x"],
        "B_w1": _B_in["w1"],
        "B_w2": _B_in["w2"],
    }

def reference(A_x, A_wqkv, A_wo, B_x, B_w1, B_w2):
    def _A_ref(x, wqkv, wo):
        B, S, D = x.shape
        H = 32
        Dh = D // H
        qkv = (lambda x, *d: x.permute(*d))((x @ wqkv).reshape(B, S, 3, H, Dh), 2, 0, 3, 1, 4)
        q, k, v = qkv[0], qkv[1], qkv[2]
        scores = torch.einsum("bhqd,bhkd->bhqk", q, k) * (Dh ** -0.5)
        p = _softmax(scores, axis=-1)
        o = torch.einsum("bhqk,bhkd->bhqd", p, v)
        return (lambda x, *d: x.permute(*d))(o, 0, 2, 1, 3).reshape(B, S, D) @ wo

    def _B_ref(x, w1, w2):
        h = torch.einsum("bsd,df->bsf", x, w1)
        zero = torch.zeros_like(h)
        h = torch.maximum(h, zero)
        return torch.einsum("bsf,fd->bsd", h, w2)

    x = A_x
    x = x + _A_ref(_layernorm(x, axis=-1), A_wqkv, A_wo)
    x = x + _B_ref(_layernorm(x, axis=-1), B_w1, B_w2)
    x = x + _A_ref(_layernorm(x, axis=-1), A_wqkv, A_wo)
    x = x + _B_ref(_layernorm(x, axis=-1), B_w1, B_w2)
    return x
```

```asm
; @launch grid=(256,1,1) block=(512,1,1) lds=163840
.amdgcn_target "amdgcn-amd-amdhsa--gfx950"
.text

.globl interleave_layers__mha_block__dense_activation_relu__prompt_kernel
.p2align 8
.type interleave_layers__mha_block__dense_activation_relu__prompt_kernel,@function
interleave_layers__mha_block__dense_activation_relu__prompt_kernel:
    s_cmp_ge_u32 s2, 256
    s_cbranch_scc1 L_end
    s_load_dwordx2 s[48:49], s[0:1], 0
    s_load_dwordx2 s[52:53], s[0:1], 8
    s_load_dwordx2 s[4:5], s[0:1], 64
    s_load_dwordx2 s[16:17], s[0:1], 56
    s_load_dwordx2 s[28:29], s[0:1], 16
    s_load_dwordx2 s[30:31], s[0:1], 32
    s_load_dwordx2 s[32:33], s[0:1], 40
    v_and_b32 v1, 63, v0
    v_lshrrev_b32 v2, 6, v0
    s_nop 0
    v_readfirstlane_b32 s8, v2
    v_lshlrev_b32 v2, 4, v1
    s_mov_b32 s10, 0
    s_mov_b32 s3, 0
    s_mov_b32 s9, 0
    s_mov_b32 s11, 0
    s_mov_b32 s12, 0
    s_mov_b32 s36, 0
    s_waitcnt lgkmcnt(0)
    s_and_b32 s5, s5, 0xffff
    s_mov_b32 s6, 58720256
    s_mov_b32 s7, 0x00020000
    s_cmp_lg_u32 s8, 7
    s_cbranch_scc1 L_w_1
    s_and_b32 s17, s17, 0xffff
    s_mov_b32 s18, 256
    s_mov_b32 s19, 0x00020000
    s_getreg_b32 s20, hwreg(HW_REG_XCC_ID, 0, 4)
    s_and_b32 s21, s20, 7
    s_lshl_b32 s21, s21, 4
    s_add_u32 s21, s21, 16
    v_mov_b32 v60, 1
    v_mov_b32 v6, s21
    s_mov_b64 exec, 1
    buffer_atomic_add v60, v6, s[16:19], 0 offen sc0 sc1
    s_cmp_lg_u32 s2, 0
    s_cbranch_scc1 L_nonce_2
    s_memrealtime s[22:23]
    s_waitcnt lgkmcnt(0)
    s_lshl_b32 s22, s22, 8
    s_or_b32 s22, s22, 0x80000000
    v_mov_b32 v4, s22
    v_mov_b32 v5, 0
    v_mov_b32 v6, 0
    buffer_atomic_cmpswap v[4:5], v6, s[16:19], 0 offen sc1
L_nonce_2:
    s_mov_b64 exec, -1
    s_lshl_b32 s37, s20, 8
L_w_1:
    s_and_b32 s20, s2, 7
    s_lshr_b32 s21, s2, 3
    s_lshl_b32 s36, s20, 5
    s_add_u32 s36, s36, s21
    s_and_b32 s13, s21, 1
    s_lshl_b32 s20, s20, 1
    s_add_u32 s13, s13, s20
    s_lshr_b32 s14, s21, 1
    s_and_b32 s49, s49, 0xffff
    s_mov_b32 s50, 2097152
    s_mov_b32 s51, 0x00020000
    s_and_b32 s53, s53, 0xffff
    s_mov_b32 s54, 1572864
    s_mov_b32 s55, 0x00020000
    s_and_b32 s20, s2, 7
    s_lshr_b32 s21, s2, 3
    v_lshlrev_b32 v8, 7, v1
    s_cmp_lg_u32 s8, 0
    s_cbranch_scc1 L_wu_3
    s_lshl_b32 s22, s20, 18
    s_lshl_b32 s23, s21, 13
    s_add_u32 s22, s22, s23
    buffer_load_dword v15, v8, s[48:51], s22 offen
    s_branch L_wu_4
L_wu_3:
    s_cmp_eq_u32 s8, 7
    s_cbranch_scc1 L_wu_4
    s_mul_i32 s22, s21, 6
    s_add_u32 s22, s22, s8
    s_sub_u32 s22, s22, 1
    s_lshl_b32 s22, s22, 13
    buffer_load_dword v15, v8, s[52:55], s22 offen
L_wu_4:
    s_lshl_b32 s20, s13, 17
    s_lshl_b32 s21, s8, 14
    s_add_u32 s20, s20, s21
    s_add_u32 s21, s21, 32768
    v_xor_b32 v8, 0, v1
    v_lshlrev_b32 v8, 4, v8
    s_add_u32 m0, s21, 0
    s_add_u32 s23, s20, 0
    buffer_load_dwordx4 v8, s[48:51], s23 offen lds
    v_xor_b32 v8, 1, v1
    v_lshlrev_b32 v8, 4, v8
    s_add_u32 m0, s21, 1024
    s_add_u32 s23, s20, 1024
    buffer_load_dwordx4 v8, s[48:51], s23 offen lds
    v_xor_b32 v8, 2, v1
    v_lshlrev_b32 v8, 4, v8
    s_add_u32 m0, s21, 2048
    s_add_u32 s23, s20, 2048
    buffer_load_dwordx4 v8, s[48:51], s23 offen lds
    v_xor_b32 v8, 3, v1
    v_lshlrev_b32 v8, 4, v8
    s_add_u32 m0, s21, 3072
    s_add_u32 s23, s20, 3072
    buffer_load_dwordx4 v8, s[48:51], s23 offen lds
    v_xor_b32 v8, 4, v1
    v_lshlrev_b32 v8, 4, v8
    s_add_u32 m0, s21, 4096
    s_add_u32 s23, s20, 4096
    buffer_load_dwordx4 v8, s[48:51], s23 offen lds
    v_xor_b32 v8, 5, v1
    v_lshlrev_b32 v8, 4, v8
    s_add_u32 m0, s21, 5120
    s_add_u32 s23, s20, 5120
    buffer_load_dwordx4 v8, s[48:51], s23 offen lds
    v_xor_b32 v8, 6, v1
    v_lshlrev_b32 v8, 4, v8
    s_add_u32 m0, s21, 6144
    s_add_u32 s23, s20, 6144
    buffer_load_dwordx4 v8, s[48:51], s23 offen lds
    v_xor_b32 v8, 7, v1
    v_lshlrev_b32 v8, 4, v8
    s_add_u32 m0, s21, 7168
    s_add_u32 s23, s20, 7168
    buffer_load_dwordx4 v8, s[48:51], s23 offen lds
    v_xor_b32 v8, 8, v1
    v_lshlrev_b32 v8, 4, v8
    s_add_u32 m0, s21, 8192
    s_add_u32 s23, s20, 8192
    buffer_load_dwordx4 v8, s[48:51], s23 offen lds
    v_xor_b32 v8, 9, v1
    v_lshlrev_b32 v8, 4, v8
    s_add_u32 m0, s21, 9216
    s_add_u32 s23, s20, 9216
    buffer_load_dwordx4 v8, s[48:51], s23 offen lds
    v_xor_b32 v8, 10, v1
    v_lshlrev_b32 v8, 4, v8
    s_add_u32 m0, s21, 10240
    s_add_u32 s23, s20, 10240
    buffer_load_dwordx4 v8, s[48:51], s23 offen lds
    v_xor_b32 v8, 11, v1
    v_lshlrev_b32 v8, 4, v8
    s_add_u32 m0, s21, 11264
    s_add_u32 s23, s20, 11264
    buffer_load_dwordx4 v8, s[48:51], s23 offen lds
    v_xor_b32 v8, 12, v1
    v_lshlrev_b32 v8, 4, v8
    s_add_u32 m0, s21, 12288
    s_add_u32 s23, s20, 12288
    buffer_load_dwordx4 v8, s[48:51], s23 offen lds
    v_xor_b32 v8, 13, v1
    v_lshlrev_b32 v8, 4, v8
    s_add_u32 m0, s21, 13312
    s_add_u32 s23, s20, 13312
    buffer_load_dwordx4 v8, s[48:51], s23 offen lds
    v_xor_b32 v8, 14, v1
    v_lshlrev_b32 v8, 4, v8
    s_add_u32 m0, s21, 14336
    s_add_u32 s23, s20, 14336
    buffer_load_dwordx4 v8, s[48:51], s23 offen lds
    v_xor_b32 v8, 15, v1
    v_lshlrev_b32 v8, 4, v8
    s_add_u32 m0, s21, 15360
    s_add_u32 s23, s20, 15360
    buffer_load_dwordx4 v8, s[48:51], s23 offen lds
    v_add_u32 v4, 0, v1
    v_mul_u32_u24 v9, 171, v4
    v_lshrrev_b32 v9, 11, v9
    v_mul_u32_u24 v10, 12, v9
    v_sub_u32 v10, v4, v10
    v_mul_u32_u24 v9, 3072, v9
    v_lshl_add_u32 v4, v10, 4, v9
    v_add_u32 v5, 64, v1
    v_mul_u32_u24 v9, 171, v5
    v_lshrrev_b32 v9, 11, v9
    v_mul_u32_u24 v10, 12, v9
    v_sub_u32 v10, v5, v10
    v_mul_u32_u24 v9, 3072, v9
    v_lshl_add_u32 v5, v10, 4, v9
    v_add_u32 v6, 128, v1
    v_mul_u32_u24 v9, 171, v6
    v_lshrrev_b32 v9, 11, v9
    v_mul_u32_u24 v10, 12, v9
    v_sub_u32 v10, v6, v10
    v_mul_u32_u24 v9, 3072, v9
    v_lshl_add_u32 v6, v10, 4, v9
    s_mul_i32 s38, s14, 192
    s_mov_b32 s20, s8
    s_mul_i32 s21, s20, 3072
    s_mul_i32 s22, s20, 49152
    s_add_u32 s22, s22, s38
    s_add_u32 m0, s21, 0
    s_nop 0
    buffer_load_dwordx4 v4, s[52:55], s22 offen lds
    s_add_u32 m0, s21, 1024
    s_nop 0
    buffer_load_dwordx4 v5, s[52:55], s22 offen lds
    s_add_u32 m0, s21, 2048
    s_nop 0
    buffer_load_dwordx4 v6, s[52:55], s22 offen lds
    s_cmp_ge_u32 s8, 2
    s_cbranch_scc1 L_w89_5
    s_add_u32 s20, s8, 8
    s_mul_i32 s21, s20, 3072
    s_mul_i32 s22, s20, 49152
    s_add_u32 s22, s22, s38
    s_add_u32 m0, s21, 0
    s_nop 0
    buffer_load_dwordx4 v4, s[52:55], s22 offen lds
    s_add_u32 m0, s21, 1024
    s_nop 0
    buffer_load_dwordx4 v5, s[52:55], s22 offen lds
    s_add_u32 m0, s21, 2048
    s_nop 0
    buffer_load_dwordx4 v6, s[52:55], s22 offen lds
L_w89_5:
    s_cmp_lg_u32 s8, 7
    s_cbranch_scc1 L_w_6
    s_load_dwordx2 s[16:17], s[0:1], 56
    s_waitcnt lgkmcnt(0)
    s_and_b32 s17, s17, 0xffff
    s_mov_b32 s18, 256
    s_mov_b32 s19, 0x00020000
    v_mov_b32 v9, 0
    s_mov_b32 s22, 0
    s_mov_b64 exec, 1
L_np_7:
    buffer_load_dword v8, v9, s[16:19], 0 offen sc1
    s_waitcnt vmcnt(0)
    v_readfirstlane_b32 s21, v8
    s_nop 3
    s_cmp_lg_u32 s21, 0
    s_cbranch_scc1 L_npd_8
    s_add_u32 s22, s22, 1
    s_cmp_lt_u32 s22, 262144
    s_cbranch_scc1 L_np_7
L_npd_8:
    s_mov_b32 s9, s21
    v_or_b32 v60, s37, v60
    s_nop 0
    v_readfirstlane_b32 s39, v60
    v_mov_b32 v8, s21
    v_mov_b32 v9, v60
    v_mov_b32 v10, 0
    s_lshl_b32 s20, s2, 7
    s_add_u32 s20, s20, 51380224
    buffer_store_dwordx2 v[8:9], v10, s[4:7], s20 offen sc1
    s_mov_b64 exec, -1
L_w_6:
    s_waitcnt vmcnt(0)
    s_barrier
    v_and_b32 v8, 31, v1
    s_and_b32 s20, s8, 3
    s_lshl_b32 s20, s20, 5
    v_add_u32 v8, s20, v8
    v_lshlrev_b32 v8, 10, v8
    v_add_u32 v8, 32768, v8
    v_and_b32 v9, 15, v1
    v_lshrrev_b32 v10, 5, v1
    v_add_u32 v11, 0, v10
    v_xor_b32 v11, v11, v9
    v_lshl_add_u32 v228, v11, 4, v8
    v_add_u32 v11, 2, v10
    v_xor_b32 v11, v11, v9
    v_lshl_add_u32 v229, v11, 4, v8
    v_add_u32 v11, 4, v10
    v_xor_b32 v11, v11, v9
    v_lshl_add_u32 v230, v11, 4, v8
    v_add_u32 v11, 6, v10
    v_xor_b32 v11, v11, v9
    v_lshl_add_u32 v231, v11, 4, v8
    v_add_u32 v11, 8, v10
    v_xor_b32 v11, v11, v9
    v_lshl_add_u32 v232, v11, 4, v8
    v_add_u32 v11, 10, v10
    v_xor_b32 v11, v11, v9
    v_lshl_add_u32 v233, v11, 4, v8
    v_add_u32 v11, 12, v10
    v_xor_b32 v11, v11, v9
    v_lshl_add_u32 v234, v11, 4, v8
    v_add_u32 v11, 14, v10
    v_xor_b32 v11, v11, v9
    v_lshl_add_u32 v235, v11, 4, v8
    s_cmp_ge_u32 s8, 4
    s_cbranch_scc1 L_xr2_11
    ds_read_b128 v[16:19], v228 offset:0
    ds_read_b128 v[20:23], v229 offset:0
    ds_read_b128 v[24:27], v230 offset:0
    ds_read_b128 v[28:31], v231 offset:0
    ds_read_b128 v[32:35], v232 offset:0
    ds_read_b128 v[36:39], v233 offset:0
    ds_read_b128 v[40:43], v234 offset:0
    ds_read_b128 v[44:47], v235 offset:0
    s_waitcnt lgkmcnt(4)
    ds_read_b128 v[48:51], v228 offset:256
    ds_read_b128 v[52:55], v229 offset:256
    ds_read_b128 v[56:59], v230 offset:256
    ds_read_b128 v[60:63], v231 offset:256
    ds_read_b128 v[64:67], v232 offset:256
    ds_read_b128 v[68:71], v233 offset:256
    ds_read_b128 v[72:75], v234 offset:256
    ds_read_b128 v[76:79], v235 offset:256
    s_waitcnt lgkmcnt(4)
L_xr2_11:
    ds_read_b128 v[80:83], v228 offset:512
    ds_read_b128 v[84:87], v229 offset:512
    ds_read_b128 v[88:91], v230 offset:512
    ds_read_b128 v[92:95], v231 offset:512
    ds_read_b128 v[96:99], v232 offset:512
    ds_read_b128 v[100:103], v233 offset:512
    ds_read_b128 v[104:107], v234 offset:512
    ds_read_b128 v[108:111], v235 offset:512
    s_waitcnt lgkmcnt(4)
    ds_read_b128 v[112:115], v228 offset:768
    ds_read_b128 v[116:119], v229 offset:768
    ds_read_b128 v[120:123], v230 offset:768
    ds_read_b128 v[124:127], v231 offset:768
    ds_read_b128 v[128:131], v232 offset:768
    ds_read_b128 v[132:135], v233 offset:768
    ds_read_b128 v[136:139], v234 offset:768
    ds_read_b128 v[140:143], v235 offset:768
    s_waitcnt lgkmcnt(0)
    s_barrier
    s_add_u32 s20, s8, 10
    s_mul_i32 s21, s20, 3072
    s_mul_i32 s22, s20, 49152
    s_add_u32 s22, s22, s38
    s_add_u32 m0, s21, 2048
    s_nop 0
    buffer_load_dwordx4 v4, s[52:55], s22 offen lds
    s_add_u32 m0, s21, 3072
    s_nop 0
    buffer_load_dwordx4 v5, s[52:55], s22 offen lds
    s_add_u32 m0, s21, 4096
    s_nop 0
    buffer_load_dwordx4 v6, s[52:55], s22 offen lds
    s_add_u32 s20, s8, 18
    s_mul_i32 s21, s20, 3072
    s_mul_i32 s22, s20, 49152
    s_add_u32 s22, s22, s38
    s_add_u32 m0, s21, 2048
    s_nop 0
    buffer_load_dwordx4 v4, s[52:55], s22 offen lds
    s_add_u32 m0, s21, 3072
    s_nop 0
    buffer_load_dwordx4 v5, s[52:55], s22 offen lds
    s_add_u32 m0, s21, 4096
    s_nop 0
    buffer_load_dwordx4 v6, s[52:55], s22 offen lds
    s_cmp_ge_u32 s8, 6
    s_cbranch_scc1 L_w26_12
    s_add_u32 s20, s8, 26
    s_mul_i32 s21, s20, 3072
    s_mul_i32 s22, s20, 49152
    s_add_u32 s22, s22, s38
    s_add_u32 m0, s21, 2048
    s_nop 0
    buffer_load_dwordx4 v4, s[52:55], s22 offen lds
    s_add_u32 m0, s21, 3072
    s_nop 0
    buffer_load_dwordx4 v5, s[52:55], s22 offen lds
    s_add_u32 m0, s21, 4096
    s_nop 0
    buffer_load_dwordx4 v6, s[52:55], s22 offen lds
L_w26_12:
    v_mov_b32 v232, 0
    v_mov_b32 v233, 0
    v_mov_b32 v234, 0
    v_mov_b32 v235, 0
    v_mov_b32 v236, 0x3f803f80
    s_cmp_ge_u32 s8, 4
    s_cbranch_scc1 L_sth_13
    v_dot2_f32_bf16 v232, v16, v236, v232
    v_dot2_f32_bf16 v233, v16, v16, v233
    v_dot2_f32_bf16 v234, v17, v236, v234
    v_dot2_f32_bf16 v235, v17, v17, v235
    v_dot2_f32_bf16 v232, v18, v236, v232
    v_dot2_f32_bf16 v233, v18, v18, v233
    v_dot2_f32_bf16 v234, v19, v236, v234
    v_dot2_f32_bf16 v235, v19, v19, v235
    v_dot2_f32_bf16 v232, v20, v236, v232
    v_dot2_f32_bf16 v233, v20, v20, v233
    v_dot2_f32_bf16 v234, v21, v236, v234
    v_dot2_f32_bf16 v235, v21, v21, v235
    v_dot2_f32_bf16 v232, v22, v236, v232
    v_dot2_f32_bf16 v233, v22, v22, v233
    v_dot2_f32_bf16 v234, v23, v236, v234
    v_dot2_f32_bf16 v235, v23, v23, v235
    v_dot2_f32_bf16 v232, v24, v236, v232
    v_dot2_f32_bf16 v233, v24, v24, v233
    v_dot2_f32_bf16 v234, v25, v236, v234
    v_dot2_f32_bf16 v235, v25, v25, v235
    v_dot2_f32_bf16 v232, v26, v236, v232
    v_dot2_f32_bf16 v233, v26, v26, v233
    v_dot2_f32_bf16 v234, v27, v236, v234
    v_dot2_f32_bf16 v235, v27, v27, v235
    v_dot2_f32_bf16 v232, v28, v236, v232
    v_dot2_f32_bf16 v233, v28, v28, v233
    v_dot2_f32_bf16 v234, v29, v236, v234
    v_dot2_f32_bf16 v235, v29, v29, v235
    v_dot2_f32_bf16 v232, v30, v236, v232
    v_dot2_f32_bf16 v233, v30, v30, v233
    v_dot2_f32_bf16 v234, v31, v236, v234
    v_dot2_f32_bf16 v235, v31, v31, v235
    v_dot2_f32_bf16 v232, v32, v236, v232
    v_dot2_f32_bf16 v233, v32, v32, v233
    v_dot2_f32_bf16 v234, v33, v236, v234
    v_dot2_f32_bf16 v235, v33, v33, v235
    v_dot2_f32_bf16 v232, v34, v236, v232
    v_dot2_f32_bf16 v233, v34, v34, v233
    v_dot2_f32_bf16 v234, v35, v236, v234
    v_dot2_f32_bf16 v235, v35, v35, v235
    v_dot2_f32_bf16 v232, v36, v236, v232
    v_dot2_f32_bf16 v233, v36, v36, v233
    v_dot2_f32_bf16 v234, v37, v236, v234
    v_dot2_f32_bf16 v235, v37, v37, v235
    v_dot2_f32_bf16 v232, v38, v236, v232
    v_dot2_f32_bf16 v233, v38, v38, v233
    v_dot2_f32_bf16 v234, v39, v236, v234
    v_dot2_f32_bf16 v235, v39, v39, v235
    v_dot2_f32_bf16 v232, v40, v236, v232
    v_dot2_f32_bf16 v233, v40, v40, v233
    v_dot2_f32_bf16 v234, v41, v236, v234
    v_dot2_f32_bf16 v235, v41, v41, v235
    v_dot2_f32_bf16 v232, v42, v236, v232
    v_dot2_f32_bf16 v233, v42, v42, v233
    v_dot2_f32_bf16 v234, v43, v236, v234
    v_dot2_f32_bf16 v235, v43, v43, v235
    v_dot2_f32_bf16 v232, v44, v236, v232
    v_dot2_f32_bf16 v233, v44, v44, v233
    v_dot2_f32_bf16 v234, v45, v236, v234
    v_dot2_f32_bf16 v235, v45, v45, v235
    v_dot2_f32_bf16 v232, v46, v236, v232
    v_dot2_f32_bf16 v233, v46, v46, v233
    v_dot2_f32_bf16 v234, v47, v236, v234
    v_dot2_f32_bf16 v235, v47, v47, v235
    v_dot2_f32_bf16 v232, v48, v236, v232
    v_dot2_f32_bf16 v233, v48, v48, v233
    v_dot2_f32_bf16 v234, v49, v236, v234
    v_dot2_f32_bf16 v235, v49, v49, v235
    v_dot2_f32_bf16 v232, v50, v236, v232
    v_dot2_f32_bf16 v233, v50, v50, v233
    v_dot2_f32_bf16 v234, v51, v236, v234
    v_dot2_f32_bf16 v235, v51, v51, v235
    v_dot2_f32_bf16 v232, v52, v236, v232
    v_dot2_f32_bf16 v233, v52, v52, v233
    v_dot2_f32_bf16 v234, v53, v236, v234
    v_dot2_f32_bf16 v235, v53, v53, v235
    v_dot2_f32_bf16 v232, v54, v236, v232
    v_dot2_f32_bf16 v233, v54, v54, v233
    v_dot2_f32_bf16 v234, v55, v236, v234
    v_dot2_f32_bf16 v235, v55, v55, v235
    v_dot2_f32_bf16 v232, v56, v236, v232
    v_dot2_f32_bf16 v233, v56, v56, v233
    v_dot2_f32_bf16 v234, v57, v236, v234
    v_dot2_f32_bf16 v235, v57, v57, v235
    v_dot2_f32_bf16 v232, v58, v236, v232
    v_dot2_f32_bf16 v233, v58, v58, v233
    v_dot2_f32_bf16 v234, v59, v236, v234
    v_dot2_f32_bf16 v235, v59, v59, v235
    v_dot2_f32_bf16 v232, v60, v236, v232
    v_dot2_f32_bf16 v233, v60, v60, v233
    v_dot2_f32_bf16 v234, v61, v236, v234
    v_dot2_f32_bf16 v235, v61, v61, v235
    v_dot2_f32_bf16 v232, v62, v236, v232
    v_dot2_f32_bf16 v233, v62, v62, v233
    v_dot2_f32_bf16 v234, v63, v236, v234
    v_dot2_f32_bf16 v235, v63, v63, v235
    v_dot2_f32_bf16 v232, v64, v236, v232
    v_dot2_f32_bf16 v233, v64, v64, v233
    v_dot2_f32_bf16 v234, v65, v236, v234
    v_dot2_f32_bf16 v235, v65, v65, v235
    v_dot2_f32_bf16 v232, v66, v236, v232
    v_dot2_f32_bf16 v233, v66, v66, v233
    v_dot2_f32_bf16 v234, v67, v236, v234
    v_dot2_f32_bf16 v235, v67, v67, v235
    v_dot2_f32_bf16 v232, v68, v236, v232
    v_dot2_f32_bf16 v233, v68, v68, v233
    v_dot2_f32_bf16 v234, v69, v236, v234
    v_dot2_f32_bf16 v235, v69, v69, v235
    v_dot2_f32_bf16 v232, v70, v236, v232
    v_dot2_f32_bf16 v233, v70, v70, v233
    v_dot2_f32_bf16 v234, v71, v236, v234
    v_dot2_f32_bf16 v235, v71, v71, v235
    v_dot2_f32_bf16 v232, v72, v236, v232
    v_dot2_f32_bf16 v233, v72, v72, v233
    v_dot2_f32_bf16 v234, v73, v236, v234
    v_dot2_f32_bf16 v235, v73, v73, v235
    v_dot2_f32_bf16 v232, v74, v236, v232
    v_dot2_f32_bf16 v233, v74, v74, v233
    v_dot2_f32_bf16 v234, v75, v236, v234
    v_dot2_f32_bf16 v235, v75, v75, v235
    v_dot2_f32_bf16 v232, v76, v236, v232
    v_dot2_f32_bf16 v233, v76, v76, v233
    v_dot2_f32_bf16 v234, v77, v236, v234
    v_dot2_f32_bf16 v235, v77, v77, v235
    v_dot2_f32_bf16 v232, v78, v236, v232
    v_dot2_f32_bf16 v233, v78, v78, v233
    v_dot2_f32_bf16 v234, v79, v236, v234
    v_dot2_f32_bf16 v235, v79, v79, v235
    s_branch L_stj_14
L_sth_13:
    v_dot2_f32_bf16 v232, v80, v236, v232
    v_dot2_f32_bf16 v233, v80, v80, v233
    v_dot2_f32_bf16 v234, v81, v236, v234
    v_dot2_f32_bf16 v235, v81, v81, v235
    v_dot2_f32_bf16 v232, v82, v236, v232
    v_dot2_f32_bf16 v233, v82, v82, v233
    v_dot2_f32_bf16 v234, v83, v236, v234
    v_dot2_f32_bf16 v235, v83, v83, v235
    v_dot2_f32_bf16 v232, v84, v236, v232
    v_dot2_f32_bf16 v233, v84, v84, v233
    v_dot2_f32_bf16 v234, v85, v236, v234
    v_dot2_f32_bf16 v235, v85, v85, v235
    v_dot2_f32_bf16 v232, v86, v236, v232
    v_dot2_f32_bf16 v233, v86, v86, v233
    v_dot2_f32_bf16 v234, v87, v236, v234
    v_dot2_f32_bf16 v235, v87, v87, v235
    v_dot2_f32_bf16 v232, v88, v236, v232
    v_dot2_f32_bf16 v233, v88, v88, v233
    v_dot2_f32_bf16 v234, v89, v236, v234
    v_dot2_f32_bf16 v235, v89, v89, v235
    v_dot2_f32_bf16 v232, v90, v236, v232
    v_dot2_f32_bf16 v233, v90, v90, v233
    v_dot2_f32_bf16 v234, v91, v236, v234
    v_dot2_f32_bf16 v235, v91, v91, v235
    v_dot2_f32_bf16 v232, v92, v236, v232
    v_dot2_f32_bf16 v233, v92, v92, v233
    v_dot2_f32_bf16 v234, v93, v236, v234
    v_dot2_f32_bf16 v235, v93, v93, v235
    v_dot2_f32_bf16 v232, v94, v236, v232
    v_dot2_f32_bf16 v233, v94, v94, v233
    v_dot2_f32_bf16 v234, v95, v236, v234
    v_dot2_f32_bf16 v235, v95, v95, v235
    v_dot2_f32_bf16 v232, v96, v236, v232
    v_dot2_f32_bf16 v233, v96, v96, v233
    v_dot2_f32_bf16 v234, v97, v236, v234
    v_dot2_f32_bf16 v235, v97, v97, v235
    v_dot2_f32_bf16 v232, v98, v236, v232
    v_dot2_f32_bf16 v233, v98, v98, v233
    v_dot2_f32_bf16 v234, v99, v236, v234
    v_dot2_f32_bf16 v235, v99, v99, v235
    v_dot2_f32_bf16 v232, v100, v236, v232
    v_dot2_f32_bf16 v233, v100, v100, v233
    v_dot2_f32_bf16 v234, v101, v236, v234
    v_dot2_f32_bf16 v235, v101, v101, v235
    v_dot2_f32_bf16 v232, v102, v236, v232
    v_dot2_f32_bf16 v233, v102, v102, v233
    v_dot2_f32_bf16 v234, v103, v236, v234
    v_dot2_f32_bf16 v235, v103, v103, v235
    v_dot2_f32_bf16 v232, v104, v236, v232
    v_dot2_f32_bf16 v233, v104, v104, v233
    v_dot2_f32_bf16 v234, v105, v236, v234
    v_dot2_f32_bf16 v235, v105, v105, v235
    v_dot2_f32_bf16 v232, v106, v236, v232
    v_dot2_f32_bf16 v233, v106, v106, v233
    v_dot2_f32_bf16 v234, v107, v236, v234
    v_dot2_f32_bf16 v235, v107, v107, v235
    v_dot2_f32_bf16 v232, v108, v236, v232
    v_dot2_f32_bf16 v233, v108, v108, v233
    v_dot2_f32_bf16 v234, v109, v236, v234
    v_dot2_f32_bf16 v235, v109, v109, v235
    v_dot2_f32_bf16 v232, v110, v236, v232
    v_dot2_f32_bf16 v233, v110, v110, v233
    v_dot2_f32_bf16 v234, v111, v236, v234
    v_dot2_f32_bf16 v235, v111, v111, v235
    v_dot2_f32_bf16 v232, v112, v236, v232
    v_dot2_f32_bf16 v233, v112, v112, v233
    v_dot2_f32_bf16 v234, v113, v236, v234
    v_dot2_f32_bf16 v235, v113, v113, v235
    v_dot2_f32_bf16 v232, v114, v236, v232
    v_dot2_f32_bf16 v233, v114, v114, v233
    v_dot2_f32_bf16 v234, v115, v236, v234
    v_dot2_f32_bf16 v235, v115, v115, v235
    v_dot2_f32_bf16 v232, v116, v236, v232
    v_dot2_f32_bf16 v233, v116, v116, v233
    v_dot2_f32_bf16 v234, v117, v236, v234
    v_dot2_f32_bf16 v235, v117, v117, v235
    v_dot2_f32_bf16 v232, v118, v236, v232
    v_dot2_f32_bf16 v233, v118, v118, v233
    v_dot2_f32_bf16 v234, v119, v236, v234
    v_dot2_f32_bf16 v235, v119, v119, v235
    v_dot2_f32_bf16 v232, v120, v236, v232
    v_dot2_f32_bf16 v233, v120, v120, v233
    v_dot2_f32_bf16 v234, v121, v236, v234
    v_dot2_f32_bf16 v235, v121, v121, v235
    v_dot2_f32_bf16 v232, v122, v236, v232
    v_dot2_f32_bf16 v233, v122, v122, v233
    v_dot2_f32_bf16 v234, v123, v236, v234
    v_dot2_f32_bf16 v235, v123, v123, v235
    v_dot2_f32_bf16 v232, v124, v236, v232
    v_dot2_f32_bf16 v233, v124, v124, v233
    v_dot2_f32_bf16 v234, v125, v236, v234
    v_dot2_f32_bf16 v235, v125, v125, v235
    v_dot2_f32_bf16 v232, v126, v236, v232
    v_dot2_f32_bf16 v233, v126, v126, v233
    v_dot2_f32_bf16 v234, v127, v236, v234
    v_dot2_f32_bf16 v235, v127, v127, v235
    v_dot2_f32_bf16 v232, v128, v236, v232
    v_dot2_f32_bf16 v233, v128, v128, v233
    v_dot2_f32_bf16 v234, v129, v236, v234
    v_dot2_f32_bf16 v235, v129, v129, v235
    v_dot2_f32_bf16 v232, v130, v236, v232
    v_dot2_f32_bf16 v233, v130, v130, v233
    v_dot2_f32_bf16 v234, v131, v236, v234
    v_dot2_f32_bf16 v235, v131, v131, v235
    v_dot2_f32_bf16 v232, v132, v236, v232
    v_dot2_f32_bf16 v233, v132, v132, v233
    v_dot2_f32_bf16 v234, v133, v236, v234
    v_dot2_f32_bf16 v235, v133, v133, v235
    v_dot2_f32_bf16 v232, v134, v236, v232
    v_dot2_f32_bf16 v233, v134, v134, v233
    v_dot2_f32_bf16 v234, v135, v236, v234
    v_dot2_f32_bf16 v235, v135, v135, v235
    v_dot2_f32_bf16 v232, v136, v236, v232
    v_dot2_f32_bf16 v233, v136, v136, v233
    v_dot2_f32_bf16 v234, v137, v236, v234
    v_dot2_f32_bf16 v235, v137, v137, v235
    v_dot2_f32_bf16 v232, v138, v236, v232
    v_dot2_f32_bf16 v233, v138, v138, v233
    v_dot2_f32_bf16 v234, v139, v236, v234
    v_dot2_f32_bf16 v235, v139, v139, v235
    v_dot2_f32_bf16 v232, v140, v236, v232
    v_dot2_f32_bf16 v233, v140, v140, v233
    v_dot2_f32_bf16 v234, v141, v236, v234
    v_dot2_f32_bf16 v235, v141, v141, v235
    v_dot2_f32_bf16 v232, v142, v236, v232
    v_dot2_f32_bf16 v233, v142, v142, v233
    v_dot2_f32_bf16 v234, v143, v236, v234
    v_dot2_f32_bf16 v235, v143, v143, v235
L_stj_14:
    s_nop 2
    v_add_f32 v232, v232, v234
    v_add_f32 v233, v233, v235
    v_mov_b32 v234, v232
    v_mov_b32 v235, v233
    s_nop 1
    v_permlane32_swap_b32 v232, v234
    v_permlane32_swap_b32 v233, v235
    s_nop 1
    v_add_f32 v248, v232, v234
    v_add_f32 v249, v233, v235
    v_lshrrev_b32 v12, 5, v1
    v_lshlrev_b32 v12, 3, v12
    v_bfe_u32 v11, v1, 2, 2
    v_add_u32 v12, v12, v11
    v_mul_u32_u24 v12, 192, v12
    v_bfe_u32 v11, v1, 4, 1
    v_lshl_add_u32 v12, v11, 5, v12
    v_and_b32 v11, 3, v1
    v_lshl_add_u32 v12, v11, 3, v12
    v_add_u32 v13, 32768, v12
    v_add_u32 v14, 81920, v12
    s_cmp_ge_u32 s8, 4
    s_cbranch_scc1 L_q0_h_9
    v_mov_b32 v228, 0x3f803f80
    v_mov_b32 v229, 0x3f803f80
    v_mov_b32 v230, 0x3f803f80
    v_mov_b32 v231, 0x3f803f80
    ds_read_b64_tr_b16 v[192:193], v12 offset:0
    ds_read_b64_tr_b16 v[194:195], v12 offset:768
    ds_read_b64_tr_b16 v[196:197], v12 offset:64
    ds_read_b64_tr_b16 v[198:199], v12 offset:832
    ds_read_b64_tr_b16 v[200:201], v12 offset:128
    ds_read_b64_tr_b16 v[202:203], v12 offset:896
    ds_read_b64_tr_b16 v[204:205], v12 offset:3072
    ds_read_b64_tr_b16 v[206:207], v12 offset:3840
    ds_read_b64_tr_b16 v[208:209], v12 offset:3136
    ds_read_b64_tr_b16 v[210:211], v12 offset:3904
    ds_read_b64_tr_b16 v[212:213], v12 offset:3200
    ds_read_b64_tr_b16 v[214:215], v12 offset:3968
    s_waitcnt lgkmcnt(6)
    v_mfma_f32_32x32x16_bf16 v[144:159], v[192:195], v[16:19], 0
    s_cmp_lg_u32 s8, 0
    s_cbranch_scc1 L_c1_15
    v_mfma_f32_32x32x16_bf16 v[232:247], v[192:195], v[228:231], 0
L_c1_15:
    ds_read_b64_tr_b16 v[216:217], v12 offset:6144
    ds_read_b64_tr_b16 v[218:219], v12 offset:6912
    v_mfma_f32_32x32x16_bf16 v[160:175], v[196:199], v[16:19], 0
    s_cmp_lg_u32 s8, 1
    s_cbranch_scc1 L_c1_16
    v_mfma_f32_32x32x16_bf16 v[232:247], v[196:199], v[228:231], 0
L_c1_16:
    ds_read_b64_tr_b16 v[220:221], v12 offset:6208
    ds_read_b64_tr_b16 v[222:223], v12 offset:6976
    v_mfma_f32_32x32x16_bf16 v[176:191], v[200:203], v[16:19], 0
    s_cmp_lg_u32 s8, 2
    s_cbranch_scc1 L_c1_17
    v_mfma_f32_32x32x16_bf16 v[232:247], v[200:203], v[228:231], 0
L_c1_17:
    ds_read_b64_tr_b16 v[224:225], v12 offset:6272
    ds_read_b64_tr_b16 v[226:227], v12 offset:7040
    s_waitcnt lgkmcnt(6)
    v_mfma_f32_32x32x16_bf16 v[144:159], v[204:207], v[20:23], v[144:159]
    s_cmp_lg_u32 s8, 0
    s_cbranch_scc1 L_c1_18
    v_mfma_f32_32x32x16_bf16 v[232:247], v[204:207], v[228:231], v[232:247]
L_c1_18:
    ds_read_b64_tr_b16 v[192:193], v12 offset:9216
    ds_read_b64_tr_b16 v[194:195], v12 offset:9984
    v_mfma_f32_32x32x16_bf16 v[160:175], v[208:211], v[20:23], v[160:175]
    s_cmp_lg_u32 s8, 1
    s_cbranch_scc1 L_c1_19
    v_mfma_f32_32x32x16_bf16 v[232:247], v[208:211], v[228:231], v[232:247]
L_c1_19:
    ds_read_b64_tr_b16 v[196:197], v12 offset:9280
    ds_read_b64_tr_b16 v[198:199], v12 offset:10048
    v_mfma_f32_32x32x16_bf16 v[176:191], v[212:215], v[20:23], v[176:191]
    s_cmp_lg_u32 s8, 2
    s_cbranch_scc1 L_c1_20
    v_mfma_f32_32x32x16_bf16 v[232:247], v[212:215], v[228:231], v[232:247]
L_c1_20:
    ds_read_b64_tr_b16 v[200:201], v12 offset:9344
    ds_read_b64_tr_b16 v[202:203], v12 offset:10112
    s_waitcnt lgkmcnt(6)
    v_mfma_f32_32x32x16_bf16 v[144:159], v[216:219], v[24:27], v[144:159]
    s_cmp_lg_u32 s8, 0
    s_cbranch_scc1 L_c1_21
    v_mfma_f32_32x32x16_bf16 v[232:247], v[216:219], v[228:231], v[232:247]
L_c1_21:
    ds_read_b64_tr_b16 v[204:205], v12 offset:12288
    ds_read_b64_tr_b16 v[206:207], v12 offset:13056
    v_mfma_f32_32x32x16_bf16 v[160:175], v[220:223], v[24:27], v[160:175]
    s_cmp_lg_u32 s8, 1
    s_cbranch_scc1 L_c1_22
    v_mfma_f32_32x32x16_bf16 v[232:247], v[220:223], v[228:231], v[232:247]
L_c1_22:
    ds_read_b64_tr_b16 v[208:209], v12 offset:12352
    ds_read_b64_tr_b16 v[210:211], v12 offset:13120
    v_mfma_f32_32x32x16_bf16 v[176:191], v[224:227], v[24:27], v[176:191]
    s_cmp_lg_u32 s8, 2
    s_cbranch_scc1 L_c1_23
    v_mfma_f32_32x32x16_bf16 v[232:247], v[224:227], v[228:231], v[232:247]
L_c1_23:
    ds_read_b64_tr_b16 v[212:213], v12 offset:12416
    ds_read_b64_tr_b16 v[214:215], v12 offset:13184
    s_waitcnt lgkmcnt(6)
    v_mfma_f32_32x32x16_bf16 v[144:159], v[192:195], v[28:31], v[144:159]
    s_cmp_lg_u32 s8, 0
    s_cbranch_scc1 L_c1_24
    v_mfma_f32_32x32x16_bf16 v[232:247], v[192:195], v[228:231], v[232:247]
L_c1_24:
    ds_read_b64_tr_b16 v[216:217], v12 offset:15360
    ds_read_b64_tr_b16 v[218:219], v12 offset:16128
    v_mfma_f32_32x32x16_bf16 v[160:175], v[196:199], v[28:31], v[160:175]
    s_cmp_lg_u32 s8, 1
    s_cbranch_scc1 L_c1_25
    v_mfma_f32_32x32x16_bf16 v[232:247], v[196:199], v[228:231], v[232:247]
L_c1_25:
    ds_read_b64_tr_b16 v[220:221], v12 offset:15424
    ds_read_b64_tr_b16 v[222:223], v12 offset:16192
    v_mfma_f32_32x32x16_bf16 v[176:191], v[200:203], v[28:31], v[176:191]
    s_cmp_lg_u32 s8, 2
    s_cbranch_scc1 L_c1_26
    v_mfma_f32_32x32x16_bf16 v[232:247], v[200:203], v[228:231], v[232:247]
L_c1_26:
    ds_read_b64_tr_b16 v[224:225], v12 offset:15488
    ds_read_b64_tr_b16 v[226:227], v12 offset:16256
    s_waitcnt lgkmcnt(6)
    v_mfma_f32_32x32x16_bf16 v[144:159], v[204:207], v[32:35], v[144:159]
    s_cmp_lg_u32 s8, 0
    s_cbranch_scc1 L_c1_27
    v_mfma_f32_32x32x16_bf16 v[232:247], v[204:207], v[228:231], v[232:247]
L_c1_27:
    ds_read_b64_tr_b16 v[192:193], v12 offset:18432
    ds_read_b64_tr_b16 v[194:195], v12 offset:19200
    v_mfma_f32_32x32x16_bf16 v[160:175], v[208:211], v[32:35], v[160:175]
    s_cmp_lg_u32 s8, 1
    s_cbranch_scc1 L_c1_28
    v_mfma_f32_32x32x16_bf16 v[232:247], v[208:211], v[228:231], v[232:247]
L_c1_28:
    ds_read_b64_tr_b16 v[196:197], v12 offset:18496
    ds_read_b64_tr_b16 v[198:199], v12 offset:19264
    v_mfma_f32_32x32x16_bf16 v[176:191], v[212:215], v[32:35], v[176:191]
    s_cmp_lg_u32 s8, 2
    s_cbranch_scc1 L_c1_29
    v_mfma_f32_32x32x16_bf16 v[232:247], v[212:215], v[228:231], v[232:247]
L_c1_29:
    ds_read_b64_tr_b16 v[200:201], v12 offset:18560
    ds_read_b64_tr_b16 v[202:203], v12 offset:19328
    s_waitcnt lgkmcnt(6)
    v_mfma_f32_32x32x16_bf16 v[144:159], v[216:219], v[36:39], v[144:159]
    s_cmp_lg_u32 s8, 0
    s_cbranch_scc1 L_c1_30
    v_mfma_f32_32x32x16_bf16 v[232:247], v[216:219], v[228:231], v[232:247]
L_c1_30:
    ds_read_b64_tr_b16 v[204:205], v12 offset:21504
    ds_read_b64_tr_b16 v[206:207], v12 offset:22272
    v_mfma_f32_32x32x16_bf16 v[160:175], v[220:223], v[36:39], v[160:175]
    s_cmp_lg_u32 s8, 1
    s_cbranch_scc1 L_c1_31
    v_mfma_f32_32x32x16_bf16 v[232:247], v[220:223], v[228:231], v[232:247]
L_c1_31:
    ds_read_b64_tr_b16 v[208:209], v12 offset:21568
    ds_read_b64_tr_b16 v[210:211], v12 offset:22336
    v_mfma_f32_32x32x16_bf16 v[176:191], v[224:227], v[36:39], v[176:191]
    s_cmp_lg_u32 s8, 2
    s_cbranch_scc1 L_c1_32
    v_mfma_f32_32x32x16_bf16 v[232:247], v[224:227], v[228:231], v[232:247]
L_c1_32:
    ds_read_b64_tr_b16 v[212:213], v12 offset:21632
    ds_read_b64_tr_b16 v[214:215], v12 offset:22400
    s_waitcnt lgkmcnt(6)
    v_mfma_f32_32x32x16_bf16 v[144:159], v[192:195], v[40:43], v[144:159]
    s_cmp_lg_u32 s8, 0
    s_cbranch_scc1 L_c1_33
    v_mfma_f32_32x32x16_bf16 v[232:247], v[192:195], v[228:231], v[232:247]
L_c1_33:
    ds_read_b64_tr_b16 v[216:217], v12 offset:24576
    ds_read_b64_tr_b16 v[218:219], v12 offset:25344
    v_mfma_f32_32x32x16_bf16 v[160:175], v[196:199], v[40:43], v[160:175]
    s_cmp_lg_u32 s8, 1
    s_cbranch_scc1 L_c1_34
    v_mfma_f32_32x32x16_bf16 v[232:247], v[196:199], v[228:231], v[232:247]
L_c1_34:
    ds_read_b64_tr_b16 v[220:221], v12 offset:24640
    ds_read_b64_tr_b16 v[222:223], v12 offset:25408
    v_mfma_f32_32x32x16_bf16 v[176:191], v[200:203], v[40:43], v[176:191]
    s_cmp_lg_u32 s8, 2
    s_cbranch_scc1 L_c1_35
    v_mfma_f32_32x32x16_bf16 v[232:247], v[200:203], v[228:231], v[232:247]
L_c1_35:
    ds_read_b64_tr_b16 v[224:225], v12 offset:24704
    ds_read_b64_tr_b16 v[226:227], v12 offset:25472
    s_waitcnt lgkmcnt(6)
    v_mfma_f32_32x32x16_bf16 v[144:159], v[204:207], v[44:47], v[144:159]
    s_cmp_lg_u32 s8, 0
    s_cbranch_scc1 L_c1_36
    v_mfma_f32_32x32x16_bf16 v[232:247], v[204:207], v[228:231], v[232:247]
L_c1_36:
    ds_read_b64_tr_b16 v[192:193], v12 offset:27648
    ds_read_b64_tr_b16 v[194:195], v12 offset:28416
    v_mfma_f32_32x32x16_bf16 v[160:175], v[208:211], v[44:47], v[160:175]
    s_cmp_lg_u32 s8, 1
    s_cbranch_scc1 L_c1_37
    v_mfma_f32_32x32x16_bf16 v[232:247], v[208:211], v[228:231], v[232:247]
L_c1_37:
    ds_read_b64_tr_b16 v[196:197], v12 offset:27712
    ds_read_b64_tr_b16 v[198:199], v12 offset:28480
    v_mfma_f32_32x32x16_bf16 v[176:191], v[212:215], v[44:47], v[176:191]
    s_cmp_lg_u32 s8, 2
    s_cbranch_scc1 L_c1_38
    v_mfma_f32_32x32x16_bf16 v[232:247], v[212:215], v[228:231], v[232:247]
L_c1_38:
    ds_read_b64_tr_b16 v[200:201], v12 offset:27776
    ds_read_b64_tr_b16 v[202:203], v12 offset:28544
    s_waitcnt vmcnt(0)
    s_barrier
    s_waitcnt lgkmcnt(6)
    v_mfma_f32_32x32x16_bf16 v[144:159], v[216:219], v[48:51], v[144:159]
    s_cmp_lg_u32 s8, 0
    s_cbranch_scc1 L_c1_39
    v_mfma_f32_32x32x16_bf16 v[232:247], v[216:219], v[228:231], v[232:247]
L_c1_39:
    ds_read_b64_tr_b16 v[204:205], v13 offset:0
    ds_read_b64_tr_b16 v[206:207], v13 offset:768
    v_mfma_f32_32x32x16_bf16 v[160:175], v[220:223], v[48:51], v[160:175]
    s_cmp_lg_u32 s8, 1
    s_cbranch_scc1 L_c1_40
    v_mfma_f32_32x32x16_bf16 v[232:247], v[220:223], v[228:231], v[232:247]
L_c1_40:
    ds_read_b64_tr_b16 v[208:209], v13 offset:64
    ds_read_b64_tr_b16 v[210:211], v13 offset:832
    v_mfma_f32_32x32x16_bf16 v[176:191], v[224:227], v[48:51], v[176:191]
    s_cmp_lg_u32 s8, 2
    s_cbranch_scc1 L_c1_41
    v_mfma_f32_32x32x16_bf16 v[232:247], v[224:227], v[228:231], v[232:247]
L_c1_41:
    ds_read_b64_tr_b16 v[212:213], v13 offset:128
    ds_read_b64_tr_b16 v[214:215], v13 offset:896
    s_waitcnt lgkmcnt(6)
    v_mfma_f32_32x32x16_bf16 v[144:159], v[192:195], v[52:55], v[144:159]
    s_cmp_lg_u32 s8, 0
    s_cbranch_scc1 L_c1_42
    v_mfma_f32_32x32x16_bf16 v[232:247], v[192:195], v[228:231], v[232:247]
L_c1_42:
    ds_read_b64_tr_b16 v[216:217], v13 offset:3072
    ds_read_b64_tr_b16 v[218:219], v13 offset:3840
    v_mfma_f32_32x32x16_bf16 v[160:175], v[196:199], v[52:55], v[160:175]
    s_cmp_lg_u32 s8, 1
    s_cbranch_scc1 L_c1_43
    v_mfma_f32_32x32x16_bf16 v[232:247], v[196:199], v[228:231], v[232:247]
L_c1_43:
    ds_read_b64_tr_b16 v[220:221], v13 offset:3136
    ds_read_b64_tr_b16 v[222:223], v13 offset:3904
    v_mfma_f32_32x32x16_bf16 v[176:191], v[200:203], v[52:55], v[176:191]
    s_cmp_lg_u32 s8, 2
    s_cbranch_scc1 L_c1_44
    v_mfma_f32_32x32x16_bf16 v[232:247], v[200:203], v[228:231], v[232:247]
L_c1_44:
    ds_read_b64_tr_b16 v[224:225], v13 offset:3200
    ds_read_b64_tr_b16 v[226:227], v13 offset:3968
    s_waitcnt lgkmcnt(6)
    v_mfma_f32_32x32x16_bf16 v[144:159], v[204:207], v[56:59], v[144:159]
    s_cmp_lg_u32 s8, 0
    s_cbranch_scc1 L_c1_45
    v_mfma_f32_32x32x16_bf16 v[232:247], v[204:207], v[228:231], v[232:247]
L_c1_45:
    ds_read_b64_tr_b16 v[192:193], v13 offset:6144
    ds_read_b64_tr_b16 v[194:195], v13 offset:6912
    v_mfma_f32_32x32x16_bf16 v[160:175], v[208:211], v[56:59], v[160:175]
    s_cmp_lg_u32 s8, 1
    s_cbranch_scc1 L_c1_46
    v_mfma_f32_32x32x16_bf16 v[232:247], v[208:211], v[228:231], v[232:247]
L_c1_46:
    ds_read_b64_tr_b16 v[196:197], v13 offset:6208
    ds_read_b64_tr_b16 v[198:199], v13 offset:6976
    v_mfma_f32_32x32x16_bf16 v[176:191], v[212:215], v[56:59], v[176:191]
    s_cmp_lg_u32 s8, 2
    s_cbranch_scc1 L_c1_47
    v_mfma_f32_32x32x16_bf16 v[232:247], v[212:215], v[228:231], v[232:247]
L_c1_47:
    ds_read_b64_tr_b16 v[200:201], v13 offset:6272
    ds_read_b64_tr_b16 v[202:203], v13 offset:7040
    s_waitcnt lgkmcnt(6)
    v_mfma_f32_32x32x16_bf16 v[144:159], v[216:219], v[60:63], v[144:159]
    s_cmp_lg_u32 s8, 0
    s_cbranch_scc1 L_c1_48
    v_mfma_f32_32x32x16_bf16 v[232:247], v[216:219], v[228:231], v[232:247]
L_c1_48:
    ds_read_b64_tr_b16 v[204:205], v13 offset:9216
    ds_read_b64_tr_b16 v[206:207], v13 offset:9984
    v_mfma_f32_32x32x16_bf16 v[160:175], v[220:223], v[60:63], v[160:175]
    s_cmp_lg_u32 s8, 1
    s_cbranch_scc1 L_c1_49
    v_mfma_f32_32x32x16_bf16 v[232:247], v[220:223], v[228:231], v[232:247]
L_c1_49:
    ds_read_b64_tr_b16 v[208:209], v13 offset:9280
    ds_read_b64_tr_b16 v[210:211], v13 offset:10048
    v_mfma_f32_32x32x16_bf16 v[176:191], v[224:227], v[60:63], v[176:191]
    s_cmp_lg_u32 s8, 2
    s_cbranch_scc1 L_c1_50
    v_mfma_f32_32x32x16_bf16 v[232:247], v[224:227], v[228:231], v[232:247]
L_c1_50:
    ds_read_b64_tr_b16 v[212:213], v13 offset:9344
    ds_read_b64_tr_b16 v[214:215], v13 offset:10112
    s_waitcnt lgkmcnt(6)
    v_mfma_f32_32x32x16_bf16 v[144:159], v[192:195], v[64:67], v[144:159]
    s_cmp_lg_u32 s8, 0
    s_cbranch_scc1 L_c1_51
    v_mfma_f32_32x32x16_bf16 v[232:247], v[192:195], v[228:231], v[232:247]
L_c1_51:
    ds_read_b64_tr_b16 v[216:217], v13 offset:12288
    ds_read_b64_tr_b16 v[218:219], v13 offset:13056
    v_mfma_f32_32x32x16_bf16 v[160:175], v[196:199], v[64:67], v[160:175]
    s_cmp_lg_u32 s8, 1
    s_cbranch_scc1 L_c1_52
    v_mfma_f32_32x32x16_bf16 v[232:247], v[196:199], v[228:231], v[232:247]
L_c1_52:
    ds_read_b64_tr_b16 v[220:221], v13 offset:12352
    ds_read_b64_tr_b16 v[222:223], v13 offset:13120
    v_mfma_f32_32x32x16_bf16 v[176:191], v[200:203], v[64:67], v[176:191]
    s_cmp_lg_u32 s8, 2
    s_cbranch_scc1 L_c1_53
    v_mfma_f32_32x32x16_bf16 v[232:247], v[200:203], v[228:231], v[232:247]
L_c1_53:
    ds_read_b64_tr_b16 v[224:225], v13 offset:12416
    ds_read_b64_tr_b16 v[226:227], v13 offset:13184
    s_waitcnt lgkmcnt(6)
    v_mfma_f32_32x32x16_bf16 v[144:159], v[204:207], v[68:71], v[144:159]
    s_cmp_lg_u32 s8, 0
    s_cbranch_scc1 L_c1_54
    v_mfma_f32_32x32x16_bf16 v[232:247], v[204:207], v[228:231], v[232:247]
L_c1_54:
    ds_read_b64_tr_b16 v[192:193], v13 offset:15360
    ds_read_b64_tr_b16 v[194:195], v13 offset:16128
    v_mfma_f32_32x32x16_bf16 v[160:175], v[208:211], v[68:71], v[160:175]
    s_cmp_lg_u32 s8, 1
    s_cbranch_scc1 L_c1_55
    v_mfma_f32_32x32x16_bf16 v[232:247], v[208:211], v[228:231], v[232:247]
L_c1_55:
    ds_read_b64_tr_b16 v[196:197], v13 offset:15424
    ds_read_b64_tr_b16 v[198:199], v13 offset:16192
    v_mfma_f32_32x32x16_bf16 v[176:191], v[212:215], v[68:71], v[176:191]
    s_cmp_lg_u32 s8, 2
    s_cbranch_scc1 L_c1_56
    v_mfma_f32_32x32x16_bf16 v[232:247], v[212:215], v[228:231], v[232:247]
L_c1_56:
    ds_read_b64_tr_b16 v[200:201], v13 offset:15488
    ds_read_b64_tr_b16 v[202:203], v13 offset:16256
    s_waitcnt lgkmcnt(6)
    v_mfma_f32_32x32x16_bf16 v[144:159], v[216:219], v[72:75], v[144:159]
    s_cmp_lg_u32 s8, 0
    s_cbranch_scc1 L_c1_57
    v_mfma_f32_32x32x16_bf16 v[232:247], v[216:219], v[228:231], v[232:247]
L_c1_57:
    ds_read_b64_tr_b16 v[204:205], v13 offset:18432
    ds_read_b64_tr_b16 v[206:207], v13 offset:19200
    v_mfma_f32_32x32x16_bf16 v[160:175], v[220:223], v[72:75], v[160:175]
    s_cmp_lg_u32 s8, 1
    s_cbranch_scc1 L_c1_58
    v_mfma_f32_32x32x16_bf16 v[232:247], v[220:223], v[228:231], v[232:247]
L_c1_58:
    ds_read_b64_tr_b16 v[208:209], v13 offset:18496
    ds_read_b64_tr_b16 v[210:211], v13 offset:19264
    v_mfma_f32_32x32x16_bf16 v[176:191], v[224:227], v[72:75], v[176:191]
    s_cmp_lg_u32 s8, 2
    s_cbranch_scc1 L_c1_59
    v_mfma_f32_32x32x16_bf16 v[232:247], v[224:227], v[228:231], v[232:247]
L_c1_59:
    ds_read_b64_tr_b16 v[212:213], v13 offset:18560
    ds_read_b64_tr_b16 v[214:215], v13 offset:19328
    s_waitcnt lgkmcnt(6)
    v_mfma_f32_32x32x16_bf16 v[144:159], v[192:195], v[76:79], v[144:159]
    s_cmp_lg_u32 s8, 0
    s_cbranch_scc1 L_c1_60
    v_mfma_f32_32x32x16_bf16 v[232:247], v[192:195], v[228:231], v[232:247]
L_c1_60:
    ds_read_b64_tr_b16 v[216:217], v13 offset:21504
    ds_read_b64_tr_b16 v[218:219], v13 offset:22272
    v_mfma_f32_32x32x16_bf16 v[160:175], v[196:199], v[76:79], v[160:175]
    s_cmp_lg_u32 s8, 1
    s_cbranch_scc1 L_c1_61
    v_mfma_f32_32x32x16_bf16 v[232:247], v[196:199], v[228:231], v[232:247]
L_c1_61:
    ds_read_b64_tr_b16 v[220:221], v13 offset:21568
    ds_read_b64_tr_b16 v[222:223], v13 offset:22336
    v_mfma_f32_32x32x16_bf16 v[176:191], v[200:203], v[76:79], v[176:191]
    s_cmp_lg_u32 s8, 2
    s_cbranch_scc1 L_c1_62
    v_mfma_f32_32x32x16_bf16 v[232:247], v[200:203], v[228:231], v[232:247]
L_c1_62:
    ds_read_b64_tr_b16 v[224:225], v13 offset:21632
    ds_read_b64_tr_b16 v[226:227], v13 offset:22400
    s_waitcnt lgkmcnt(6)
    v_mfma_f32_32x32x16_bf16 v[144:159], v[204:207], v[80:83], v[144:159]
    s_cmp_lg_u32 s8, 0
    s_cbranch_scc1 L_c1_63
    v_mfma_f32_32x32x16_bf16 v[232:247], v[204:207], v[228:231], v[232:247]
L_c1_63:
    ds_read_b64_tr_b16 v[192:193], v13 offset:24576
    ds_read_b64_tr_b16 v[194:195], v13 offset:25344
    v_mfma_f32_32x32x16_bf16 v[160:175], v[208:211], v[80:83], v[160:175]
    s_cmp_lg_u32 s8, 1
    s_cbranch_scc1 L_c1_64
    v_mfma_f32_32x32x16_bf16 v[232:247], v[208:211], v[228:231], v[232:247]
L_c1_64:
    ds_read_b64_tr_b16 v[196:197], v13 offset:24640
    ds_read_b64_tr_b16 v[198:199], v13 offset:25408
    v_mfma_f32_32x32x16_bf16 v[176:191], v[212:215], v[80:83], v[176:191]
    s_cmp_lg_u32 s8, 2
    s_cbranch_scc1 L_c1_65
    v_mfma_f32_32x32x16_bf16 v[232:247], v[212:215], v[228:231], v[232:247]
L_c1_65:
    ds_read_b64_tr_b16 v[200:201], v13 offset:24704
    ds_read_b64_tr_b16 v[202:203], v13 offset:25472
    s_waitcnt lgkmcnt(6)
    v_mfma_f32_32x32x16_bf16 v[144:159], v[216:219], v[84:87], v[144:159]
    s_cmp_lg_u32 s8, 0
    s_cbranch_scc1 L_c1_66
    v_mfma_f32_32x32x16_bf16 v[232:247], v[216:219], v[228:231], v[232:247]
L_c1_66:
    ds_read_b64_tr_b16 v[204:205], v13 offset:27648
    ds_read_b64_tr_b16 v[206:207], v13 offset:28416
    v_mfma_f32_32x32x16_bf16 v[160:175], v[220:223], v[84:87], v[160:175]
    s_cmp_lg_u32 s8, 1
    s_cbranch_scc1 L_c1_67
    v_mfma_f32_32x32x16_bf16 v[232:247], v[220:223], v[228:231], v[232:247]
L_c1_67:
    ds_read_b64_tr_b16 v[208:209], v13 offset:27712
    ds_read_b64_tr_b16 v[210:211], v13 offset:28480
    v_mfma_f32_32x32x16_bf16 v[176:191], v[224:227], v[84:87], v[176:191]
    s_cmp_lg_u32 s8, 2
    s_cbranch_scc1 L_c1_68
    v_mfma_f32_32x32x16_bf16 v[232:247], v[224:227], v[228:231], v[232:247]
L_c1_68:
    ds_read_b64_tr_b16 v[212:213], v13 offset:27776
    ds_read_b64_tr_b16 v[214:215], v13 offset:28544
    s_waitcnt lgkmcnt(6)
    v_mfma_f32_32x32x16_bf16 v[144:159], v[192:195], v[88:91], v[144:159]
    s_cmp_lg_u32 s8, 0
    s_cbranch_scc1 L_c1_69
    v_mfma_f32_32x32x16_bf16 v[232:247], v[192:195], v[228:231], v[232:247]
L_c1_69:
    ds_read_b64_tr_b16 v[216:217], v13 offset:30720
    ds_read_b64_tr_b16 v[218:219], v13 offset:31488
    v_mfma_f32_32x32x16_bf16 v[160:175], v[196:199], v[88:91], v[160:175]
    s_cmp_lg_u32 s8, 1
    s_cbranch_scc1 L_c1_70
    v_mfma_f32_32x32x16_bf16 v[232:247], v[196:199], v[228:231], v[232:247]
L_c1_70:
    ds_read_b64_tr_b16 v[220:221], v13 offset:30784
    ds_read_b64_tr_b16 v[222:223], v13 offset:31552
    v_mfma_f32_32x32x16_bf16 v[176:191], v[200:203], v[88:91], v[176:191]
    s_cmp_lg_u32 s8, 2
    s_cbranch_scc1 L_c1_71
    v_mfma_f32_32x32x16_bf16 v[232:247], v[200:203], v[228:231], v[232:247]
L_c1_71:
    ds_read_b64_tr_b16 v[224:225], v13 offset:30848
    ds_read_b64_tr_b16 v[226:227], v13 offset:31616
    s_waitcnt lgkmcnt(6)
    v_mfma_f32_32x32x16_bf16 v[144:159], v[204:207], v[92:95], v[144:159]
    s_cmp_lg_u32 s8, 0
    s_cbranch_scc1 L_c1_72
    v_mfma_f32_32x32x16_bf16 v[232:247], v[204:207], v[228:231], v[232:247]
L_c1_72:
    ds_read_b64_tr_b16 v[192:193], v13 offset:33792
    ds_read_b64_tr_b16 v[194:195], v13 offset:34560
    v_mfma_f32_32x32x16_bf16 v[160:175], v[208:211], v[92:95], v[160:175]
    s_cmp_lg_u32 s8, 1
    s_cbranch_scc1 L_c1_73
    v_mfma_f32_32x32x16_bf16 v[232:247], v[208:211], v[228:231], v[232:247]
L_c1_73:
    ds_read_b64_tr_b16 v[196:197], v13 offset:33856
    ds_read_b64_tr_b16 v[198:199], v13 offset:34624
    v_mfma_f32_32x32x16_bf16 v[176:191], v[212:215], v[92:95], v[176:191]
    s_cmp_lg_u32 s8, 2
    s_cbranch_scc1 L_c1_74
    v_mfma_f32_32x32x16_bf16 v[232:247], v[212:215], v[228:231], v[232:247]
L_c1_74:
    ds_read_b64_tr_b16 v[200:201], v13 offset:33920
    ds_read_b64_tr_b16 v[202:203], v13 offset:34688
    s_waitcnt lgkmcnt(6)
    v_mfma_f32_32x32x16_bf16 v[144:159], v[216:219], v[96:99], v[144:159]
    s_cmp_lg_u32 s8, 0
    s_cbranch_scc1 L_c1_75
    v_mfma_f32_32x32x16_bf16 v[232:247], v[216:219], v[228:231], v[232:247]
L_c1_75:
    ds_read_b64_tr_b16 v[204:205], v13 offset:36864
    ds_read_b64_tr_b16 v[206:207], v13 offset:37632
    v_mfma_f32_32x32x16_bf16 v[160:175], v[220:223], v[96:99], v[160:175]
    s_cmp_lg_u32 s8, 1
    s_cbranch_scc1 L_c1_76
    v_mfma_f32_32x32x16_bf16 v[232:247], v[220:223], v[228:231], v[232:247]
L_c1_76:
    ds_read_b64_tr_b16 v[208:209], v13 offset:36928
    ds_read_b64_tr_b16 v[210:211], v13 offset:37696
    v_mfma_f32_32x32x16_bf16 v[176:191], v[224:227], v[96:99], v[176:191]
    s_cmp_lg_u32 s8, 2
    s_cbranch_scc1 L_c1_77
    v_mfma_f32_32x32x16_bf16 v[232:247], v[224:227], v[228:231], v[232:247]
L_c1_77:
    ds_read_b64_tr_b16 v[212:213], v13 offset:36992
    ds_read_b64_tr_b16 v[214:215], v13 offset:37760
    s_waitcnt lgkmcnt(6)
    v_mfma_f32_32x32x16_bf16 v[144:159], v[192:195], v[100:103], v[144:159]
    s_cmp_lg_u32 s8, 0
    s_cbranch_scc1 L_c1_78
    v_mfma_f32_32x32x16_bf16 v[232:247], v[192:195], v[228:231], v[232:247]
L_c1_78:
    ds_read_b64_tr_b16 v[216:217], v13 offset:39936
    ds_read_b64_tr_b16 v[218:219], v13 offset:40704
    v_mfma_f32_32x32x16_bf16 v[160:175], v[196:199], v[100:103], v[160:175]
    s_cmp_lg_u32 s8, 1
    s_cbranch_scc1 L_c1_79
    v_mfma_f32_32x32x16_bf16 v[232:247], v[196:199], v[228:231], v[232:247]
L_c1_79:
    ds_read_b64_tr_b16 v[220:221], v13 offset:40000
    ds_read_b64_tr_b16 v[222:223], v13 offset:40768
    v_mfma_f32_32x32x16_bf16 v[176:191], v[200:203], v[100:103], v[176:191]
    s_cmp_lg_u32 s8, 2
    s_cbranch_scc1 L_c1_80
    v_mfma_f32_32x32x16_bf16 v[232:247], v[200:203], v[228:231], v[232:247]
L_c1_80:
    ds_read_b64_tr_b16 v[224:225], v13 offset:40064
    ds_read_b64_tr_b16 v[226:227], v13 offset:40832
    s_waitcnt lgkmcnt(6)
    v_mfma_f32_32x32x16_bf16 v[144:159], v[204:207], v[104:107], v[144:159]
    s_cmp_lg_u32 s8, 0
    s_cbranch_scc1 L_c1_81
    v_mfma_f32_32x32x16_bf16 v[232:247], v[204:207], v[228:231], v[232:247]
L_c1_81:
    ds_read_b64_tr_b16 v[192:193], v13 offset:43008
    ds_read_b64_tr_b16 v[194:195], v13 offset:43776
    v_mfma_f32_32x32x16_bf16 v[160:175], v[208:211], v[104:107], v[160:175]
    s_cmp_lg_u32 s8, 1
    s_cbranch_scc1 L_c1_82
    v_mfma_f32_32x32x16_bf16 v[232:247], v[208:211], v[228:231], v[232:247]
L_c1_82:
    ds_read_b64_tr_b16 v[196:197], v13 offset:43072
    ds_read_b64_tr_b16 v[198:199], v13 offset:43840
    v_mfma_f32_32x32x16_bf16 v[176:191], v[212:215], v[104:107], v[176:191]
    s_cmp_lg_u32 s8, 2
    s_cbranch_scc1 L_c1_83
    v_mfma_f32_32x32x16_bf16 v[232:247], v[212:215], v[228:231], v[232:247]
L_c1_83:
    ds_read_b64_tr_b16 v[200:201], v13 offset:43136
    ds_read_b64_tr_b16 v[202:203], v13 offset:43904
    s_waitcnt lgkmcnt(6)
    v_mfma_f32_32x32x16_bf16 v[144:159], v[216:219], v[108:111], v[144:159]
    s_cmp_lg_u32 s8, 0
    s_cbranch_scc1 L_c1_84
    v_mfma_f32_32x32x16_bf16 v[232:247], v[216:219], v[228:231], v[232:247]
L_c1_84:
    ds_read_b64_tr_b16 v[204:205], v13 offset:46080
    ds_read_b64_tr_b16 v[206:207], v13 offset:46848
    v_mfma_f32_32x32x16_bf16 v[160:175], v[220:223], v[108:111], v[160:175]
    s_cmp_lg_u32 s8, 1
    s_cbranch_scc1 L_c1_85
    v_mfma_f32_32x32x16_bf16 v[232:247], v[220:223], v[228:231], v[232:247]
L_c1_85:
    ds_read_b64_tr_b16 v[208:209], v13 offset:46144
    ds_read_b64_tr_b16 v[210:211], v13 offset:46912
    v_mfma_f32_32x32x16_bf16 v[176:191], v[224:227], v[108:111], v[176:191]
    s_cmp_lg_u32 s8, 2
    s_cbranch_scc1 L_c1_86
    v_mfma_f32_32x32x16_bf16 v[232:247], v[224:227], v[228:231], v[232:247]
L_c1_86:
    ds_read_b64_tr_b16 v[212:213], v13 offset:46208
    ds_read_b64_tr_b16 v[214:215], v13 offset:46976
    s_waitcnt lgkmcnt(6)
    v_mfma_f32_32x32x16_bf16 v[144:159], v[192:195], v[112:115], v[144:159]
    s_cmp_lg_u32 s8, 0
    s_cbranch_scc1 L_c1_87
    v_mfma_f32_32x32x16_bf16 v[232:247], v[192:195], v[228:231], v[232:247]
L_c1_87:
    ds_read_b64_tr_b16 v[216:217], v14 offset:0
    ds_read_b64_tr_b16 v[218:219], v14 offset:768
    v_mfma_f32_32x32x16_bf16 v[160:175], v[196:199], v[112:115], v[160:175]
    s_cmp_lg_u32 s8, 1
    s_cbranch_scc1 L_c1_88
    v_mfma_f32_32x32x16_bf16 v[232:247], v[196:199], v[228:231], v[232:247]
L_c1_88:
    ds_read_b64_tr_b16 v[220:221], v14 offset:64
    ds_read_b64_tr_b16 v[222:223], v14 offset:832
    v_mfma_f32_32x32x16_bf16 v[176:191], v[200:203], v[112:115], v[176:191]
    s_cmp_lg_u32 s8, 2
    s_cbranch_scc1 L_c1_89
    v_mfma_f32_32x32x16_bf16 v[232:247], v[200:203], v[228:231], v[232:247]
L_c1_89:
    ds_read_b64_tr_b16 v[224:225], v14 offset:128
    ds_read_b64_tr_b16 v[226:227], v14 offset:896
    s_waitcnt lgkmcnt(6)
    v_mfma_f32_32x32x16_bf16 v[144:159], v[204:207], v[116:119], v[144:159]
    s_cmp_lg_u32 s8, 0
    s_cbranch_scc1 L_c1_90
    v_mfma_f32_32x32x16_bf16 v[232:247], v[204:207], v[228:231], v[232:247]
L_c1_90:
    ds_read_b64_tr_b16 v[192:193], v14 offset:3072
    ds_read_b64_tr_b16 v[194:195], v14 offset:3840
    v_mfma_f32_32x32x16_bf16 v[160:175], v[208:211], v[116:119], v[160:175]
    s_cmp_lg_u32 s8, 1
    s_cbranch_scc1 L_c1_91
    v_mfma_f32_32x32x16_bf16 v[232:247], v[208:211], v[228:231], v[232:247]
L_c1_91:
    ds_read_b64_tr_b16 v[196:197], v14 offset:3136
    ds_read_b64_tr_b16 v[198:199], v14 offset:3904
    v_mfma_f32_32x32x16_bf16 v[176:191], v[212:215], v[116:119], v[176:191]
    s_cmp_lg_u32 s8, 2
    s_cbranch_scc1 L_c1_92
    v_mfma_f32_32x32x16_bf16 v[232:247], v[212:215], v[228:231], v[232:247]
L_c1_92:
    ds_read_b64_tr_b16 v[200:201], v14 offset:3200
    ds_read_b64_tr_b16 v[202:203], v14 offset:3968
    s_waitcnt lgkmcnt(6)
    v_mfma_f32_32x32x16_bf16 v[144:159], v[216:219], v[120:123], v[144:159]
    s_cmp_lg_u32 s8, 0
    s_cbranch_scc1 L_c1_93
    v_mfma_f32_32x32x16_bf16 v[232:247], v[216:219], v[228:231], v[232:247]
L_c1_93:
    ds_read_b64_tr_b16 v[204:205], v14 offset:6144
    ds_read_b64_tr_b16 v[206:207], v14 offset:6912
    v_mfma_f32_32x32x16_bf16 v[160:175], v[220:223], v[120:123], v[160:175]
    s_cmp_lg_u32 s8, 1
    s_cbranch_scc1 L_c1_94
    v_mfma_f32_32x32x16_bf16 v[232:247], v[220:223], v[228:231], v[232:247]
L_c1_94:
    ds_read_b64_tr_b16 v[208:209], v14 offset:6208
    ds_read_b64_tr_b16 v[210:211], v14 offset:6976
    v_mfma_f32_32x32x16_bf16 v[176:191], v[224:227], v[120:123], v[176:191]
    s_cmp_lg_u32 s8, 2
    s_cbranch_scc1 L_c1_95
    v_mfma_f32_32x32x16_bf16 v[232:247], v[224:227], v[228:231], v[232:247]
L_c1_95:
    ds_read_b64_tr_b16 v[212:213], v14 offset:6272
    ds_read_b64_tr_b16 v[214:215], v14 offset:7040
    s_waitcnt lgkmcnt(6)
    v_mfma_f32_32x32x16_bf16 v[144:159], v[192:195], v[124:127], v[144:159]
    s_cmp_lg_u32 s8, 0
    s_cbranch_scc1 L_c1_96
    v_mfma_f32_32x32x16_bf16 v[232:247], v[192:195], v[228:231], v[232:247]
L_c1_96:
    ds_read_b64_tr_b16 v[216:217], v14 offset:9216
    ds_read_b64_tr_b16 v[218:219], v14 offset:9984
    v_mfma_f32_32x32x16_bf16 v[160:175], v[196:199], v[124:127], v[160:175]
    s_cmp_lg_u32 s8, 1
    s_cbranch_scc1 L_c1_97
    v_mfma_f32_32x32x16_bf16 v[232:247], v[196:199], v[228:231], v[232:247]
L_c1_97:
    ds_read_b64_tr_b16 v[220:221], v14 offset:9280
    ds_read_b64_tr_b16 v[222:223], v14 offset:10048
    v_mfma_f32_32x32x16_bf16 v[176:191], v[200:203], v[124:127], v[176:191]
    s_cmp_lg_u32 s8, 2
    s_cbranch_scc1 L_c1_98
    v_mfma_f32_32x32x16_bf16 v[232:247], v[200:203], v[228:231], v[232:247]
L_c1_98:
    ds_read_b64_tr_b16 v[224:225], v14 offset:9344
    ds_read_b64_tr_b16 v[226:227], v14 offset:10112
    s_waitcnt lgkmcnt(6)
    v_mfma_f32_32x32x16_bf16 v[144:159], v[204:207], v[128:131], v[144:159]
    s_cmp_lg_u32 s8, 0
    s_cbranch_scc1 L_c1_99
    v_mfma_f32_32x32x16_bf16 v[232:247], v[204:207], v[228:231], v[232:247]
L_c1_99:
    ds_read_b64_tr_b16 v[192:193], v14 offset:12288
    ds_read_b64_tr_b16 v[194:195], v14 offset:13056
    v_mfma_f32_32x32x16_bf16 v[160:175], v[208:211], v[128:131], v[160:175]
    s_cmp_lg_u32 s8, 1
    s_cbranch_scc1 L_c1_100
    v_mfma_f32_32x32x16_bf16 v[232:247], v[208:211], v[228:231], v[232:247]
L_c1_100:
    ds_read_b64_tr_b16 v[196:197], v14 offset:12352
    ds_read_b64_tr_b16 v[198:199], v14 offset:13120
    v_mfma_f32_32x32x16_bf16 v[176:191], v[212:215], v[128:131], v[176:191]
    s_cmp_lg_u32 s8, 2
    s_cbranch_scc1 L_c1_101
    v_mfma_f32_32x32x16_bf16 v[232:247], v[212:215], v[228:231], v[232:247]
L_c1_101:
    ds_read_b64_tr_b16 v[200:201], v14 offset:12416
    ds_read_b64_tr_b16 v[202:203], v14 offset:13184
    s_waitcnt lgkmcnt(6)
    v_mfma_f32_32x32x16_bf16 v[144:159], v[216:219], v[132:135], v[144:159]
    s_cmp_lg_u32 s8, 0
    s_cbranch_scc1 L_c1_102
    v_mfma_f32_32x32x16_bf16 v[232:247], v[216:219], v[228:231], v[232:247]
L_c1_102:
    ds_read_b64_tr_b16 v[204:205], v14 offset:15360
    ds_read_b64_tr_b16 v[206:207], v14 offset:16128
    v_mfma_f32_32x32x16_bf16 v[160:175], v[220:223], v[132:135], v[160:175]
    s_cmp_lg_u32 s8, 1
    s_cbranch_scc1 L_c1_103
    v_mfma_f32_32x32x16_bf16 v[232:247], v[220:223], v[228:231], v[232:247]
L_c1_103:
    ds_read_b64_tr_b16 v[208:209], v14 offset:15424
    ds_read_b64_tr_b16 v[210:211], v14 offset:16192
    v_mfma_f32_32x32x16_bf16 v[176:191], v[224:227], v[132:135], v[176:191]
    s_cmp_lg_u32 s8, 2
    s_cbranch_scc1 L_c1_104
    v_mfma_f32_32x32x16_bf16 v[232:247], v[224:227], v[228:231], v[232:247]
L_c1_104:
    ds_read_b64_tr_b16 v[212:213], v14 offset:15488
    ds_read_b64_tr_b16 v[214:215], v14 offset:16256
    s_waitcnt lgkmcnt(6)
    v_mfma_f32_32x32x16_bf16 v[144:159], v[192:195], v[136:139], v[144:159]
    s_cmp_lg_u32 s8, 0
    s_cbranch_scc1 L_c1_105
    v_mfma_f32_32x32x16_bf16 v[232:247], v[192:195], v[228:231], v[232:247]
L_c1_105:
    v_mfma_f32_32x32x16_bf16 v[160:175], v[196:199], v[136:139], v[160:175]
    s_cmp_lg_u32 s8, 1
    s_cbranch_scc1 L_c1_106
    v_mfma_f32_32x32x16_bf16 v[232:247], v[196:199], v[228:231], v[232:247]
L_c1_106:
    v_mfma_f32_32x32x16_bf16 v[176:191], v[200:203], v[136:139], v[176:191]
    s_cmp_lg_u32 s8, 2
    s_cbranch_scc1 L_c1_107
    v_mfma_f32_32x32x16_bf16 v[232:247], v[200:203], v[228:231], v[232:247]
L_c1_107:
    s_barrier
    s_waitcnt lgkmcnt(0)
    v_mfma_f32_32x32x16_bf16 v[144:159], v[204:207], v[140:143], v[144:159]
    s_cmp_lg_u32 s8, 0
    s_cbranch_scc1 L_c1_108
    v_mfma_f32_32x32x16_bf16 v[232:247], v[204:207], v[228:231], v[232:247]
L_c1_108:
    v_mfma_f32_32x32x16_bf16 v[160:175], v[208:211], v[140:143], v[160:175]
    s_cmp_lg_u32 s8, 1
    s_cbranch_scc1 L_c1_109
    v_mfma_f32_32x32x16_bf16 v[232:247], v[208:211], v[228:231], v[232:247]
L_c1_109:
    v_mfma_f32_32x32x16_bf16 v[176:191], v[212:215], v[140:143], v[176:191]
    s_cmp_lg_u32 s8, 2
    s_cbranch_scc1 L_c1_110
    v_mfma_f32_32x32x16_bf16 v[232:247], v[212:215], v[228:231], v[232:247]
L_c1_110:
    s_nop 7
    s_nop 7
    s_cmp_ge_u32 s8, 3
    s_cbranch_scc1 L_cspub_111
    v_lshrrev_b32 v8, 5, v1
    v_lshlrev_b32 v8, 4, v8
    s_lshl_b32 s20, s8, 7
    s_add_u32 s20, s20, 102400
    v_add_u32 v8, s20, v8
    s_mov_b32 exec_lo, 1
    s_mov_b32 exec_hi, 1
    ds_write_b128 v8, v[232:235] offset:0
    ds_write_b128 v8, v[236:239] offset:32
    ds_write_b128 v8, v[240:243] offset:64
    ds_write_b128 v8, v[244:247] offset:96
    s_mov_b64 exec, -1
L_cspub_111:
    s_waitcnt lgkmcnt(0)
    s_barrier
    s_lshl_b32 s20, s8, 8
    s_add_u32 s20, s20, 104448
    v_and_b32 v8, 31, v1
    v_lshlrev_b32 v8, 3, v8
    v_add_u32 v8, s20, v8
    ds_read_b64 v[10:11], v8
    v_lshrrev_b32 v8, 5, v1
    v_lshlrev_b32 v8, 4, v8
    v_add_u32 v8, 102400, v8
    ds_read_b128 v[16:19], v8 offset:0
    ds_read_b128 v[20:23], v8 offset:32
    ds_read_b128 v[24:27], v8 offset:64
    ds_read_b128 v[28:31], v8 offset:96
    ds_read_b128 v[32:35], v8 offset:128
    ds_read_b128 v[36:39], v8 offset:160
    ds_read_b128 v[40:43], v8 offset:192
    ds_read_b128 v[44:47], v8 offset:224
    ds_read_b128 v[48:51], v8 offset:256
    ds_read_b128 v[52:55], v8 offset:288
    ds_read_b128 v[56:59], v8 offset:320
    ds_read_b128 v[60:63], v8 offset:352
    s_waitcnt lgkmcnt(0)
    v_add_f32 v10, v10, v248
    v_add_f32 v11, v11, v249
    v_mul_f32 v4, 0xbb000000, v10
    v_mul_f32 v11, 0x3b000000, v11
    v_fma_f32 v11, -v4, v4, v11
    v_max_f32 v11, 0, v11
    v_add_f32 v11, 0x3727c5ac, v11
    v_rsq_f32 v6, v11
    s_lshl_b32 s15, s13, 2
    s_add_u32 s15, s15, s8
    s_mul_i32 s21, s14, 393216
    s_lshl_b32 s22, s15, 10
    s_add_u32 s21, s21, s22
    s_add_u32 s21, s21, 14680064
    s_mul_i32 s23, s14, 3
    s_add_u32 s23, s23, 0
    s_cmp_lt_u32 s23, 16
    s_cselect_b32 s24, 0x3eb8aa3b, 1.0
    v_mul_f32 v8, s24, v6
    v_pk_fma_f32 v[144:145], v[16:17], v[4:5], v[144:145] op_sel_hi:[1,0,1]
    v_pk_fma_f32 v[146:147], v[18:19], v[4:5], v[146:147] op_sel_hi:[1,0,1]
    v_pk_fma_f32 v[148:149], v[20:21], v[4:5], v[148:149] op_sel_hi:[1,0,1]
    v_pk_fma_f32 v[150:151], v[22:23], v[4:5], v[150:151] op_sel_hi:[1,0,1]
    v_pk_fma_f32 v[152:153], v[24:25], v[4:5], v[152:153] op_sel_hi:[1,0,1]
    v_pk_fma_f32 v[154:155], v[26:27], v[4:5], v[154:155] op_sel_hi:[1,0,1]
    v_pk_fma_f32 v[156:157], v[28:29], v[4:5], v[156:157] op_sel_hi:[1,0,1]
    v_pk_fma_f32 v[158:159], v[30:31], v[4:5], v[158:159] op_sel_hi:[1,0,1]
    v_pk_mul_f32 v[144:145], v[144:145], v[8:9] op_sel_hi:[1,0]
    v_pk_mul_f32 v[146:147], v[146:147], v[8:9] op_sel_hi:[1,0]
    v_pk_mul_f32 v[148:149], v[148:149], v[8:9] op_sel_hi:[1,0]
    v_pk_mul_f32 v[150:151], v[150:151], v[8:9] op_sel_hi:[1,0]
    v_pk_mul_f32 v[152:153], v[152:153], v[8:9] op_sel_hi:[1,0]
    v_pk_mul_f32 v[154:155], v[154:155], v[8:9] op_sel_hi:[1,0]
    v_pk_mul_f32 v[156:157], v[156:157], v[8:9] op_sel_hi:[1,0]
    v_pk_mul_f32 v[158:159], v[158:159], v[8:9] op_sel_hi:[1,0]
    v_cvt_pk_bf16_f32 v192, v144, v145
    v_cvt_pk_bf16_f32 v193, v146, v147
    v_cvt_pk_bf16_f32 v194, v148, v149
    v_cvt_pk_bf16_f32 v195, v150, v151
    v_cvt_pk_bf16_f32 v196, v152, v153
    v_cvt_pk_bf16_f32 v197, v154, v155
    v_cvt_pk_bf16_f32 v198, v156, v157
    v_cvt_pk_bf16_f32 v199, v158, v159
    s_add_u32 s23, s21, 0
    buffer_store_dwordx4 v[192:195], v2, s[4:7], s23 offen sc1
    s_add_u32 s23, s21, 65536
    buffer_store_dwordx4 v[196:199], v2, s[4:7], s23 offen sc1
    s_mul_i32 s23, s14, 3
    s_add_u32 s23, s23, 1
    s_cmp_lt_u32 s23, 16
    s_cselect_b32 s24, 0x3eb8aa3b, 1.0
    v_mul_f32 v8, s24, v6
    v_pk_fma_f32 v[160:161], v[32:33], v[4:5], v[160:161] op_sel_hi:[1,0,1]
    v_pk_fma_f32 v[162:163], v[34:35], v[4:5], v[162:163] op_sel_hi:[1,0,1]
    v_pk_fma_f32 v[164:165], v[36:37], v[4:5], v[164:165] op_sel_hi:[1,0,1]
    v_pk_fma_f32 v[166:167], v[38:39], v[4:5], v[166:167] op_sel_hi:[1,0,1]
    v_pk_fma_f32 v[168:169], v[40:41], v[4:5], v[168:169] op_sel_hi:[1,0,1]
    v_pk_fma_f32 v[170:171], v[42:43], v[4:5], v[170:171] op_sel_hi:[1,0,1]
    v_pk_fma_f32 v[172:173], v[44:45], v[4:5], v[172:173] op_sel_hi:[1,0,1]
    v_pk_fma_f32 v[174:175], v[46:47], v[4:5], v[174:175] op_sel_hi:[1,0,1]
    v_pk_mul_f32 v[160:161], v[160:161], v[8:9] op_sel_hi:[1,0]
    v_pk_mul_f32 v[162:163], v[162:163], v[8:9] op_sel_hi:[1,0]
    v_pk_mul_f32 v[164:165], v[164:165], v[8:9] op_sel_hi:[1,0]
    v_pk_mul_f32 v[166:167], v[166:167], v[8:9] op_sel_hi:[1,0]
    v_pk_mul_f32 v[168:169], v[168:169], v[8:9] op_sel_hi:[1,0]
    v_pk_mul_f32 v[170:171], v[170:171], v[8:9] op_sel_hi:[1,0]
    v_pk_mul_f32 v[172:173], v[172:173], v[8:9] op_sel_hi:[1,0]
    v_pk_mul_f32 v[174:175], v[174:175], v[8:9] op_sel_hi:[1,0]
    v_cvt_pk_bf16_f32 v200, v160, v161
    v_cvt_pk_bf16_f32 v201, v162, v163
    v_cvt_pk_bf16_f32 v202, v164, v165
    v_cvt_pk_bf16_f32 v203, v166, v167
    v_cvt_pk_bf16_f32 v204, v168, v169
    v_cvt_pk_bf16_f32 v205, v170, v171
    v_cvt_pk_bf16_f32 v206, v172, v173
    v_cvt_pk_bf16_f32 v207, v174, v175
    s_add_u32 s23, s21, 131072
    buffer_store_dwordx4 v[200:203], v2, s[4:7], s23 offen sc1
    s_add_u32 s23, s21, 196608
    buffer_store_dwordx4 v[204:207], v2, s[4:7], s23 offen sc1
    s_mul_i32 s23, s14, 3
    s_add_u32 s23, s23, 2
    s_cmp_lt_u32 s23, 16
    s_cselect_b32 s24, 0x3eb8aa3b, 1.0
    v_mul_f32 v8, s24, v6
    v_pk_fma_f32 v[176:177], v[48:49], v[4:5], v[176:177] op_sel_hi:[1,0,1]
    v_pk_fma_f32 v[178:179], v[50:51], v[4:5], v[178:179] op_sel_hi:[1,0,1]
    v_pk_fma_f32 v[180:181], v[52:53], v[4:5], v[180:181] op_sel_hi:[1,0,1]
    v_pk_fma_f32 v[182:183], v[54:55], v[4:5], v[182:183] op_sel_hi:[1,0,1]
    v_pk_fma_f32 v[184:185], v[56:57], v[4:5], v[184:185] op_sel_hi:[1,0,1]
    v_pk_fma_f32 v[186:187], v[58:59], v[4:5], v[186:187] op_sel_hi:[1,0,1]
    v_pk_fma_f32 v[188:189], v[60:61], v[4:5], v[188:189] op_sel_hi:[1,0,1]
    v_pk_fma_f32 v[190:191], v[62:63], v[4:5], v[190:191] op_sel_hi:[1,0,1]
    v_pk_mul_f32 v[176:177], v[176:177], v[8:9] op_sel_hi:[1,0]
    v_pk_mul_f32 v[178:179], v[178:179], v[8:9] op_sel_hi:[1,0]
    v_pk_mul_f32 v[180:181], v[180:181], v[8:9] op_sel_hi:[1,0]
    v_pk_mul_f32 v[182:183], v[182:183], v[8:9] op_sel_hi:[1,0]
    v_pk_mul_f32 v[184:185], v[184:185], v[8:9] op_sel_hi:[1,0]
    v_pk_mul_f32 v[186:187], v[186:187], v[8:9] op_sel_hi:[1,0]
    v_pk_mul_f32 v[188:189], v[188:189], v[8:9] op_sel_hi:[1,0]
    v_pk_mul_f32 v[190:191], v[190:191], v[8:9] op_sel_hi:[1,0]
    v_cvt_pk_bf16_f32 v208, v176, v177
    v_cvt_pk_bf16_f32 v209, v178, v179
    v_cvt_pk_bf16_f32 v210, v180, v181
    v_cvt_pk_bf16_f32 v211, v182, v183
    v_cvt_pk_bf16_f32 v212, v184, v185
    v_cvt_pk_bf16_f32 v213, v186, v187
    v_cvt_pk_bf16_f32 v214, v188, v189
    v_cvt_pk_bf16_f32 v215, v190, v191
    s_add_u32 s23, s21, 262144
    buffer_store_dwordx4 v[208:211], v2, s[4:7], s23 offen sc1
    s_add_u32 s23, s21, 327680
    buffer_store_dwordx4 v[212:215], v2, s[4:7], s23 offen sc1
    s_mov_b32 s62, 0
    s_mov_b32 s63, 0
    s_branch L_q0_end_10
L_q0_h_9:
    s_waitcnt vmcnt(0)
    s_barrier
    s_sub_u32 s20, s8, 4
    s_lshl_b32 s21, s20, 8
    s_add_u32 s21, s21, 104448
    v_and_b32 v11, 31, v1
    v_lshlrev_b32 v11, 3, v11
    v_add_u32 v11, s21, v11
    ds_write_b64 v11, v[248:249]
    s_mov_b32 s62, 0
    s_mov_b32 s63, 0
    s_cmp_ge_u32 s2, 176
    s_cbranch_scc1 L_q0nr_112
    s_sub_u32 s23, s8, 4
    s_lshl_b32 s23, s23, 3
    s_cmp_ge_u32 s2, 120
    s_cbranch_scc1 L_rw2_113
    s_cmp_ge_u32 s2, 104
    s_cbranch_scc1 L_rwo_114
    s_cmp_ge_u32 s2, 48
    s_cbranch_scc1 L_rw1_115
    s_mov_b32 s56, s52
    s_mov_b32 s57, s53
    s_mov_b32 s58, 1572864
    s_mov_b32 s21, 3072
    s_mov_b32 s22, s2
    s_lshl_b32 s61, s22, 15
    s_add_u32 s61, s61, 8388608
    s_lshl_b32 s62, s22, 7
    s_add_u32 s62, s62, 50331648
    s_sub_u32 s24, s8, 4
    s_mul_i32 s24, s24, 6144
    s_add_u32 s62, s62, s24
    s_branch L_rwc_116
L_rw1_115:
    s_mov_b32 s56, s30
    s_mov_b32 s57, s31
    s_mov_b32 s58, 1835008
    s_mov_b32 s21, 3584
    s_sub_u32 s22, s2, 48
    s_lshl_b32 s61, s22, 15
    s_add_u32 s61, s61, 10485760
    s_lshl_b32 s62, s22, 7
    s_add_u32 s62, s62, 50364416
    s_sub_u32 s24, s8, 4
    s_mul_i32 s24, s24, 7168
    s_add_u32 s62, s62, s24
    s_branch L_rwc_116
L_rwo_114:
    s_mov_b32 s56, s28
    s_mov_b32 s57, s29
    s_mov_b32 s58, 524288
    s_mov_b32 s21, 1024
    s_sub_u32 s22, s2, 104
    s_lshl_b32 s61, s22, 15
    s_add_u32 s61, s61, 9961472
L_rwc_116:
    s_lshl_b32 s26, s23, 10
    s_add_u32 s61, s61, s26
    s_branch L_rgo_117
L_rw2_113:
    s_mov_b32 s56, s32
    s_mov_b32 s57, s33
    s_mov_b32 s58, 1835008
    s_mov_b32 s21, 1024
    s_sub_u32 s26, s2, 120
    s_lshl_b32 s26, s26, 5
    s_add_u32 s26, s26, s23
    s_mul_i32 s22, s26, 9363
    s_lshr_b32 s22, s22, 20
    s_mul_i32 s27, s22, 112
    s_sub_u32 s23, s26, s27
    s_lshl_b32 s61, s26, 10
    s_add_u32 s61, s61, 12582912
L_rgo_117:
    s_and_b32 s57, s57, 0xffff
    s_mov_b32 s59, 0x00020000
    s_mov_b32 s63, 1
    v_lshrrev_b32 v8, 2, v1
    s_lshl_b32 s26, s23, 4
    v_add_u32 v8, s26, v8
    v_mul_lo_u32 v8, v8, s21
    v_and_b32 v9, 3, v1
    v_lshlrev_b32 v9, 4, v9
    s_lshl_b32 s26, s22, 6
    v_add3_u32 v8, v8, v9, s26
    s_lshl_b32 s27, s21, 4
    s_mov_b32 s26, 0
    buffer_load_dwordx4 v[168:171], v8, s[56:59], s26 offen
    s_add_u32 s26, s26, s27
    buffer_load_dwordx4 v[172:175], v8, s[56:59], s26 offen
    s_add_u32 s26, s26, s27
    buffer_load_dwordx4 v[176:179], v8, s[56:59], s26 offen
    s_add_u32 s26, s26, s27
    buffer_load_dwordx4 v[180:183], v8, s[56:59], s26 offen
    s_add_u32 s26, s26, s27
    buffer_load_dwordx4 v[184:187], v8, s[56:59], s26 offen
    s_add_u32 s26, s26, s27
    buffer_load_dwordx4 v[188:191], v8, s[56:59], s26 offen
    s_add_u32 s26, s26, s27
    buffer_load_dwordx4 v[192:195], v8, s[56:59], s26 offen
    s_add_u32 s26, s26, s27
    buffer_load_dwordx4 v[196:199], v8, s[56:59], s26 offen
    s_add_u32 s26, s26, s27
L_q0nr_112:
    s_waitcnt lgkmcnt(0)
    s_barrier
    s_barrier
    s_cmp_lg_u32 s8, 7
    s_cbranch_scc1 L_w_118
    v_lshlrev_b32 v4, 7, v1
    s_mov_b32 s22, 0
L_pp_119:
    s_mov_b32 s23, 51380224
    buffer_load_dwordx2 v[24:25], v4, s[4:7], s23 offen sc1
    s_mov_b32 s23, 51388416
    buffer_load_dwordx2 v[26:27], v4, s[4:7], s23 offen sc1
    s_mov_b32 s23, 51396608
    buffer_load_dwordx2 v[28:29], v4, s[4:7], s23 offen sc1
    s_mov_b32 s23, 51404800
    buffer_load_dwordx2 v[30:31], v4, s[4:7], s23 offen sc1
    s_waitcnt vmcnt(0)
    v_cmp_ne_u32 vcc, s9, v24
    v_cmp_ne_u32 s[24:25], s9, v26
    s_or_b64 vcc, vcc, s[24:25]
    v_cmp_ne_u32 s[24:25], s9, v28
    s_or_b64 vcc, vcc, s[24:25]
    v_cmp_ne_u32 s[24:25], s9, v30
    s_or_b64 vcc, vcc, s[24:25]
    s_cmp_eq_u64 vcc, 0
    s_cbranch_scc1 L_ppd_120
    s_add_u32 s22, s22, 1
    s_cmp_lt_u32 s22, 262144
    s_cbranch_scc1 L_pp_119
L_ppd_120:
    v_or_b32 v32, v25, v27
    v_or3_b32 v32, v32, v29, v31
    v_and_b32 v32, 0xfffff8e0, v32
    v_cmp_ne_u32 vcc, 0, v32
    s_cmp_eq_u64 vcc, 0
    s_cselect_b32 s3, 1, 0
    s_and_b32 s24, s2, 7
    s_lshr_b32 s25, s2, 3
    s_lshr_b32 s26, s39, 8
    s_and_b32 s27, s39, 0xff
    s_cmp_eq_u32 s3, 1
    s_cselect_b32 s11, s26, s24
    s_cselect_b32 s12, s27, s25
L_w_118:
L_q0_end_10:
    s_cmp_ge_u32 s8, 4
    s_cbranch_scc1 L_w_121
    s_waitcnt vmcnt(0)
L_w_121:
    s_mul_i32 s35, s10, 5
    s_add_u32 s35, s35, 1
    s_add_u32 s34, s9, s35
    s_lshl_b32 s35, s35, 8
    s_add_u32 s35, s35, s36
    s_lshl_b32 s35, s35, 7
    s_add_u32 s35, s35, 51380224
    s_waitcnt vmcnt(63)
    s_barrier
    s_cmp_lg_u32 s8, 7
    s_cbranch_scc1 L_sig_122
    v_mov_b32 v4, s34
    v_mov_b32 v5, 0
    s_mov_b64 exec, 1
    buffer_store_dword v4, v5, s[4:7], s35 offen sc1
    s_mov_b64 exec, -1
L_sig_122:
    s_cmp_lg_u32 s8, 7
    s_cbranch_scc1 L_w_123
    v_mov_b32 v4, s3
    v_mov_b32 v5, s11
    v_mov_b32 v6, s12
    v_mov_b32 v7, s9
    v_mov_b32 v8, 163776
    ds_write_b128 v8, v[4:7]
    s_waitcnt lgkmcnt(0)
L_w_123:
    s_barrier
    v_mov_b32 v8, 163776
    ds_read_b128 v[4:7], v8
    s_waitcnt lgkmcnt(0)
    v_readfirstlane_b32 s3, v4
    v_readfirstlane_b32 s11, v5
    v_readfirstlane_b32 s12, v6
    v_readfirstlane_b32 s9, v7
    s_nop 3
    s_lshl_b32 s36, s11, 5
    s_add_u32 s36, s36, s12
    s_cmp_lg_u32 s8, 7
    s_cbranch_scc1 L_w_124
    v_and_b32 v4, 3, v1
    v_lshrrev_b32 v5, 2, v1
    v_mul_u32_u24 v5, 5, v5
    v_add3_u32 v4, v4, v5, 2
    v_lshlrev_b32 v4, 15, v4
    s_lshl_b32 s20, s36, 7
    s_add_u32 s20, s20, 51380224
    s_mov_b32 exec_lo, 0xff
    s_mov_b32 exec_hi, 0x0
    buffer_load_dword v61, v4, s[4:7], s20 offen
    s_mov_b64 exec, -1
L_w_124:
    s_cmp_eq_u32 s63, 0
    s_cbranch_scc1 L_rp_skip_125
    s_sub_u32 s20, s8, 4
    s_lshl_b32 s28, s20, 12
    s_add_u32 s28, s28, 139264
    v_add_u32 v9, s28, v2
    v_lshrrev_b32 v6, 5, v1
    v_lshlrev_b32 v6, 2, v6
    v_bfe_u32 v7, v1, 2, 2
    v_add_u32 v6, v6, v7
    v_lshlrev_b32 v6, 6, v6
    v_bfe_u32 v7, v1, 4, 1
    v_lshlrev_b32 v7, 5, v7
    v_add_u32 v6, v6, v7
    v_and_b32 v7, 3, v1
    v_lshlrev_b32 v7, 3, v7
    v_add3_u32 v6, v6, v7, s28
    s_waitcnt vmcnt(0)
    ds_write_b128 v9, v[168:171] offset:0
    ds_write_b128 v9, v[172:175] offset:1024
    ds_write_b128 v9, v[176:179] offset:2048
    ds_write_b128 v9, v[180:183] offset:3072
    s_waitcnt lgkmcnt(0)
    ds_read_b64_tr_b16 v[96:97], v6 offset:0
    ds_read_b64_tr_b16 v[98:99], v6 offset:512
    ds_read_b64_tr_b16 v[100:101], v6 offset:1024
    ds_read_b64_tr_b16 v[102:103], v6 offset:1536
    ds_read_b64_tr_b16 v[104:105], v6 offset:2048
    ds_read_b64_tr_b16 v[106:107], v6 offset:2560
    ds_read_b64_tr_b16 v[108:109], v6 offset:3072
    ds_read_b64_tr_b16 v[110:111], v6 offset:3584
    s_waitcnt lgkmcnt(0)
    buffer_store_dwordx4 v[96:99], v2, s[4:7], s61 offen offset:0 sc1
    buffer_store_dwordx4 v[100:103], v2, s[4:7], s61 offen offset:1024 sc1
    buffer_store_dwordx4 v[104:107], v2, s[4:7], s61 offen offset:2048 sc1
    buffer_store_dwordx4 v[108:111], v2, s[4:7], s61 offen offset:3072 sc1
    ds_write_b128 v9, v[184:187] offset:0
    ds_write_b128 v9, v[188:191] offset:1024
    ds_write_b128 v9, v[192:195] offset:2048
    ds_write_b128 v9, v[196:199] offset:3072
    s_waitcnt lgkmcnt(0)
    ds_read_b64_tr_b16 v[112:113], v6 offset:0
    ds_read_b64_tr_b16 v[114:115], v6 offset:512
    ds_read_b64_tr_b16 v[116:117], v6 offset:1024
    ds_read_b64_tr_b16 v[118:119], v6 offset:1536
    ds_read_b64_tr_b16 v[120:121], v6 offset:2048
    ds_read_b64_tr_b16 v[122:123], v6 offset:2560
    ds_read_b64_tr_b16 v[124:125], v6 offset:3072
    ds_read_b64_tr_b16 v[126:127], v6 offset:3584
    s_waitcnt lgkmcnt(0)
    s_add_u32 s61, s61, 4096
    buffer_store_dwordx4 v[112:115], v2, s[4:7], s61 offen offset:0 sc1
    buffer_store_dwordx4 v[116:119], v2, s[4:7], s61 offen offset:1024 sc1
    buffer_store_dwordx4 v[120:123], v2, s[4:7], s61 offen offset:2048 sc1
    buffer_store_dwordx4 v[124:127], v2, s[4:7], s61 offen offset:3072 sc1
    s_cmp_eq_u32 s62, 0
    s_cbranch_scc1 L_rp_cs_126
    v_mov_b32 v30, 0x3f803f80
    v_mov_b32 v31, 0
    s_nop 0
    v_dot2_f32_bf16 v31, v96, v30, v31
    v_dot2_f32_bf16 v31, v97, v30, v31
    v_dot2_f32_bf16 v31, v98, v30, v31
    v_dot2_f32_bf16 v31, v99, v30, v31
    v_dot2_f32_bf16 v31, v100, v30, v31
    v_dot2_f32_bf16 v31, v101, v30, v31
    v_dot2_f32_bf16 v31, v102, v30, v31
    v_dot2_f32_bf16 v31, v103, v30, v31
    v_dot2_f32_bf16 v31, v104, v30, v31
    v_dot2_f32_bf16 v31, v105, v30, v31
    v_dot2_f32_bf16 v31, v106, v30, v31
    v_dot2_f32_bf16 v31, v107, v30, v31
    v_dot2_f32_bf16 v31, v108, v30, v31
    v_dot2_f32_bf16 v31, v109, v30, v31
    v_dot2_f32_bf16 v31, v110, v30, v31
    v_dot2_f32_bf16 v31, v111, v30, v31
    v_dot2_f32_bf16 v31, v112, v30, v31
    v_dot2_f32_bf16 v31, v113, v30, v31
    v_dot2_f32_bf16 v31, v114, v30, v31
    v_dot2_f32_bf16 v31, v115, v30, v31
    v_dot2_f32_bf16 v31, v116, v30, v31
    v_dot2_f32_bf16 v31, v117, v30, v31
    v_dot2_f32_bf16 v31, v118, v30, v31
    v_dot2_f32_bf16 v31, v119, v30, v31
    v_dot2_f32_bf16 v31, v120, v30, v31
    v_dot2_f32_bf16 v31, v121, v30, v31
    v_dot2_f32_bf16 v31, v122, v30, v31
    v_dot2_f32_bf16 v31, v123, v30, v31
    v_dot2_f32_bf16 v31, v124, v30, v31
    v_dot2_f32_bf16 v31, v125, v30, v31
    v_dot2_f32_bf16 v31, v126, v30, v31
    v_dot2_f32_bf16 v31, v127, v30, v31
    s_nop 2
    v_mov_b32 v32, v31
    s_nop 1
    v_permlane32_swap_b32 v31, v32
    s_nop 1
    v_add_f32 v31, v31, v32
    v_lshlrev_b32 v33, 2, v1
    s_mov_b32 exec_lo, 0xffffffff
    s_mov_b32 exec_hi, 0x0
    buffer_store_dword v31, v33, s[4:7], s62 offen sc1
    s_mov_b64 exec, -1
L_rp_cs_126:
L_rp_skip_125:
    s_branch L_att
L_layer:
    s_and_b32 s13, s12, 1
    s_lshl_b32 s14, s11, 1
    s_add_u32 s13, s13, s14
    s_lshr_b32 s14, s12, 1
    s_cmp_lg_u32 s8, 4
    s_cbranch_scc1 L_w_128
    s_mul_i32 s18, s14, 384
    s_add_u32 s18, s18, 50331648
    v_lshlrev_b32 v4, 2, v1
    buffer_load_dword v8, v4, s[4:7], s18 offen
    buffer_load_dword v9, v4, s[4:7], s18 offen offset:256
    s_add_u32 s18, s18, 6144
    buffer_load_dword v10, v4, s[4:7], s18 offen
    buffer_load_dword v11, v4, s[4:7], s18 offen offset:256
    s_add_u32 s18, s18, 6144
    buffer_load_dword v12, v4, s[4:7], s18 offen
    buffer_load_dword v13, v4, s[4:7], s18 offen offset:256
    s_add_u32 s18, s18, 6144
    buffer_load_dword v14, v4, s[4:7], s18 offen
    buffer_load_dword v15, v4, s[4:7], s18 offen offset:256
    s_waitcnt vmcnt(0)
    v_pk_add_f32 v[8:9], v[8:9], v[10:11]
    v_pk_add_f32 v[12:13], v[12:13], v[14:15]
    v_pk_add_f32 v[8:9], v[8:9], v[12:13]
    v_add_u32 v4, 139264, v4
    ds_write_b32 v4, v8
    ds_write_b32 v4, v9 offset:256
    s_waitcnt lgkmcnt(0)
L_w_128:
    s_cmp_lg_u32 s8, 7
    s_cbranch_scc1 L_w_129
    s_and_b32 s19, s12, 1
    s_lshl_b32 s19, s19, 1
    s_lshl_b32 s23, s11, 5
    s_add_u32 s19, s19, s23
    v_lshrrev_b32 v4, 1, v1
    v_lshlrev_b32 v4, 2, v4
    v_and_b32 v5, 1, v1
    v_add3_u32 v4, v4, v5, s19
    s_mov_b32 s19, 5
    s_add_u32 s21, s9, s19
    s_lshl_b32 s20, s19, 15
    s_add_u32 s20, s20, 51380224
    v_lshlrev_b32 v4, 7, v4
    s_mov_b32 exec_lo, 0xffff
    s_mov_b32 exec_hi, 0x0
    s_mov_b32 s22, 0
L_poll_130:
    buffer_load_dword v5, v4, s[4:7], s20 offen sc1
    s_waitcnt vmcnt(0)
    v_cmp_ne_u32 vcc, s21, v5
    s_cmp_eq_u64 vcc, 0
    s_cbranch_scc1 L_polld_131
    s_sleep 1
    s_add_u32 s22, s22, 1
    s_cmp_lt_u32 s22, 262144
    s_cbranch_scc1 L_poll_130
L_polld_131:
    s_mov_b64 exec, -1
L_w_129:
    s_waitcnt vmcnt(0)
    s_barrier
    s_cmp_lt_u32 s8, 4
    s_cbranch_scc1 L_ga_comp_132
    s_lshl_b32 s15, s13, 2
    s_add_u32 s15, s15, s8
    s_sub_u32 s15, s15, 4
    s_lshl_b32 s19, s10, 20
    s_add_u32 s19, s19, 48234496
    v_lshrrev_b32 v8, 5, v1
    v_mul_u32_u24 v8, 262144, v8
    v_and_b32 v16, 31, v1
    v_lshl_add_u32 v8, v16, 3, v8
    s_lshl_b32 s18, s15, 8
    s_add_u32 s18, s18, s19
    buffer_load_dwordx2 v[16:17], v8, s[4:7], s18 offen
    s_add_u32 s18, s18, 16384
    buffer_load_dwordx2 v[18:19], v8, s[4:7], s18 offen
    s_add_u32 s18, s18, 16384
    buffer_load_dwordx2 v[20:21], v8, s[4:7], s18 offen
    s_add_u32 s18, s18, 16384
    buffer_load_dwordx2 v[22:23], v8, s[4:7], s18 offen
    s_add_u32 s18, s18, 16384
    buffer_load_dwordx2 v[24:25], v8, s[4:7], s18 offen
    s_add_u32 s18, s18, 16384
    buffer_load_dwordx2 v[26:27], v8, s[4:7], s18 offen
    s_add_u32 s18, s18, 16384
    buffer_load_dwordx2 v[28:29], v8, s[4:7], s18 offen
    s_add_u32 s18, s18, 16384
    buffer_load_dwordx2 v[30:31], v8, s[4:7], s18 offen
    s_add_u32 s18, s18, 16384
    buffer_load_dwordx2 v[32:33], v8, s[4:7], s18 offen
    s_add_u32 s18, s18, 16384
    buffer_load_dwordx2 v[34:35], v8, s[4:7], s18 offen
    s_add_u32 s18, s18, 16384
    buffer_load_dwordx2 v[36:37], v8, s[4:7], s18 offen
    s_add_u32 s18, s18, 16384
    buffer_load_dwordx2 v[38:39], v8, s[4:7], s18 offen
    s_add_u32 s18, s18, 16384
    buffer_load_dwordx2 v[40:41], v8, s[4:7], s18 offen
    s_add_u32 s18, s18, 16384
    buffer_load_dwordx2 v[42:43], v8, s[4:7], s18 offen
    s_add_u32 s18, s18, 16384
    buffer_load_dwordx2 v[44:45], v8, s[4:7], s18 offen
    s_add_u32 s18, s18, 16384
    buffer_load_dwordx2 v[46:47], v8, s[4:7], s18 offen
    s_waitcnt vmcnt(0)
    v_pk_add_f32 v[16:17], v[16:17], v[18:19]
    v_pk_add_f32 v[16:17], v[16:17], v[20:21]
    v_pk_add_f32 v[16:17], v[16:17], v[22:23]
    v_pk_add_f32 v[16:17], v[16:17], v[24:25]
    v_pk_add_f32 v[16:17], v[16:17], v[26:27]
    v_pk_add_f32 v[16:17], v[16:17], v[28:29]
    v_pk_add_f32 v[16:17], v[16:17], v[30:31]
    v_pk_add_f32 v[16:17], v[16:17], v[32:33]
    v_pk_add_f32 v[16:17], v[16:17], v[34:35]
    v_pk_add_f32 v[16:17], v[16:17], v[36:37]
    v_pk_add_f32 v[16:17], v[16:17], v[38:39]
    v_pk_add_f32 v[16:17], v[16:17], v[40:41]
    v_pk_add_f32 v[16:17], v[16:17], v[42:43]
    v_pk_add_f32 v[16:17], v[16:17], v[44:45]
    v_pk_add_f32 v[16:17], v[16:17], v[46:47]
    v_mov_b32 v18, v16
    v_mov_b32 v19, v17
    s_nop 1
    v_permlane32_swap_b32 v16, v18
    v_permlane32_swap_b32 v17, v19
    s_nop 1
    v_add_f32 v16, v16, v18
    v_add_f32 v17, v17, v19
    v_mul_f32 v10, 0xbb000000, v16
    v_mul_f32 v17, 0x3b000000, v17
    v_fma_f32 v17, -v10, v10, v17
    v_max_f32 v17, 0, v17
    v_add_f32 v17, 0x3727c5ac, v17
    v_rsq_f32 v11, v17
    s_nop 0
    s_sub_u32 s20, s8, 4
    s_lshl_b32 s20, s20, 8
    s_add_u32 s20, s20, 139776
    v_and_b32 v12, 31, v1
    v_lshlrev_b32 v12, 3, v12
    v_add_u32 v12, s20, v12
    ds_write_b64 v12, v[10:11]
    s_waitcnt lgkmcnt(0)
    s_barrier
    s_branch L_ga_end_133
L_ga_comp_132:
    s_setprio 2
    v_add_u32 v3, 0x10000, v2
    s_lshl_b32 s15, s13, 2
    s_add_u32 s15, s15, s8
    s_lshl_b32 s16, s10, 22
    s_lshl_b32 s17, s15, 15
    s_add_u32 s16, s16, s17
    buffer_load_dwordx4 v[16:19], v2, s[4:7], s16 offen offset:0
    buffer_load_dwordx4 v[20:23], v2, s[4:7], s16 offen offset:1024
    buffer_load_dwordx4 v[24:27], v2, s[4:7], s16 offen offset:2048
    buffer_load_dwordx4 v[28:31], v2, s[4:7], s16 offen offset:3072
    ds_read_b128 v[144:147], v2 offset:0
    ds_read_b128 v[148:151], v2 offset:32768
    ds_read_b128 v[152:155], v3 offset:0
    ds_read_b128 v[156:159], v2 offset:1024
    ds_read_b128 v[160:163], v2 offset:33792
    ds_read_b128 v[164:167], v3 offset:1024
    s_add_u32 s16, s16, 4096
    buffer_load_dwordx4 v[32:35], v2, s[4:7], s16 offen offset:0
    buffer_load_dwordx4 v[36:39], v2, s[4:7], s16 offen offset:1024
    buffer_load_dwordx4 v[40:43], v2, s[4:7], s16 offen offset:2048
    buffer_load_dwordx4 v[44:47], v2, s[4:7], s16 offen offset:3072
    s_add_u32 s16, s16, 4096
    buffer_load_dwordx4 v[48:51], v2, s[4:7], s16 offen offset:0
    s_waitcnt vmcnt(8) lgkmcnt(3)
    v_mfma_f32_32x32x16_bf16 v[80:95], v[144:147], v[16:19], 0
    ds_read_b128 v[168:171], v2 offset:2048
    v_mfma_f32_32x32x16_bf16 v[96:111], v[148:151], v[16:19], 0
    ds_read_b128 v[172:175], v2 offset:34816
    v_mfma_f32_32x32x16_bf16 v[112:127], v[152:155], v[16:19], 0
    ds_read_b128 v[176:179], v3 offset:2048
    s_waitcnt vmcnt(7) lgkmcnt(3)
    v_mfma_f32_32x32x16_bf16 v[80:95], v[156:159], v[20:23], v[80:95]
    ds_read_b128 v[144:147], v2 offset:3072
    v_mfma_f32_32x32x16_bf16 v[96:111], v[160:163], v[20:23], v[96:111]
    ds_read_b128 v[148:151], v2 offset:35840
    buffer_load_dwordx4 v[52:55], v2, s[4:7], s16 offen offset:1024
    v_mfma_f32_32x32x16_bf16 v[112:127], v[164:167], v[20:23], v[112:127]
    ds_read_b128 v[152:155], v3 offset:3072
    s_waitcnt vmcnt(7) lgkmcnt(3)
    v_mfma_f32_32x32x16_bf16 v[80:95], v[168:171], v[24:27], v[80:95]
    ds_read_b128 v[156:159], v2 offset:4096
    v_mfma_f32_32x32x16_bf16 v[96:111], v[172:175], v[24:27], v[96:111]
    ds_read_b128 v[160:163], v2 offset:36864
    buffer_load_dwordx4 v[56:59], v2, s[4:7], s16 offen offset:2048
    v_mfma_f32_32x32x16_bf16 v[112:127], v[176:179], v[24:27], v[112:127]
    ds_read_b128 v[164:167], v3 offset:4096
    s_waitcnt vmcnt(7) lgkmcnt(3)
    v_mfma_f32_32x32x16_bf16 v[80:95], v[144:147], v[28:31], v[80:95]
    ds_read_b128 v[168:171], v2 offset:5120
    v_mfma_f32_32x32x16_bf16 v[96:111], v[148:151], v[28:31], v[96:111]
    ds_read_b128 v[172:175], v2 offset:37888
    buffer_load_dwordx4 v[60:63], v2, s[4:7], s16 offen offset:3072
    v_mfma_f32_32x32x16_bf16 v[112:127], v[152:155], v[28:31], v[112:127]
    ds_read_b128 v[176:179], v3 offset:5120
    s_waitcnt vmcnt(7) lgkmcnt(3)
    v_mfma_f32_32x32x16_bf16 v[80:95], v[156:159], v[32:35], v[80:95]
    ds_read_b128 v[144:147], v2 offset:6144
    v_mfma_f32_32x32x16_bf16 v[96:111], v[160:163], v[32:35], v[96:111]
    ds_read_b128 v[148:151], v2 offset:38912
    s_add_u32 s16, s16, 4096
    buffer_load_dwordx4 v[64:67], v2, s[4:7], s16 offen offset:0
    v_mfma_f32_32x32x16_bf16 v[112:127], v[164:167], v[32:35], v[112:127]
    ds_read_b128 v[152:155], v3 offset:6144
    s_waitcnt vmcnt(7) lgkmcnt(3)
    v_mfma_f32_32x32x16_bf16 v[80:95], v[168:171], v[36:39], v[80:95]
    ds_read_b128 v[156:159], v2 offset:7168
    v_mfma_f32_32x32x16_bf16 v[96:111], v[172:175], v[36:39], v[96:111]
    ds_read_b128 v[160:163], v2 offset:39936
    buffer_load_dwordx4 v[68:71], v2, s[4:7], s16 offen offset:1024
    v_mfma_f32_32x32x16_bf16 v[112:127], v[176:179], v[36:39], v[112:127]
    ds_read_b128 v[164:167], v3 offset:7168
    s_waitcnt vmcnt(7) lgkmcnt(3)
    v_mfma_f32_32x32x16_bf16 v[80:95], v[144:147], v[40:43], v[80:95]
    ds_read_b128 v[168:171], v2 offset:8192
    v_mfma_f32_32x32x16_bf16 v[96:111], v[148:151], v[40:43], v[96:111]
    ds_read_b128 v[172:175], v2 offset:40960
    buffer_load_dwordx4 v[72:75], v2, s[4:7], s16 offen offset:2048
    v_mfma_f32_32x32x16_bf16 v[112:127], v[152:155], v[40:43], v[112:127]
    ds_read_b128 v[176:179], v3 offset:8192
    s_waitcnt vmcnt(7) lgkmcnt(3)
    v_mfma_f32_32x32x16_bf16 v[80:95], v[156:159], v[44:47], v[80:95]
    ds_read_b128 v[144:147], v2 offset:9216
    v_mfma_f32_32x32x16_bf16 v[96:111], v[160:163], v[44:47], v[96:111]
    ds_read_b128 v[148:151], v2 offset:41984
    buffer_load_dwordx4 v[76:79], v2, s[4:7], s16 offen offset:3072
    v_mfma_f32_32x32x16_bf16 v[112:127], v[164:167], v[44:47], v[112:127]
    ds_read_b128 v[152:155], v3 offset:9216
    s_waitcnt vmcnt(7) lgkmcnt(3)
    v_mfma_f32_32x32x16_bf16 v[80:95], v[168:171], v[48:51], v[80:95]
    ds_read_b128 v[156:159], v2 offset:10240
    v_mfma_f32_32x32x16_bf16 v[96:111], v[172:175], v[48:51], v[96:111]
    ds_read_b128 v[160:163], v2 offset:43008
    s_add_u32 s16, s16, 4096
    buffer_load_dwordx4 v[16:19], v2, s[4:7], s16 offen offset:0
    v_mfma_f32_32x32x16_bf16 v[112:127], v[176:179], v[48:51], v[112:127]
    ds_read_b128 v[164:167], v3 offset:10240
    s_waitcnt vmcnt(7) lgkmcnt(3)
    v_mfma_f32_32x32x16_bf16 v[80:95], v[144:147], v[52:55], v[80:95]
    ds_read_b128 v[168:171], v2 offset:11264
    v_mfma_f32_32x32x16_bf16 v[96:111], v[148:151], v[52:55], v[96:111]
    ds_read_b128 v[172:175], v2 offset:44032
    buffer_load_dwordx4 v[20:23], v2, s[4:7], s16 offen offset:1024
    v_mfma_f32_32x32x16_bf16 v[112:127], v[152:155], v[52:55], v[112:127]
    ds_read_b128 v[176:179], v3 offset:11264
    s_waitcnt vmcnt(7) lgkmcnt(3)
    v_mfma_f32_32x32x16_bf16 v[80:95], v[156:159], v[56:59], v[80:95]
    ds_read_b128 v[144:147], v2 offset:12288
    v_mfma_f32_32x32x16_bf16 v[96:111], v[160:163], v[56:59], v[96:111]
    ds_read_b128 v[148:151], v2 offset:45056
    buffer_load_dwordx4 v[24:27], v2, s[4:7], s16 offen offset:2048
    v_mfma_f32_32x32x16_bf16 v[112:127], v[164:167], v[56:59], v[112:127]
    ds_read_b128 v[152:155], v3 offset:12288
    s_waitcnt vmcnt(7) lgkmcnt(3)
    v_mfma_f32_32x32x16_bf16 v[80:95], v[168:171], v[60:63], v[80:95]
    ds_read_b128 v[156:159], v2 offset:13312
    v_mfma_f32_32x32x16_bf16 v[96:111], v[172:175], v[60:63], v[96:111]
    ds_read_b128 v[160:163], v2 offset:46080
    buffer_load_dwordx4 v[28:31], v2, s[4:7], s16 offen offset:3072
    v_mfma_f32_32x32x16_bf16 v[112:127], v[176:179], v[60:63], v[112:127]
    ds_read_b128 v[164:167], v3 offset:13312
    s_waitcnt vmcnt(7) lgkmcnt(3)
    v_mfma_f32_32x32x16_bf16 v[80:95], v[144:147], v[64:67], v[80:95]
    ds_read_b128 v[168:171], v2 offset:14336
    v_mfma_f32_32x32x16_bf16 v[96:111], v[148:151], v[64:67], v[96:111]
    ds_read_b128 v[172:175], v2 offset:47104
    s_add_u32 s16, s16, 4096
    buffer_load_dwordx4 v[32:35], v2, s[4:7], s16 offen offset:0
    v_mfma_f32_32x32x16_bf16 v[112:127], v[152:155], v[64:67], v[112:127]
    ds_read_b128 v[176:179], v3 offset:14336
    s_waitcnt vmcnt(7) lgkmcnt(3)
    v_mfma_f32_32x32x16_bf16 v[80:95], v[156:159], v[68:71], v[80:95]
    ds_read_b128 v[144:147], v2 offset:15360
    v_mfma_f32_32x32x16_bf16 v[96:111], v[160:163], v[68:71], v[96:111]
    ds_read_b128 v[148:151], v2 offset:48128
    buffer_load_dwordx4 v[36:39], v2, s[4:7], s16 offen offset:1024
    v_mfma_f32_32x32x16_bf16 v[112:127], v[164:167], v[68:71], v[112:127]
    ds_read_b128 v[152:155], v3 offset:15360
    s_waitcnt vmcnt(7) lgkmcnt(3)
    v_mfma_f32_32x32x16_bf16 v[80:95], v[168:171], v[72:75], v[80:95]
    ds_read_b128 v[156:159], v2 offset:16384
    v_mfma_f32_32x32x16_bf16 v[96:111], v[172:175], v[72:75], v[96:111]
    ds_read_b128 v[160:163], v2 offset:49152
    buffer_load_dwordx4 v[40:43], v2, s[4:7], s16 offen offset:2048
    v_mfma_f32_32x32x16_bf16 v[112:127], v[176:179], v[72:75], v[112:127]
    ds_read_b128 v[164:167], v3 offset:16384
    s_waitcnt vmcnt(7) lgkmcnt(3)
    v_mfma_f32_32x32x16_bf16 v[80:95], v[144:147], v[76:79], v[80:95]
    ds_read_b128 v[168:171], v2 offset:17408
    v_mfma_f32_32x32x16_bf16 v[96:111], v[148:151], v[76:79], v[96:111]
    ds_read_b128 v[172:175], v2 offset:50176
    buffer_load_dwordx4 v[44:47], v2, s[4:7], s16 offen offset:3072
    v_mfma_f32_32x32x16_bf16 v[112:127], v[152:155], v[76:79], v[112:127]
    ds_read_b128 v[176:179], v3 offset:17408
    s_waitcnt vmcnt(7) lgkmcnt(3)
    v_mfma_f32_32x32x16_bf16 v[80:95], v[156:159], v[16:19], v[80:95]
    ds_read_b128 v[144:147], v2 offset:18432
    v_mfma_f32_32x32x16_bf16 v[96:111], v[160:163], v[16:19], v[96:111]
    ds_read_b128 v[148:151], v2 offset:51200
    s_add_u32 s16, s16, 4096
    buffer_load_dwordx4 v[48:51], v2, s[4:7], s16 offen offset:0
    v_mfma_f32_32x32x16_bf16 v[112:127], v[164:167], v[16:19], v[112:127]
    ds_read_b128 v[152:155], v3 offset:18432
    s_waitcnt vmcnt(7) lgkmcnt(3)
    v_mfma_f32_32x32x16_bf16 v[80:95], v[168:171], v[20:23], v[80:95]
    ds_read_b128 v[156:159], v2 offset:19456
    v_mfma_f32_32x32x16_bf16 v[96:111], v[172:175], v[20:23], v[96:111]
    ds_read_b128 v[160:163], v2 offset:52224
    buffer_load_dwordx4 v[52:55], v2, s[4:7], s16 offen offset:1024
    v_mfma_f32_32x32x16_bf16 v[112:127], v[176:179], v[20:23], v[112:127]
    ds_read_b128 v[164:167], v3 offset:19456
    s_waitcnt vmcnt(7) lgkmcnt(3)
    v_mfma_f32_32x32x16_bf16 v[80:95], v[144:147], v[24:27], v[80:95]
    ds_read_b128 v[168:171], v2 offset:20480
    v_mfma_f32_32x32x16_bf16 v[96:111], v[148:151], v[24:27], v[96:111]
    ds_read_b128 v[172:175], v2 offset:53248
    buffer_load_dwordx4 v[56:59], v2, s[4:7], s16 offen offset:2048
    v_mfma_f32_32x32x16_bf16 v[112:127], v[152:155], v[24:27], v[112:127]
    ds_read_b128 v[176:179], v3 offset:20480
    s_waitcnt vmcnt(7) lgkmcnt(3)
    v_mfma_f32_32x32x16_bf16 v[80:95], v[156:159], v[28:31], v[80:95]
    ds_read_b128 v[144:147], v2 offset:21504
    v_mfma_f32_32x32x16_bf16 v[96:111], v[160:163], v[28:31], v[96:111]
    ds_read_b128 v[148:151], v2 offset:54272
    buffer_load_dwordx4 v[60:63], v2, s[4:7], s16 offen offset:3072
    v_mfma_f32_32x32x16_bf16 v[112:127], v[164:167], v[28:31], v[112:127]
    ds_read_b128 v[152:155], v3 offset:21504
    s_waitcnt vmcnt(7) lgkmcnt(3)
    v_mfma_f32_32x32x16_bf16 v[80:95], v[168:171], v[32:35], v[80:95]
    ds_read_b128 v[156:159], v2 offset:22528
    v_mfma_f32_32x32x16_bf16 v[96:111], v[172:175], v[32:35], v[96:111]
    ds_read_b128 v[160:163], v2 offset:55296
    s_add_u32 s16, s16, 4096
    buffer_load_dwordx4 v[64:67], v2, s[4:7], s16 offen offset:0
    v_mfma_f32_32x32x16_bf16 v[112:127], v[176:179], v[32:35], v[112:127]
    ds_read_b128 v[164:167], v3 offset:22528
    s_waitcnt vmcnt(7) lgkmcnt(3)
    v_mfma_f32_32x32x16_bf16 v[80:95], v[144:147], v[36:39], v[80:95]
    ds_read_b128 v[168:171], v2 offset:23552
    v_mfma_f32_32x32x16_bf16 v[96:111], v[148:151], v[36:39], v[96:111]
    ds_read_b128 v[172:175], v2 offset:56320
    buffer_load_dwordx4 v[68:71], v2, s[4:7], s16 offen offset:1024
    v_mfma_f32_32x32x16_bf16 v[112:127], v[152:155], v[36:39], v[112:127]
    ds_read_b128 v[176:179], v3 offset:23552
    s_waitcnt vmcnt(7) lgkmcnt(3)
    v_mfma_f32_32x32x16_bf16 v[80:95], v[156:159], v[40:43], v[80:95]
    ds_read_b128 v[144:147], v2 offset:24576
    v_mfma_f32_32x32x16_bf16 v[96:111], v[160:163], v[40:43], v[96:111]
    ds_read_b128 v[148:151], v2 offset:57344
    buffer_load_dwordx4 v[72:75], v2, s[4:7], s16 offen offset:2048
    v_mfma_f32_32x32x16_bf16 v[112:127], v[164:167], v[40:43], v[112:127]
    ds_read_b128 v[152:155], v3 offset:24576
    s_waitcnt vmcnt(7) lgkmcnt(3)
    v_mfma_f32_32x32x16_bf16 v[80:95], v[168:171], v[44:47], v[80:95]
    ds_read_b128 v[156:159], v2 offset:25600
    v_mfma_f32_32x32x16_bf16 v[96:111], v[172:175], v[44:47], v[96:111]
    ds_read_b128 v[160:163], v2 offset:58368
    buffer_load_dwordx4 v[76:79], v2, s[4:7], s16 offen offset:3072
    v_mfma_f32_32x32x16_bf16 v[112:127], v[176:179], v[44:47], v[112:127]
    ds_read_b128 v[164:167], v3 offset:25600
    s_waitcnt vmcnt(7) lgkmcnt(3)
    v_mfma_f32_32x32x16_bf16 v[80:95], v[144:147], v[48:51], v[80:95]
    ds_read_b128 v[168:171], v2 offset:26624
    v_mfma_f32_32x32x16_bf16 v[96:111], v[148:151], v[48:51], v[96:111]
    ds_read_b128 v[172:175], v2 offset:59392
    v_mfma_f32_32x32x16_bf16 v[112:127], v[152:155], v[48:51], v[112:127]
    ds_read_b128 v[176:179], v3 offset:26624
    s_barrier
    s_waitcnt vmcnt(6) lgkmcnt(3)
    v_mfma_f32_32x32x16_bf16 v[80:95], v[156:159], v[52:55], v[80:95]
    ds_read_b128 v[144:147], v2 offset:27648
    v_mfma_f32_32x32x16_bf16 v[96:111], v[160:163], v[52:55], v[96:111]
    ds_read_b128 v[148:151], v2 offset:60416
    v_mfma_f32_32x32x16_bf16 v[112:127], v[164:167], v[52:55], v[112:127]
    ds_read_b128 v[152:155], v3 offset:27648
    s_waitcnt vmcnt(5) lgkmcnt(3)
    v_mfma_f32_32x32x16_bf16 v[80:95], v[168:171], v[56:59], v[80:95]
    ds_read_b128 v[156:159], v2 offset:28672
    v_mfma_f32_32x32x16_bf16 v[96:111], v[172:175], v[56:59], v[96:111]
    ds_read_b128 v[160:163], v2 offset:61440
    v_mfma_f32_32x32x16_bf16 v[112:127], v[176:179], v[56:59], v[112:127]
    ds_read_b128 v[164:167], v3 offset:28672
    s_waitcnt vmcnt(4) lgkmcnt(3)
    v_mfma_f32_32x32x16_bf16 v[80:95], v[144:147], v[60:63], v[80:95]
    ds_read_b128 v[168:171], v2 offset:29696
    v_mfma_f32_32x32x16_bf16 v[96:111], v[148:151], v[60:63], v[96:111]
    ds_read_b128 v[172:175], v2 offset:62464
    v_mfma_f32_32x32x16_bf16 v[112:127], v[152:155], v[60:63], v[112:127]
    ds_read_b128 v[176:179], v3 offset:29696
    s_waitcnt vmcnt(3) lgkmcnt(3)
    v_mfma_f32_32x32x16_bf16 v[80:95], v[156:159], v[64:67], v[80:95]
    ds_read_b128 v[144:147], v2 offset:30720
    v_mfma_f32_32x32x16_bf16 v[96:111], v[160:163], v[64:67], v[96:111]
    ds_read_b128 v[148:151], v2 offset:63488
    v_mfma_f32_32x32x16_bf16 v[112:127], v[164:167], v[64:67], v[112:127]
    ds_read_b128 v[152:155], v3 offset:30720
    s_waitcnt vmcnt(2) lgkmcnt(3)
    v_mfma_f32_32x32x16_bf16 v[80:95], v[168:171], v[68:71], v[80:95]
    ds_read_b128 v[156:159], v2 offset:31744
    v_mfma_f32_32x32x16_bf16 v[96:111], v[172:175], v[68:71], v[96:111]
    ds_read_b128 v[160:163], v2 offset:64512
    v_mfma_f32_32x32x16_bf16 v[112:127], v[176:179], v[68:71], v[112:127]
    ds_read_b128 v[164:167], v3 offset:31744
    s_waitcnt vmcnt(1) lgkmcnt(3)
    v_mfma_f32_32x32x16_bf16 v[80:95], v[144:147], v[72:75], v[80:95]
    v_mfma_f32_32x32x16_bf16 v[96:111], v[148:151], v[72:75], v[96:111]
    v_mfma_f32_32x32x16_bf16 v[112:127], v[152:155], v[72:75], v[112:127]
    s_waitcnt vmcnt(0) lgkmcnt(0)
    v_mfma_f32_32x32x16_bf16 v[80:95], v[156:159], v[76:79], v[80:95]
    v_mfma_f32_32x32x16_bf16 v[96:111], v[160:163], v[76:79], v[96:111]
    v_mfma_f32_32x32x16_bf16 v[112:127], v[164:167], v[76:79], v[112:127]
    s_lshl_b32 s20, s8, 8
    s_add_u32 s20, s20, 139776
    v_and_b32 v8, 31, v1
    v_lshlrev_b32 v8, 3, v8
    v_add_u32 v8, s20, v8
    ds_read_b64 v[192:193], v8
    v_lshrrev_b32 v8, 5, v1
    v_lshlrev_b32 v8, 4, v8
    v_add_u32 v8, 139264, v8
    ds_read_b128 v[16:19], v8 offset:0
    ds_read_b128 v[20:23], v8 offset:32
    ds_read_b128 v[24:27], v8 offset:64
    ds_read_b128 v[28:31], v8 offset:96
    ds_read_b128 v[32:35], v8 offset:128
    ds_read_b128 v[36:39], v8 offset:160
    ds_read_b128 v[40:43], v8 offset:192
    ds_read_b128 v[44:47], v8 offset:224
    ds_read_b128 v[48:51], v8 offset:256
    ds_read_b128 v[52:55], v8 offset:288
    ds_read_b128 v[56:59], v8 offset:320
    s_waitcnt lgkmcnt(4)
    ds_read_b128 v[60:63], v8 offset:352
    s_mul_i32 s21, s14, 393216
    s_lshl_b32 s22, s15, 10
    s_add_u32 s21, s21, s22
    s_mul_i32 s22, s10, 6291456
    s_add_u32 s21, s21, s22
    s_add_u32 s21, s21, 14680064
    s_waitcnt lgkmcnt(0)
    v_mov_b32 v4, v192
    v_mov_b32 v6, v193
    s_nop 7
    s_mul_i32 s23, s14, 3
    s_add_u32 s23, s23, 0
    s_cmp_lt_u32 s23, 16
    s_cselect_b32 s24, 0x3eb8aa3b, 1.0
    v_mul_f32 v8, s24, v6
    v_pk_fma_f32 v[80:81], v[16:17], v[4:5], v[80:81] op_sel_hi:[1,0,1]
    v_pk_fma_f32 v[82:83], v[18:19], v[4:5], v[82:83] op_sel_hi:[1,0,1]
    v_pk_fma_f32 v[84:85], v[20:21], v[4:5], v[84:85] op_sel_hi:[1,0,1]
    v_pk_fma_f32 v[86:87], v[22:23], v[4:5], v[86:87] op_sel_hi:[1,0,1]
    v_pk_fma_f32 v[88:89], v[24:25], v[4:5], v[88:89] op_sel_hi:[1,0,1]
    v_pk_fma_f32 v[90:91], v[26:27], v[4:5], v[90:91] op_sel_hi:[1,0,1]
    v_pk_fma_f32 v[92:93], v[28:29], v[4:5], v[92:93] op_sel_hi:[1,0,1]
    v_pk_fma_f32 v[94:95], v[30:31], v[4:5], v[94:95] op_sel_hi:[1,0,1]
    v_pk_mul_f32 v[80:81], v[80:81], v[8:9] op_sel_hi:[1,0]
    v_pk_mul_f32 v[82:83], v[82:83], v[8:9] op_sel_hi:[1,0]
    v_pk_mul_f32 v[84:85], v[84:85], v[8:9] op_sel_hi:[1,0]
    v_pk_mul_f32 v[86:87], v[86:87], v[8:9] op_sel_hi:[1,0]
    v_pk_mul_f32 v[88:89], v[88:89], v[8:9] op_sel_hi:[1,0]
    v_pk_mul_f32 v[90:91], v[90:91], v[8:9] op_sel_hi:[1,0]
    v_pk_mul_f32 v[92:93], v[92:93], v[8:9] op_sel_hi:[1,0]
    v_pk_mul_f32 v[94:95], v[94:95], v[8:9] op_sel_hi:[1,0]
    v_cvt_pk_bf16_f32 v144, v80, v81
    v_cvt_pk_bf16_f32 v145, v82, v83
    v_cvt_pk_bf16_f32 v146, v84, v85
    v_cvt_pk_bf16_f32 v147, v86, v87
    v_cvt_pk_bf16_f32 v148, v88, v89
    v_cvt_pk_bf16_f32 v149, v90, v91
    v_cvt_pk_bf16_f32 v150, v92, v93
    v_cvt_pk_bf16_f32 v151, v94, v95
    s_add_u32 s23, s21, 0
    buffer_store_dwordx4 v[144:147], v2, s[4:7], s23 offen sc1
    s_add_u32 s23, s21, 65536
    buffer_store_dwordx4 v[148:151], v2, s[4:7], s23 offen sc1
    s_mul_i32 s23, s14, 3
    s_add_u32 s23, s23, 1
    s_cmp_lt_u32 s23, 16
    s_cselect_b32 s24, 0x3eb8aa3b, 1.0
    v_mul_f32 v8, s24, v6
    v_pk_fma_f32 v[96:97], v[32:33], v[4:5], v[96:97] op_sel_hi:[1,0,1]
    v_pk_fma_f32 v[98:99], v[34:35], v[4:5], v[98:99] op_sel_hi:[1,0,1]
    v_pk_fma_f32 v[100:101], v[36:37], v[4:5], v[100:101] op_sel_hi:[1,0,1]
    v_pk_fma_f32 v[102:103], v[38:39], v[4:5], v[102:103] op_sel_hi:[1,0,1]
    v_pk_fma_f32 v[104:105], v[40:41], v[4:5], v[104:105] op_sel_hi:[1,0,1]
    v_pk_fma_f32 v[106:107], v[42:43], v[4:5], v[106:107] op_sel_hi:[1,0,1]
    v_pk_fma_f32 v[108:109], v[44:45], v[4:5], v[108:109] op_sel_hi:[1,0,1]
    v_pk_fma_f32 v[110:111], v[46:47], v[4:5], v[110:111] op_sel_hi:[1,0,1]
    v_pk_mul_f32 v[96:97], v[96:97], v[8:9] op_sel_hi:[1,0]
    v_pk_mul_f32 v[98:99], v[98:99], v[8:9] op_sel_hi:[1,0]
    v_pk_mul_f32 v[100:101], v[100:101], v[8:9] op_sel_hi:[1,0]
    v_pk_mul_f32 v[102:103], v[102:103], v[8:9] op_sel_hi:[1,0]
    v_pk_mul_f32 v[104:105], v[104:105], v[8:9] op_sel_hi:[1,0]
    v_pk_mul_f32 v[106:107], v[106:107], v[8:9] op_sel_hi:[1,0]
    v_pk_mul_f32 v[108:109], v[108:109], v[8:9] op_sel_hi:[1,0]
    v_pk_mul_f32 v[110:111], v[110:111], v[8:9] op_sel_hi:[1,0]
    v_cvt_pk_bf16_f32 v152, v96, v97
    v_cvt_pk_bf16_f32 v153, v98, v99
    v_cvt_pk_bf16_f32 v154, v100, v101
    v_cvt_pk_bf16_f32 v155, v102, v103
    v_cvt_pk_bf16_f32 v156, v104, v105
    v_cvt_pk_bf16_f32 v157, v106, v107
    v_cvt_pk_bf16_f32 v158, v108, v109
    v_cvt_pk_bf16_f32 v159, v110, v111
    s_add_u32 s23, s21, 131072
    buffer_store_dwordx4 v[152:155], v2, s[4:7], s23 offen sc1
    s_add_u32 s23, s21, 196608
    buffer_store_dwordx4 v[156:159], v2, s[4:7], s23 offen sc1
    s_mul_i32 s23, s14, 3
    s_add_u32 s23, s23, 2
    s_cmp_lt_u32 s23, 16
    s_cselect_b32 s24, 0x3eb8aa3b, 1.0
    v_mul_f32 v8, s24, v6
    v_pk_fma_f32 v[112:113], v[48:49], v[4:5], v[112:113] op_sel_hi:[1,0,1]
    v_pk_fma_f32 v[114:115], v[50:51], v[4:5], v[114:115] op_sel_hi:[1,0,1]
    v_pk_fma_f32 v[116:117], v[52:53], v[4:5], v[116:117] op_sel_hi:[1,0,1]
    v_pk_fma_f32 v[118:119], v[54:55], v[4:5], v[118:119] op_sel_hi:[1,0,1]
    v_pk_fma_f32 v[120:121], v[56:57], v[4:5], v[120:121] op_sel_hi:[1,0,1]
    v_pk_fma_f32 v[122:123], v[58:59], v[4:5], v[122:123] op_sel_hi:[1,0,1]
    v_pk_fma_f32 v[124:125], v[60:61], v[4:5], v[124:125] op_sel_hi:[1,0,1]
    v_pk_fma_f32 v[126:127], v[62:63], v[4:5], v[126:127] op_sel_hi:[1,0,1]
    v_pk_mul_f32 v[112:113], v[112:113], v[8:9] op_sel_hi:[1,0]
    v_pk_mul_f32 v[114:115], v[114:115], v[8:9] op_sel_hi:[1,0]
    v_pk_mul_f32 v[116:117], v[116:117], v[8:9] op_sel_hi:[1,0]
    v_pk_mul_f32 v[118:119], v[118:119], v[8:9] op_sel_hi:[1,0]
    v_pk_mul_f32 v[120:121], v[120:121], v[8:9] op_sel_hi:[1,0]
    v_pk_mul_f32 v[122:123], v[122:123], v[8:9] op_sel_hi:[1,0]
    v_pk_mul_f32 v[124:125], v[124:125], v[8:9] op_sel_hi:[1,0]
    v_pk_mul_f32 v[126:127], v[126:127], v[8:9] op_sel_hi:[1,0]
    v_cvt_pk_bf16_f32 v160, v112, v113
    v_cvt_pk_bf16_f32 v161, v114, v115
    v_cvt_pk_bf16_f32 v162, v116, v117
    v_cvt_pk_bf16_f32 v163, v118, v119
    v_cvt_pk_bf16_f32 v164, v120, v121
    v_cvt_pk_bf16_f32 v165, v122, v123
    v_cvt_pk_bf16_f32 v166, v124, v125
    v_cvt_pk_bf16_f32 v167, v126, v127
    s_add_u32 s23, s21, 262144
    buffer_store_dwordx4 v[160:163], v2, s[4:7], s23 offen sc1
    s_add_u32 s23, s21, 327680
    buffer_store_dwordx4 v[164:167], v2, s[4:7], s23 offen sc1
    s_setprio 0
L_ga_end_133:
    s_mul_i32 s35, s10, 5
    s_add_u32 s35, s35, 1
    s_add_u32 s34, s9, s35
    s_lshl_b32 s35, s35, 8
    s_add_u32 s35, s35, s36
    s_lshl_b32 s35, s35, 7
    s_add_u32 s35, s35, 51380224
    s_waitcnt vmcnt(0)
    s_barrier
    s_cmp_lg_u32 s8, 7
    s_cbranch_scc1 L_sig_134
    v_mov_b32 v4, s34
    v_mov_b32 v5, 0
    s_mov_b64 exec, 1
    buffer_store_dword v4, v5, s[4:7], s35 offen sc1
    s_mov_b64 exec, -1
L_sig_134:
L_ga_skip_127:
L_att:
    s_lshl_b32 s13, s11, 2
    s_and_b32 s14, s12, 3
    s_add_u32 s13, s13, s14
    s_lshr_b32 s14, s12, 2
    v_and_b32 v5, 7, v0
    v_cmp_eq_u32 vcc, 0, v5
    v_mov_b32 v4, 0
    v_mov_b32 v6, 0x3f80
    v_cndmask_b32 v4, v4, v6, vcc
    v_mov_b32 v5, 0
    v_mov_b32 v6, 0
    v_mov_b32 v7, 0
    v_lshlrev_b32 v12, 4, v0
    v_add_u32 v12, 131072, v12
    v_cmp_gt_u32 vcc, 288, v0
    s_and_saveexec_b64 s[16:17], vcc
    ds_write_b128 v12, v[4:7]
    s_mov_b64 exec, -1
    s_cmp_lg_u32 s8, 7
    s_cbranch_scc1 L_w_135
    v_mov_b32 v4, 137216
    v_mov_b32 v6, 0
    v_mov_b32 v7, 0
    v_mov_b32 v8, 0
    v_mov_b32 v9, 0
    ds_write_b128 v4, v[6:9]
    ds_write_b128 v4, v[6:9] offset:16
    ds_write_b128 v4, v[6:9] offset:32
L_w_135:
    s_cmp_lg_u32 s8, 7
    s_cbranch_scc1 L_w_136
    s_lshr_b32 s16, s13, 1
    s_add_u32 s17, s16, 16
    s_mul_i32 s17, s17, 171
    s_lshr_b32 s17, s17, 9
    s_add_u32 s18, s16, 32
    s_mul_i32 s18, s18, 171
    s_lshr_b32 s18, s18, 9
    s_mul_i32 s19, s16, 171
    s_lshr_b32 s19, s19, 9
    v_mov_b32 v9, s17
    v_mov_b32 v10, s18
    v_cmp_le_u32 vcc, 2, v1
    s_nop 1
    v_cndmask_b32 v9, v9, v10, vcc
    v_mov_b32 v10, s19
    v_cmp_le_u32 vcc, 4, v1
    s_nop 1
    v_cndmask_b32 v9, v9, v10, vcc
    v_and_b32 v4, 1, v1
    v_lshl_add_u32 v4, v9, 1, v4
    s_lshl_b32 s19, s14, 5
    v_add_u32 v4, s19, v4
    s_mul_i32 s19, s10, 5
    s_add_u32 s19, s19, 1
    s_add_u32 s21, s9, s19
    s_lshl_b32 s20, s19, 15
    s_add_u32 s20, s20, 51380224
    v_lshlrev_b32 v4, 7, v4
    s_mov_b32 exec_lo, 0x3f
    s_mov_b32 exec_hi, 0x0
    s_mov_b32 s22, 0
L_poll_137:
    buffer_load_dword v5, v4, s[4:7], s20 offen sc1
    s_waitcnt vmcnt(0)
    v_cmp_ne_u32 vcc, s21, v5
    s_cmp_eq_u64 vcc, 0
    s_cbranch_scc1 L_polld_138
    s_sleep 1
    s_add_u32 s22, s22, 1
    s_cmp_lt_u32 s22, 262144
    s_cbranch_scc1 L_poll_137
L_polld_138:
    s_mov_b64 exec, -1
L_w_136:
    s_waitcnt lgkmcnt(0)
    s_barrier
    s_and_b32 s15, s8, 3
    s_lshr_b32 s16, s8, 2
    s_lshl_b32 s17, s14, 3
    s_lshl_b32 s18, s15, 1
    s_add_u32 s17, s17, s18
    s_mul_i32 s18, s10, 6291456
    s_add_u32 s18, s18, 14680064
    s_lshl_b32 s19, s13, 16
    s_add_u32 s18, s18, s19
    v_lshrrev_b32 v3, 1, v1
    v_and_b32 v4, 1, v1
    v_lshl_add_u32 v3, v4, 5, v3
    v_lshlrev_b32 v3, 4, v3
    s_lshl_b32 s20, s16, 5
    s_add_u32 s20, s20, s15
    s_lshl_b32 s20, s20, 10
    s_lshl_b32 s21, s16, 2
    s_add_u32 s21, s21, s15
    s_lshl_b32 s21, s21, 10
    s_add_u32 s21, s21, s18
    s_add_u32 s22, s21, 4194304
    s_add_u32 s21, s21, 2097152
    s_mov_b32 s44, s21
    s_mov_b32 s45, s22
    s_add_u32 s19, s14, 0
    s_and_b32 s19, s19, 7
    s_lshl_b32 s19, s19, 13
    s_add_u32 s19, s19, s21
    s_add_u32 m0, s20, 0
    s_nop 0
    buffer_load_dwordx4 v2, s[4:7], s19 offen lds
    s_add_u32 s19, s14, 0
    s_and_b32 s19, s19, 7
    s_lshl_b32 s19, s19, 13
    s_add_u32 s19, s19, s22
    s_add_u32 m0, s20, 65536
    s_nop 0
    buffer_load_dwordx4 v3, s[4:7], s19 offen lds
    s_lshl_b32 s19, s17, 10
    s_add_u32 s19, s19, s18
    buffer_load_dwordx4 v[8:11], v2, s[4:7], s19 offen
    buffer_load_dwordx4 v[12:15], v2, s[4:7], s19 offen offset:1024
    s_lshl_b32 s23, s16, 15
    v_add_u32 v16, s23, v2
    v_lshrrev_b32 v17, 5, v1
    v_lshlrev_b32 v17, 2, v17
    v_bfe_u32 v4, v1, 2, 2
    v_add_u32 v17, v17, v4
    v_lshlrev_b32 v17, 5, v17
    v_and_b32 v4, 1, v1
    v_lshl_add_u32 v17, v4, 4, v17
    v_bfe_u32 v4, v1, 1, 1
    v_lshl_add_u32 v17, v4, 3, v17
    v_mov_b32 v19, v17
    s_add_u32 s23, s23, 65536
    v_add_u32 v17, s23, v17
    v_lshrrev_b32 v4, 5, v1
    v_xor_b32 v4, 1, v4
    v_lshlrev_b32 v4, 7, v4
    v_add_u32 v4, 131072, v4
    v_bfe_u32 v5, v1, 1, 1
    v_lshl_add_u32 v4, v5, 4, v4
    v_bfe_u32 v5, v1, 4, 1
    v_cmp_eq_u32 vcc, 1, v5
    v_mov_b32 v18, 4096
    v_mov_b32 v6, 0
    v_add_u32 v19, 65536, v19
    v_cndmask_b32 v17, v17, v4, vcc
    v_cndmask_b32 v18, v18, v6, vcc
    v_cndmask_b32 v19, v19, v4, vcc
    v_mov_b32 v76, 0
    v_mov_b32 v77, 0
    v_mov_b32 v78, 0
    v_mov_b32 v79, 0
    v_mov_b32 v80, 0
    v_mov_b32 v81, 0
    v_mov_b32 v82, 0
    v_mov_b32 v83, 0
    v_mov_b32 v84, 0
    v_mov_b32 v85, 0
    v_mov_b32 v86, 0
    v_mov_b32 v87, 0
    v_mov_b32 v88, 0
    v_mov_b32 v89, 0
    v_mov_b32 v90, 0
    v_mov_b32 v91, 0
    v_mov_b32 v92, 0
    v_mov_b32 v93, 0
    v_mov_b32 v94, 0
    v_mov_b32 v95, 0
    v_mov_b32 v96, 0
    v_mov_b32 v97, 0
    v_mov_b32 v98, 0
    v_mov_b32 v99, 0
    v_mov_b32 v100, 0
    v_mov_b32 v101, 0
    v_mov_b32 v102, 0
    v_mov_b32 v103, 0
    v_mov_b32 v104, 0
    v_mov_b32 v105, 0
    v_mov_b32 v106, 0
    v_mov_b32 v107, 0
    v_mov_b32 v68, 0
    v_mov_b32 v116, 0
    v_mov_b32 v69, 0
    v_mov_b32 v117, 0
    v_mov_b32 v70, 0
    v_mov_b32 v118, 0
    v_mov_b32 v71, 0
    v_mov_b32 v119, 0
    v_mov_b32 v72, 0
    v_mov_b32 v120, 0
    v_mov_b32 v73, 0
    v_mov_b32 v121, 0
    v_mov_b32 v74, 0
    v_mov_b32 v122, 0
    v_mov_b32 v75, 0
    v_mov_b32 v123, 0
    s_cmp_lg_u32 s8, 7
    s_cbranch_scc1 L_w_139
    s_mov_b32 s46, s16
    s_mov_b32 s47, s17
    s_mov_b32 s43, s18
    s_mov_b32 s42, s20
    s_mov_b32 s41, s21
    s_mov_b32 s40, s22
    s_lshr_b32 s16, s13, 1
    s_add_u32 s17, s16, 16
    s_mul_i32 s17, s17, 171
    s_lshr_b32 s17, s17, 9
    s_add_u32 s18, s16, 32
    s_mul_i32 s18, s18, 171
    s_lshr_b32 s18, s18, 9
    s_mul_i32 s19, s16, 171
    s_lshr_b32 s19, s19, 9
    v_bfe_u32 v5, v1, 1, 3
    v_mov_b32 v6, s17
    v_mov_b32 v7, s18
    v_cmp_le_u32 vcc, 16, v1
    s_nop 1
    v_cndmask_b32 v6, v6, v7, vcc
    v_and_b32 v4, 1, v1
    v_lshl_add_u32 v4, v6, 1, v4
    v_lshl_add_u32 v4, v5, 5, v4
    s_mul_i32 s19, s10, 5
    s_add_u32 s19, s19, 1
    s_add_u32 s21, s9, s19
    s_lshl_b32 s20, s19, 15
    s_add_u32 s20, s20, 51380224
    v_lshlrev_b32 v4, 7, v4
    s_mov_b32 exec_lo, 0xffffffff
    s_mov_b32 exec_hi, 0x0
    s_mov_b32 s22, 0
L_poll_140:
    buffer_load_dword v5, v4, s[4:7], s20 offen sc1
    s_waitcnt vmcnt(0)
    v_cmp_ne_u32 vcc, s21, v5
    s_cmp_eq_u64 vcc, 0
    s_cbranch_scc1 L_polld_141
    s_sleep 1
    s_add_u32 s22, s22, 1
    s_cmp_lt_u32 s22, 262144
    s_cbranch_scc1 L_poll_140
L_polld_141:
    s_mov_b64 exec, -1
    s_mov_b32 s16, s46
    s_mov_b32 s17, s47
    s_mov_b32 s18, s43
    s_mov_b32 s20, s42
    s_mov_b32 s21, s41
    s_mov_b32 s22, s40
L_w_139:
    s_waitcnt vmcnt(0)
    s_barrier
    s_cmp_lg_u32 s8, 7
    s_cbranch_scc1 L_w_142
    s_cmp_lg_u32 s10, 0
    s_cbranch_scc1 L_rpf_143
    s_add_u32 s23, s9, 11
    s_lshl_b32 s24, s2, 7
    s_add_u32 s24, s24, 51740672
    v_mov_b32 v4, s23
    v_mov_b32 v5, 0
    s_mov_b64 exec, 1
    buffer_store_dword v4, v5, s[4:7], s24 offen sc1
    s_mov_b64 exec, -1
L_rpf_143:
L_w_142:
    ds_read_b128 v[20:23], v16 offset:0
    s_waitcnt lgkmcnt(0)
    v_mfma_f32_32x32x16_bf16 v[28:43], v[20:23], v[8:11], 0
    s_nop 7
    s_nop 7
    s_setprio 3
    v_mfma_f32_32x32x16_bf16 v[44:59], v[20:23], v[12:15], 0
    ds_read_b128 v[24:27], v16 offset:1024
    ds_read_b64_tr_b16 v[108:109], v17 offset:0
    ds_read_b64_tr_b16 v[110:111], v17 offset:256
    ds_read_b64_tr_b16 v[112:113], v17 offset:512
    ds_read_b64_tr_b16 v[114:115], v17 offset:768
    s_add_u32 s19, s14, 1
    s_and_b32 s19, s19, 7
    s_lshl_b32 s19, s19, 13
    s_add_u32 s19, s19, s21
    s_add_u32 m0, s20, 4096
    s_nop 0
    buffer_load_dwordx4 v2, s[4:7], s19 offen lds
    v_exp_f32 v28, v28
    v_exp_f32 v29, v29
    v_exp_f32 v30, v30
    v_exp_f32 v31, v31
    v_exp_f32 v32, v32
    v_exp_f32 v33, v33
    v_exp_f32 v34, v34
    v_exp_f32 v35, v35
    v_mfma_f32_32x32x16_bf16 v[92:107], v[116:119], v[68:71], v[92:107]
    v_cvt_pk_bf16_f32 v60, v28, v29
    v_cvt_pk_bf16_f32 v61, v30, v31
    v_cvt_pk_bf16_f32 v62, v32, v33
    v_cvt_pk_bf16_f32 v63, v34, v35
    v_exp_f32 v36, v36
    v_exp_f32 v37, v37
    v_exp_f32 v38, v38
    v_exp_f32 v39, v39
    v_mfma_f32_32x32x16_bf16 v[92:107], v[120:123], v[72:75], v[92:107]
    v_exp_f32 v40, v40
    v_exp_f32 v41, v41
    v_exp_f32 v42, v42
    v_exp_f32 v43, v43
    v_cvt_pk_bf16_f32 v64, v36, v37
    v_cvt_pk_bf16_f32 v65, v38, v39
    v_cvt_pk_bf16_f32 v66, v40, v41
    v_cvt_pk_bf16_f32 v67, v42, v43
    s_waitcnt lgkmcnt(0)
    v_mfma_f32_32x32x16_bf16 v[28:43], v[24:27], v[8:11], 0
    s_add_u32 s19, s14, 1
    s_and_b32 s19, s19, 7
    s_lshl_b32 s19, s19, 13
    s_add_u32 s19, s19, s22
    s_add_u32 m0, s20, 69632
    s_nop 0
    buffer_load_dwordx4 v3, s[4:7], s19 offen lds
    v_exp_f32 v44, v44
    v_exp_f32 v45, v45
    v_exp_f32 v46, v46
    v_exp_f32 v47, v47
    v_exp_f32 v48, v48
    v_exp_f32 v49, v49
    v_exp_f32 v50, v50
    v_exp_f32 v51, v51
    v_mfma_f32_32x32x16_bf16 v[76:91], v[108:111], v[60:63], v[76:91]
    v_cvt_pk_bf16_f32 v68, v44, v45
    v_cvt_pk_bf16_f32 v69, v46, v47
    v_cvt_pk_bf16_f32 v70, v48, v49
    v_cvt_pk_bf16_f32 v71, v50, v51
    v_exp_f32 v52, v52
    v_exp_f32 v53, v53
    v_exp_f32 v54, v54
    v_exp_f32 v55, v55
    v_mfma_f32_32x32x16_bf16 v[76:91], v[112:115], v[64:67], v[76:91]
    v_exp_f32 v56, v56
    v_exp_f32 v57, v57
    v_exp_f32 v58, v58
    v_exp_f32 v59, v59
    v_cvt_pk_bf16_f32 v72, v52, v53
    v_cvt_pk_bf16_f32 v73, v54, v55
    v_cvt_pk_bf16_f32 v74, v56, v57
    v_cvt_pk_bf16_f32 v75, v58, v59
    v_mfma_f32_32x32x16_bf16 v[44:59], v[24:27], v[12:15], 0
    ds_read_b128 v[20:23], v16 offset:2048
    ds_read_b64_tr_b16 v[116:117], v17 offset:1024
    ds_read_b64_tr_b16 v[118:119], v17 offset:1280
    ds_read_b64_tr_b16 v[120:121], v17 offset:1536
    ds_read_b64_tr_b16 v[122:123], v17 offset:1792
    s_add_u32 s19, s14, 2
    s_and_b32 s19, s19, 7
    s_lshl_b32 s19, s19, 13
    s_add_u32 s19, s19, s21
    s_add_u32 m0, s20, 8192
    s_nop 0
    buffer_load_dwordx4 v2, s[4:7], s19 offen lds
    v_exp_f32 v28, v28
    v_exp_f32 v29, v29
    v_exp_f32 v30, v30
    v_exp_f32 v31, v31
    v_exp_f32 v32, v32
    v_exp_f32 v33, v33
    v_exp_f32 v34, v34
    v_exp_f32 v35, v35
    v_mfma_f32_32x32x16_bf16 v[92:107], v[108:111], v[68:71], v[92:107]
    v_cvt_pk_bf16_f32 v60, v28, v29
    v_cvt_pk_bf16_f32 v61, v30, v31
    v_cvt_pk_bf16_f32 v62, v32, v33
    v_cvt_pk_bf16_f32 v63, v34, v35
    v_exp_f32 v36, v36
    v_exp_f32 v37, v37
    v_exp_f32 v38, v38
    v_exp_f32 v39, v39
    v_mfma_f32_32x32x16_bf16 v[92:107], v[112:115], v[72:75], v[92:107]
    v_exp_f32 v40, v40
    v_exp_f32 v41, v41
    v_exp_f32 v42, v42
    v_exp_f32 v43, v43
    v_cvt_pk_bf16_f32 v64, v36, v37
    v_cvt_pk_bf16_f32 v65, v38, v39
    v_cvt_pk_bf16_f32 v66, v40, v41
    v_cvt_pk_bf16_f32 v67, v42, v43
    s_waitcnt lgkmcnt(0)
    v_mfma_f32_32x32x16_bf16 v[28:43], v[20:23], v[8:11], 0
    s_add_u32 s19, s14, 2
    s_and_b32 s19, s19, 7
    s_lshl_b32 s19, s19, 13
    s_add_u32 s19, s19, s22
    s_add_u32 m0, s20, 73728
    s_nop 0
    buffer_load_dwordx4 v3, s[4:7], s19 offen lds
    v_exp_f32 v44, v44
    v_exp_f32 v45, v45
    v_exp_f32 v46, v46
    v_exp_f32 v47, v47
    v_exp_f32 v48, v48
    v_exp_f32 v49, v49
    v_exp_f32 v50, v50
    v_exp_f32 v51, v51
    v_mfma_f32_32x32x16_bf16 v[76:91], v[116:119], v[60:63], v[76:91]
    v_cvt_pk_bf16_f32 v68, v44, v45
    v_cvt_pk_bf16_f32 v69, v46, v47
    v_cvt_pk_bf16_f32 v70, v48, v49
    v_cvt_pk_bf16_f32 v71, v50, v51
    v_exp_f32 v52, v52
    v_exp_f32 v53, v53
    v_exp_f32 v54, v54
    v_exp_f32 v55, v55
    v_mfma_f32_32x32x16_bf16 v[76:91], v[120:123], v[64:67], v[76:91]
    v_exp_f32 v56, v56
    v_exp_f32 v57, v57
    v_exp_f32 v58, v58
    v_exp_f32 v59, v59
    v_cvt_pk_bf16_f32 v72, v52, v53
    v_cvt_pk_bf16_f32 v73, v54, v55
    v_cvt_pk_bf16_f32 v74, v56, v57
    v_cvt_pk_bf16_f32 v75, v58, v59
    v_mfma_f32_32x32x16_bf16 v[44:59], v[20:23], v[12:15], 0
    ds_read_b128 v[24:27], v16 offset:3072
    ds_read_b64_tr_b16 v[108:109], v17 offset:2048
    ds_read_b64_tr_b16 v[110:111], v17 offset:2304
    ds_read_b64_tr_b16 v[112:113], v17 offset:2560
    ds_read_b64_tr_b16 v[114:115], v17 offset:2816
    s_add_u32 s19, s14, 3
    s_and_b32 s19, s19, 7
    s_lshl_b32 s19, s19, 13
    s_add_u32 s19, s19, s21
    s_add_u32 m0, s20, 12288
    s_nop 0
    buffer_load_dwordx4 v2, s[4:7], s19 offen lds
    v_exp_f32 v28, v28
    v_exp_f32 v29, v29
    v_exp_f32 v30, v30
    v_exp_f32 v31, v31
    v_exp_f32 v32, v32
    v_exp_f32 v33, v33
    v_exp_f32 v34, v34
    v_exp_f32 v35, v35
    v_mfma_f32_32x32x16_bf16 v[92:107], v[116:119], v[68:71], v[92:107]
    v_cvt_pk_bf16_f32 v60, v28, v29
    v_cvt_pk_bf16_f32 v61, v30, v31
    v_cvt_pk_bf16_f32 v62, v32, v33
    v_cvt_pk_bf16_f32 v63, v34, v35
    v_exp_f32 v36, v36
    v_exp_f32 v37, v37
    v_exp_f32 v38, v38
    v_exp_f32 v39, v39
    v_mfma_f32_32x32x16_bf16 v[92:107], v[120:123], v[72:75], v[92:107]
    v_exp_f32 v40, v40
    v_exp_f32 v41, v41
    v_exp_f32 v42, v42
    v_exp_f32 v43, v43
    v_cvt_pk_bf16_f32 v64, v36, v37
    v_cvt_pk_bf16_f32 v65, v38, v39
    v_cvt_pk_bf16_f32 v66, v40, v41
    v_cvt_pk_bf16_f32 v67, v42, v43
    s_waitcnt lgkmcnt(0)
    v_mfma_f32_32x32x16_bf16 v[28:43], v[24:27], v[8:11], 0
    s_add_u32 s19, s14, 3
    s_and_b32 s19, s19, 7
    s_lshl_b32 s19, s19, 13
    s_add_u32 s19, s19, s22
    s_add_u32 m0, s20, 77824
    s_nop 0
    buffer_load_dwordx4 v3, s[4:7], s19 offen lds
    v_exp_f32 v44, v44
    v_exp_f32 v45, v45
    v_exp_f32 v46, v46
    v_exp_f32 v47, v47
    v_exp_f32 v48, v48
    v_exp_f32 v49, v49
    v_exp_f32 v50, v50
    v_exp_f32 v51, v51
    v_mfma_f32_32x32x16_bf16 v[76:91], v[108:111], v[60:63], v[76:91]
    v_cvt_pk_bf16_f32 v68, v44, v45
    v_cvt_pk_bf16_f32 v69, v46, v47
    v_cvt_pk_bf16_f32 v70, v48, v49
    v_cvt_pk_bf16_f32 v71, v50, v51
    v_exp_f32 v52, v52
    v_exp_f32 v53, v53
    v_exp_f32 v54, v54
    v_exp_f32 v55, v55
    v_mfma_f32_32x32x16_bf16 v[76:91], v[112:115], v[64:67], v[76:91]
    v_exp_f32 v56, v56
    v_exp_f32 v57, v57
    v_exp_f32 v58, v58
    v_exp_f32 v59, v59
    v_cvt_pk_bf16_f32 v72, v52, v53
    v_cvt_pk_bf16_f32 v73, v54, v55
    v_cvt_pk_bf16_f32 v74, v56, v57
    v_cvt_pk_bf16_f32 v75, v58, v59
    s_waitcnt vmcnt(2)
    s_barrier
    s_lshl_b32 s23, s10, 3
    s_add_u32 s23, s23, s8
    s_cmp_eq_u32 s23, 7
    s_cselect_b32 exec_lo, -1, 1
    s_cselect_b32 exec_hi, -1, 0
    v_lshlrev_b32 v4, 7, v1
    s_mov_b32 s23, 51740672
    buffer_load_dword v5, v4, s[4:7], s23 offen sc1
    s_mov_b32 s23, 51748864
    buffer_load_dword v6, v4, s[4:7], s23 offen sc1
    s_mov_b32 s23, 51757056
    buffer_load_dword v7, v4, s[4:7], s23 offen sc1
    s_mov_b64 exec, -1
    v_mfma_f32_32x32x16_bf16 v[44:59], v[24:27], v[12:15], 0
    ds_read_b128 v[20:23], v16 offset:4096
    ds_read_b64_tr_b16 v[116:117], v17 offset:3072
    ds_read_b64_tr_b16 v[118:119], v17 offset:3328
    ds_read_b64_tr_b16 v[120:121], v17 offset:3584
    ds_read_b64_tr_b16 v[122:123], v17 offset:3840
    s_add_u32 s19, s14, 4
    s_and_b32 s19, s19, 7
    s_lshl_b32 s19, s19, 13
    s_add_u32 s19, s19, s21
    s_add_u32 m0, s20, 16384
    s_nop 0
    buffer_load_dwordx4 v2, s[4:7], s19 offen lds
    v_exp_f32 v28, v28
    v_exp_f32 v29, v29
    v_exp_f32 v30, v30
    v_exp_f32 v31, v31
    v_exp_f32 v32, v32
    v_exp_f32 v33, v33
    v_exp_f32 v34, v34
    v_exp_f32 v35, v35
    v_mfma_f32_32x32x16_bf16 v[92:107], v[108:111], v[68:71], v[92:107]
    v_cvt_pk_bf16_f32 v60, v28, v29
    v_cvt_pk_bf16_f32 v61, v30, v31
    v_cvt_pk_bf16_f32 v62, v32, v33
    v_cvt_pk_bf16_f32 v63, v34, v35
    v_exp_f32 v36, v36
    v_exp_f32 v37, v37
    v_exp_f32 v38, v38
    v_exp_f32 v39, v39
    v_mfma_f32_32x32x16_bf16 v[92:107], v[112:115], v[72:75], v[92:107]
    v_exp_f32 v40, v40
    v_exp_f32 v41, v41
    v_exp_f32 v42, v42
    v_exp_f32 v43, v43
    v_cvt_pk_bf16_f32 v64, v36, v37
    v_cvt_pk_bf16_f32 v65, v38, v39
    v_cvt_pk_bf16_f32 v66, v40, v41
    v_cvt_pk_bf16_f32 v67, v42, v43
    s_waitcnt lgkmcnt(0)
    v_mfma_f32_32x32x16_bf16 v[28:43], v[20:23], v[8:11], 0
    s_add_u32 s19, s14, 4
    s_and_b32 s19, s19, 7
    s_lshl_b32 s19, s19, 13
    s_add_u32 s19, s19, s22
    s_add_u32 m0, s20, 81920
    s_nop 0
    buffer_load_dwordx4 v3, s[4:7], s19 offen lds
    v_exp_f32 v44, v44
    v_exp_f32 v45, v45
    v_exp_f32 v46, v46
    v_exp_f32 v47, v47
    v_exp_f32 v48, v48
    v_exp_f32 v49, v49
    v_exp_f32 v50, v50
    v_exp_f32 v51, v51
    v_mfma_f32_32x32x16_bf16 v[76:91], v[116:119], v[60:63], v[76:91]
    v_cvt_pk_bf16_f32 v68, v44, v45
    v_cvt_pk_bf16_f32 v69, v46, v47
    v_cvt_pk_bf16_f32 v70, v48, v49
    v_cvt_pk_bf16_f32 v71, v50, v51
    v_exp_f32 v52, v52
    v_exp_f32 v53, v53
    v_exp_f32 v54, v54
    v_exp_f32 v55, v55
    v_mfma_f32_32x32x16_bf16 v[76:91], v[120:123], v[64:67], v[76:91]
    v_exp_f32 v56, v56
    v_exp_f32 v57, v57
    v_exp_f32 v58, v58
    v_exp_f32 v59, v59
    v_cvt_pk_bf16_f32 v72, v52, v53
    v_cvt_pk_bf16_f32 v73, v54, v55
    v_cvt_pk_bf16_f32 v74, v56, v57
    v_cvt_pk_bf16_f32 v75, v58, v59
    v_add_u32 v16, 4096, v16
    v_add_u32 v17, v17, v18
    v_mfma_f32_32x32x16_bf16 v[44:59], v[20:23], v[12:15], 0
    ds_read_b128 v[24:27], v16 offset:1024
    ds_read_b64_tr_b16 v[108:109], v17 offset:0
    ds_read_b64_tr_b16 v[110:111], v17 offset:256
    ds_read_b64_tr_b16 v[112:113], v17 offset:512
    ds_read_b64_tr_b16 v[114:115], v17 offset:768
    s_add_u32 s19, s14, 5
    s_and_b32 s19, s19, 7
    s_lshl_b32 s19, s19, 13
    s_add_u32 s19, s19, s21
    s_add_u32 m0, s20, 20480
    s_nop 0
    buffer_load_dwordx4 v2, s[4:7], s19 offen lds
    v_exp_f32 v28, v28
    v_exp_f32 v29, v29
    v_exp_f32 v30, v30
    v_exp_f32 v31, v31
    v_exp_f32 v32, v32
    v_exp_f32 v33, v33
    v_exp_f32 v34, v34
    v_exp_f32 v35, v35
    v_mfma_f32_32x32x16_bf16 v[92:107], v[116:119], v[68:71], v[92:107]
    v_cvt_pk_bf16_f32 v60, v28, v29
    v_cvt_pk_bf16_f32 v61, v30, v31
    v_cvt_pk_bf16_f32 v62, v32, v33
    v_cvt_pk_bf16_f32 v63, v34, v35
    v_exp_f32 v36, v36
    v_exp_f32 v37, v37
    v_exp_f32 v38, v38
    v_exp_f32 v39, v39
    v_mfma_f32_32x32x16_bf16 v[92:107], v[120:123], v[72:75], v[92:107]
    v_exp_f32 v40, v40
    v_exp_f32 v41, v41
    v_exp_f32 v42, v42
    v_exp_f32 v43, v43
    v_cvt_pk_bf16_f32 v64, v36, v37
    v_cvt_pk_bf16_f32 v65, v38, v39
    v_cvt_pk_bf16_f32 v66, v40, v41
    v_cvt_pk_bf16_f32 v67, v42, v43
    s_waitcnt lgkmcnt(0)
    v_mfma_f32_32x32x16_bf16 v[28:43], v[24:27], v[8:11], 0
    s_add_u32 s19, s14, 5
    s_and_b32 s19, s19, 7
    s_lshl_b32 s19, s19, 13
    s_add_u32 s19, s19, s22
    s_add_u32 m0, s20, 86016
    s_nop 0
    buffer_load_dwordx4 v3, s[4:7], s19 offen lds
    v_exp_f32 v44, v44
    v_exp_f32 v45, v45
    v_exp_f32 v46, v46
    v_exp_f32 v47, v47
    v_exp_f32 v48, v48
    v_exp_f32 v49, v49
    v_exp_f32 v50, v50
    v_exp_f32 v51, v51
    v_mfma_f32_32x32x16_bf16 v[76:91], v[108:111], v[60:63], v[76:91]
    v_cvt_pk_bf16_f32 v68, v44, v45
    v_cvt_pk_bf16_f32 v69, v46, v47
    v_cvt_pk_bf16_f32 v70, v48, v49
    v_cvt_pk_bf16_f32 v71, v50, v51
    v_exp_f32 v52, v52
    v_exp_f32 v53, v53
    v_exp_f32 v54, v54
    v_exp_f32 v55, v55
    v_mfma_f32_32x32x16_bf16 v[76:91], v[112:115], v[64:67], v[76:91]
    v_exp_f32 v56, v56
    v_exp_f32 v57, v57
    v_exp_f32 v58, v58
    v_exp_f32 v59, v59
    v_cvt_pk_bf16_f32 v72, v52, v53
    v_cvt_pk_bf16_f32 v73, v54, v55
    v_cvt_pk_bf16_f32 v74, v56, v57
    v_cvt_pk_bf16_f32 v75, v58, v59
    v_mfma_f32_32x32x16_bf16 v[44:59], v[24:27], v[12:15], 0
    ds_read_b128 v[20:23], v16 offset:2048
    ds_read_b64_tr_b16 v[116:117], v17 offset:1024
    ds_read_b64_tr_b16 v[118:119], v17 offset:1280
    ds_read_b64_tr_b16 v[120:121], v17 offset:1536
    ds_read_b64_tr_b16 v[122:123], v17 offset:1792
    s_add_u32 s19, s14, 6
    s_and_b32 s19, s19, 7
    s_lshl_b32 s19, s19, 13
    s_add_u32 s19, s19, s21
    s_add_u32 m0, s20, 24576
    s_nop 0
    buffer_load_dwordx4 v2, s[4:7], s19 offen lds
    v_exp_f32 v28, v28
    v_exp_f32 v29, v29
    v_exp_f32 v30, v30
    v_exp_f32 v31, v31
    v_exp_f32 v32, v32
    v_exp_f32 v33, v33
    v_exp_f32 v34, v34
    v_exp_f32 v35, v35
    v_mfma_f32_32x32x16_bf16 v[92:107], v[108:111], v[68:71], v[92:107]
    v_cvt_pk_bf16_f32 v60, v28, v29
    v_cvt_pk_bf16_f32 v61, v30, v31
    v_cvt_pk_bf16_f32 v62, v32, v33
    v_cvt_pk_bf16_f32 v63, v34, v35
    v_exp_f32 v36, v36
    v_exp_f32 v37, v37
    v_exp_f32 v38, v38
    v_exp_f32 v39, v39
    v_mfma_f32_32x32x16_bf16 v[92:107], v[112:115], v[72:75], v[92:107]
    v_exp_f32 v40, v40
    v_exp_f32 v41, v41
    v_exp_f32 v42, v42
    v_exp_f32 v43, v43
    v_cvt_pk_bf16_f32 v64, v36, v37
    v_cvt_pk_bf16_f32 v65, v38, v39
    v_cvt_pk_bf16_f32 v66, v40, v41
    v_cvt_pk_bf16_f32 v67, v42, v43
    s_waitcnt lgkmcnt(0)
    v_mfma_f32_32x32x16_bf16 v[28:43], v[20:23], v[8:11], 0
    s_add_u32 s19, s14, 6
    s_and_b32 s19, s19, 7
    s_lshl_b32 s19, s19, 13
    s_add_u32 s19, s19, s22
    s_add_u32 m0, s20, 90112
    s_nop 0
    buffer_load_dwordx4 v3, s[4:7], s19 offen lds
    v_exp_f32 v44, v44
    v_exp_f32 v45, v45
    v_exp_f32 v46, v46
    v_exp_f32 v47, v47
    v_exp_f32 v48, v48
    v_exp_f32 v49, v49
    v_exp_f32 v50, v50
    v_exp_f32 v51, v51
    v_mfma_f32_32x32x16_bf16 v[76:91], v[116:119], v[60:63], v[76:91]
    v_cvt_pk_bf16_f32 v68, v44, v45
    v_cvt_pk_bf16_f32 v69, v46, v47
    v_cvt_pk_bf16_f32 v70, v48, v49
    v_cvt_pk_bf16_f32 v71, v50, v51
    v_exp_f32 v52, v52
    v_exp_f32 v53, v53
    v_exp_f32 v54, v54
    v_exp_f32 v55, v55
    v_mfma_f32_32x32x16_bf16 v[76:91], v[120:123], v[64:67], v[76:91]
    v_exp_f32 v56, v56
    v_exp_f32 v57, v57
    v_exp_f32 v58, v58
    v_exp_f32 v59, v59
    v_cvt_pk_bf16_f32 v72, v52, v53
    v_cvt_pk_bf16_f32 v73, v54, v55
    v_cvt_pk_bf16_f32 v74, v56, v57
    v_cvt_pk_bf16_f32 v75, v58, v59
    v_mfma_f32_32x32x16_bf16 v[44:59], v[20:23], v[12:15], 0
    ds_read_b128 v[24:27], v16 offset:3072
    ds_read_b64_tr_b16 v[108:109], v17 offset:2048
    ds_read_b64_tr_b16 v[110:111], v17 offset:2304
    ds_read_b64_tr_b16 v[112:113], v17 offset:2560
    ds_read_b64_tr_b16 v[114:115], v17 offset:2816
    s_add_u32 s19, s14, 7
    s_and_b32 s19, s19, 7
    s_lshl_b32 s19, s19, 13
    s_add_u32 s19, s19, s21
    s_add_u32 m0, s20, 28672
    s_nop 0
    buffer_load_dwordx4 v2, s[4:7], s19 offen lds
    v_exp_f32 v28, v28
    v_exp_f32 v29, v29
    v_exp_f32 v30, v30
    v_exp_f32 v31, v31
    v_exp_f32 v32, v32
    v_exp_f32 v33, v33
    v_exp_f32 v34, v34
    v_exp_f32 v35, v35
    v_mfma_f32_32x32x16_bf16 v[92:107], v[116:119], v[68:71], v[92:107]
    v_cvt_pk_bf16_f32 v60, v28, v29
    v_cvt_pk_bf16_f32 v61, v30, v31
    v_cvt_pk_bf16_f32 v62, v32, v33
    v_cvt_pk_bf16_f32 v63, v34, v35
    v_exp_f32 v36, v36
    v_exp_f32 v37, v37
    v_exp_f32 v38, v38
    v_exp_f32 v39, v39
    v_mfma_f32_32x32x16_bf16 v[92:107], v[120:123], v[72:75], v[92:107]
    v_exp_f32 v40, v40
    v_exp_f32 v41, v41
    v_exp_f32 v42, v42
    v_exp_f32 v43, v43
    v_cvt_pk_bf16_f32 v64, v36, v37
    v_cvt_pk_bf16_f32 v65, v38, v39
    v_cvt_pk_bf16_f32 v66, v40, v41
    v_cvt_pk_bf16_f32 v67, v42, v43
    s_waitcnt lgkmcnt(0)
    v_mfma_f32_32x32x16_bf16 v[28:43], v[24:27], v[8:11], 0
    s_add_u32 s19, s14, 7
    s_and_b32 s19, s19, 7
    s_lshl_b32 s19, s19, 13
    s_add_u32 s19, s19, s22
    s_add_u32 m0, s20, 94208
    s_nop 0
    buffer_load_dwordx4 v3, s[4:7], s19 offen lds
    v_exp_f32 v44, v44
    v_exp_f32 v45, v45
    v_exp_f32 v46, v46
    v_exp_f32 v47, v47
    v_exp_f32 v48, v48
    v_exp_f32 v49, v49
    v_exp_f32 v50, v50
    v_exp_f32 v51, v51
    v_mfma_f32_32x32x16_bf16 v[76:91], v[108:111], v[60:63], v[76:91]
    v_cvt_pk_bf16_f32 v68, v44, v45
    v_cvt_pk_bf16_f32 v69, v46, v47
    v_cvt_pk_bf16_f32 v70, v48, v49
    v_cvt_pk_bf16_f32 v71, v50, v51
    v_exp_f32 v52, v52
    v_exp_f32 v53, v53
    v_exp_f32 v54, v54
    v_exp_f32 v55, v55
    v_mfma_f32_32x32x16_bf16 v[76:91], v[112:115], v[64:67], v[76:91]
    v_exp_f32 v56, v56
    v_exp_f32 v57, v57
    v_exp_f32 v58, v58
    v_exp_f32 v59, v59
    v_cvt_pk_bf16_f32 v72, v52, v53
    v_cvt_pk_bf16_f32 v73, v54, v55
    v_cvt_pk_bf16_f32 v74, v56, v57
    v_cvt_pk_bf16_f32 v75, v58, v59
    v_mfma_f32_32x32x16_bf16 v[44:59], v[24:27], v[12:15], 0
    ds_read_b128 v[20:23], v16 offset:4096
    ds_read_b64_tr_b16 v[116:117], v17 offset:3072
    ds_read_b64_tr_b16 v[118:119], v17 offset:3328
    ds_read_b64_tr_b16 v[120:121], v17 offset:3584
    ds_read_b64_tr_b16 v[122:123], v17 offset:3840
    v_exp_f32 v28, v28
    v_exp_f32 v29, v29
    v_exp_f32 v30, v30
    v_exp_f32 v31, v31
    v_exp_f32 v32, v32
    v_exp_f32 v33, v33
    v_exp_f32 v34, v34
    v_exp_f32 v35, v35
    v_mfma_f32_32x32x16_bf16 v[92:107], v[108:111], v[68:71], v[92:107]
    v_cvt_pk_bf16_f32 v60, v28, v29
    v_cvt_pk_bf16_f32 v61, v30, v31
    v_cvt_pk_bf16_f32 v62, v32, v33
    v_cvt_pk_bf16_f32 v63, v34, v35
    v_exp_f32 v36, v36
    v_exp_f32 v37, v37
    v_exp_f32 v38, v38
    v_exp_f32 v39, v39
    v_mfma_f32_32x32x16_bf16 v[92:107], v[112:115], v[72:75], v[92:107]
    v_exp_f32 v40, v40
    v_exp_f32 v41, v41
    v_exp_f32 v42, v42
    v_exp_f32 v43, v43
    v_cvt_pk_bf16_f32 v64, v36, v37
    v_cvt_pk_bf16_f32 v65, v38, v39
    v_cvt_pk_bf16_f32 v66, v40, v41
    v_cvt_pk_bf16_f32 v67, v42, v43
    s_waitcnt lgkmcnt(0)
    v_mfma_f32_32x32x16_bf16 v[28:43], v[20:23], v[8:11], 0
    v_exp_f32 v44, v44
    v_exp_f32 v45, v45
    v_exp_f32 v46, v46
    v_exp_f32 v47, v47
    v_exp_f32 v48, v48
    v_exp_f32 v49, v49
    v_exp_f32 v50, v50
    v_exp_f32 v51, v51
    v_mfma_f32_32x32x16_bf16 v[76:91], v[116:119], v[60:63], v[76:91]
    v_cvt_pk_bf16_f32 v68, v44, v45
    v_cvt_pk_bf16_f32 v69, v46, v47
    v_cvt_pk_bf16_f32 v70, v48, v49
    v_cvt_pk_bf16_f32 v71, v50, v51
    v_exp_f32 v52, v52
    v_exp_f32 v53, v53
    v_exp_f32 v54, v54
    v_exp_f32 v55, v55
    v_mfma_f32_32x32x16_bf16 v[76:91], v[120:123], v[64:67], v[76:91]
    v_exp_f32 v56, v56
    v_exp_f32 v57, v57
    v_exp_f32 v58, v58
    v_exp_f32 v59, v59
    v_cvt_pk_bf16_f32 v72, v52, v53
    v_cvt_pk_bf16_f32 v73, v54, v55
    v_cvt_pk_bf16_f32 v74, v56, v57
    v_cvt_pk_bf16_f32 v75, v58, v59
    v_add_u32 v16, 4096, v16
    v_add_u32 v17, v17, v18
    s_cmp_ge_u32 s8, 4
    s_cbranch_scc1 L_tp_144
    s_setprio 2
    s_branch L_tp_145
L_tp_144:
    s_setprio 3
L_tp_145:
    v_mfma_f32_32x32x16_bf16 v[44:59], v[20:23], v[12:15], 0
    ds_read_b128 v[24:27], v16 offset:1024
    ds_read_b64_tr_b16 v[108:109], v17 offset:0
    ds_read_b64_tr_b16 v[110:111], v17 offset:256
    ds_read_b64_tr_b16 v[112:113], v17 offset:512
    ds_read_b64_tr_b16 v[114:115], v17 offset:768
    v_exp_f32 v28, v28
    v_exp_f32 v29, v29
    v_exp_f32 v30, v30
    v_exp_f32 v31, v31
    v_exp_f32 v32, v32
    v_exp_f32 v33, v33
    v_exp_f32 v34, v34
    v_exp_f32 v35, v35
    v_mfma_f32_32x32x16_bf16 v[92:107], v[116:119], v[68:71], v[92:107]
    v_cvt_pk_bf16_f32 v60, v28, v29
    v_cvt_pk_bf16_f32 v61, v30, v31
    v_cvt_pk_bf16_f32 v62, v32, v33
    v_cvt_pk_bf16_f32 v63, v34, v35
    v_exp_f32 v36, v36
    v_exp_f32 v37, v37
    v_exp_f32 v38, v38
    v_exp_f32 v39, v39
    v_mfma_f32_32x32x16_bf16 v[92:107], v[120:123], v[72:75], v[92:107]
    v_exp_f32 v40, v40
    v_exp_f32 v41, v41
    v_exp_f32 v42, v42
    v_exp_f32 v43, v43
    v_cvt_pk_bf16_f32 v64, v36, v37
    v_cvt_pk_bf16_f32 v65, v38, v39
    v_cvt_pk_bf16_f32 v66, v40, v41
    v_cvt_pk_bf16_f32 v67, v42, v43
    s_waitcnt lgkmcnt(0)
    v_mfma_f32_32x32x16_bf16 v[28:43], v[24:27], v[8:11], 0
    v_exp_f32 v44, v44
    v_exp_f32 v45, v45
    v_exp_f32 v46, v46
    v_exp_f32 v47, v47
    v_exp_f32 v48, v48
    v_exp_f32 v49, v49
    v_exp_f32 v50, v50
    v_exp_f32 v51, v51
    v_mfma_f32_32x32x16_bf16 v[76:91], v[108:111], v[60:63], v[76:91]
    v_cvt_pk_bf16_f32 v68, v44, v45
    v_cvt_pk_bf16_f32 v69, v46, v47
    v_cvt_pk_bf16_f32 v70, v48, v49
    v_cvt_pk_bf16_f32 v71, v50, v51
    v_exp_f32 v52, v52
    v_exp_f32 v53, v53
    v_exp_f32 v54, v54
    v_exp_f32 v55, v55
    v_mfma_f32_32x32x16_bf16 v[76:91], v[112:115], v[64:67], v[76:91]
    v_exp_f32 v56, v56
    v_exp_f32 v57, v57
    v_exp_f32 v58, v58
    v_exp_f32 v59, v59
    v_cvt_pk_bf16_f32 v72, v52, v53
    v_cvt_pk_bf16_f32 v73, v54, v55
    v_cvt_pk_bf16_f32 v74, v56, v57
    v_cvt_pk_bf16_f32 v75, v58, v59
    v_mfma_f32_32x32x16_bf16 v[44:59], v[24:27], v[12:15], 0
    ds_read_b128 v[20:23], v16 offset:2048
    ds_read_b64_tr_b16 v[116:117], v17 offset:1024
    ds_read_b64_tr_b16 v[118:119], v17 offset:1280
    ds_read_b64_tr_b16 v[120:121], v17 offset:1536
    ds_read_b64_tr_b16 v[122:123], v17 offset:1792
    v_exp_f32 v28, v28
    v_exp_f32 v29, v29
    v_exp_f32 v30, v30
    v_exp_f32 v31, v31
    v_exp_f32 v32, v32
    v_exp_f32 v33, v33
    v_exp_f32 v34, v34
    v_exp_f32 v35, v35
    v_mfma_f32_32x32x16_bf16 v[92:107], v[108:111], v[68:71], v[92:107]
    v_cvt_pk_bf16_f32 v60, v28, v29
    v_cvt_pk_bf16_f32 v61, v30, v31
    v_cvt_pk_bf16_f32 v62, v32, v33
    v_cvt_pk_bf16_f32 v63, v34, v35
    v_exp_f32 v36, v36
    v_exp_f32 v37, v37
    v_exp_f32 v38, v38
    v_exp_f32 v39, v39
    v_mfma_f32_32x32x16_bf16 v[92:107], v[112:115], v[72:75], v[92:107]
    v_exp_f32 v40, v40
    v_exp_f32 v41, v41
    v_exp_f32 v42, v42
    v_exp_f32 v43, v43
    v_cvt_pk_bf16_f32 v64, v36, v37
    v_cvt_pk_bf16_f32 v65, v38, v39
    v_cvt_pk_bf16_f32 v66, v40, v41
    v_cvt_pk_bf16_f32 v67, v42, v43
    s_waitcnt lgkmcnt(0)
    v_mfma_f32_32x32x16_bf16 v[28:43], v[20:23], v[8:11], 0
    v_exp_f32 v44, v44
    v_exp_f32 v45, v45
    v_exp_f32 v46, v46
    v_exp_f32 v47, v47
    v_exp_f32 v48, v48
    v_exp_f32 v49, v49
    v_exp_f32 v50, v50
    v_exp_f32 v51, v51
    v_mfma_f32_32x32x16_bf16 v[76:91], v[116:119], v[60:63], v[76:91]
    v_cvt_pk_bf16_f32 v68, v44, v45
    v_cvt_pk_bf16_f32 v69, v46, v47
    v_cvt_pk_bf16_f32 v70, v48, v49
    v_cvt_pk_bf16_f32 v71, v50, v51
    v_exp_f32 v52, v52
    v_exp_f32 v53, v53
    v_exp_f32 v54, v54
    v_exp_f32 v55, v55
    v_mfma_f32_32x32x16_bf16 v[76:91], v[120:123], v[64:67], v[76:91]
    v_exp_f32 v56, v56
    v_exp_f32 v57, v57
    v_exp_f32 v58, v58
    v_exp_f32 v59, v59
    v_cvt_pk_bf16_f32 v72, v52, v53
    v_cvt_pk_bf16_f32 v73, v54, v55
    v_cvt_pk_bf16_f32 v74, v56, v57
    v_cvt_pk_bf16_f32 v75, v58, v59
    v_mfma_f32_32x32x16_bf16 v[44:59], v[20:23], v[12:15], 0
    ds_read_b128 v[24:27], v16 offset:3072
    ds_read_b64_tr_b16 v[108:109], v17 offset:2048
    ds_read_b64_tr_b16 v[110:111], v17 offset:2304
    ds_read_b64_tr_b16 v[112:113], v17 offset:2560
    ds_read_b64_tr_b16 v[114:115], v17 offset:2816
    v_exp_f32 v28, v28
    v_exp_f32 v29, v29
    v_exp_f32 v30, v30
    v_exp_f32 v31, v31
    v_exp_f32 v32, v32
    v_exp_f32 v33, v33
    v_exp_f32 v34, v34
    v_exp_f32 v35, v35
    v_mfma_f32_32x32x16_bf16 v[92:107], v[116:119], v[68:71], v[92:107]
    v_cvt_pk_bf16_f32 v60, v28, v29
    v_cvt_pk_bf16_f32 v61, v30, v31
    v_cvt_pk_bf16_f32 v62, v32, v33
    v_cvt_pk_bf16_f32 v63, v34, v35
    v_exp_f32 v36, v36
    v_exp_f32 v37, v37
    v_exp_f32 v38, v38
    v_exp_f32 v39, v39
    v_mfma_f32_32x32x16_bf16 v[92:107], v[120:123], v[72:75], v[92:107]
    v_exp_f32 v40, v40
    v_exp_f32 v41, v41
    v_exp_f32 v42, v42
    v_exp_f32 v43, v43
    v_cvt_pk_bf16_f32 v64, v36, v37
    v_cvt_pk_bf16_f32 v65, v38, v39
    v_cvt_pk_bf16_f32 v66, v40, v41
    v_cvt_pk_bf16_f32 v67, v42, v43
    s_waitcnt lgkmcnt(0)
    v_mfma_f32_32x32x16_bf16 v[28:43], v[24:27], v[8:11], 0
    v_exp_f32 v44, v44
    v_exp_f32 v45, v45
    v_exp_f32 v46, v46
    v_exp_f32 v47, v47
    v_exp_f32 v48, v48
    v_exp_f32 v49, v49
    v_exp_f32 v50, v50
    v_exp_f32 v51, v51
    v_mfma_f32_32x32x16_bf16 v[76:91], v[108:111], v[60:63], v[76:91]
    v_cvt_pk_bf16_f32 v68, v44, v45
    v_cvt_pk_bf16_f32 v69, v46, v47
    v_cvt_pk_bf16_f32 v70, v48, v49
    v_cvt_pk_bf16_f32 v71, v50, v51
    v_exp_f32 v52, v52
    v_exp_f32 v53, v53
    v_exp_f32 v54, v54
    v_exp_f32 v55, v55
    v_mfma_f32_32x32x16_bf16 v[76:91], v[112:115], v[64:67], v[76:91]
    v_exp_f32 v56, v56
    v_exp_f32 v57, v57
    v_exp_f32 v58, v58
    v_exp_f32 v59, v59
    v_cvt_pk_bf16_f32 v72, v52, v53
    v_cvt_pk_bf16_f32 v73, v54, v55
    v_cvt_pk_bf16_f32 v74, v56, v57
    v_cvt_pk_bf16_f32 v75, v58, v59
    s_waitcnt vmcnt(6)
    s_lshl_b32 s23, s10, 3
    s_add_u32 s23, s23, s8
    s_cmp_lg_u32 s23, 7
    s_cbranch_scc1 L_rpkd_147
    s_add_u32 s21, s9, 11
    s_mov_b32 s22, 0
L_rpk_146:
    v_cmp_ne_u32 vcc, s21, v5
    v_cmp_ne_u32 s[24:25], s21, v6
    s_or_b64 vcc, vcc, s[24:25]
    v_cmp_ne_u32 s[24:25], s21, v7
    s_and_b32 s25, s25, 0xffff
    s_or_b64 vcc, vcc, s[24:25]
    s_cmp_eq_u64 vcc, 0
    s_cbranch_scc1 L_rpkd_147
    v_lshlrev_b32 v4, 7, v1
    s_mov_b32 s23, 51740672
    buffer_load_dword v5, v4, s[4:7], s23 offen sc1
    s_mov_b32 s23, 51748864
    buffer_load_dword v6, v4, s[4:7], s23 offen sc1
    s_mov_b32 s23, 51757056
    buffer_load_dword v7, v4, s[4:7], s23 offen sc1
    s_waitcnt vmcnt(0)
    s_add_u32 s22, s22, 1
    s_cmp_lt_u32 s22, 262144
    s_cbranch_scc1 L_rpk_146
L_rpkd_147:
    s_barrier
    s_cmp_ge_u32 s8, 4
    s_cbranch_scc1 L_pfs_148
    s_lshr_b32 s40, s12, 2
    s_and_b32 s41, s8, 1
    s_lshl_b32 s41, s41, 14
    s_mul_i32 s40, s40, 65536
    s_add_u32 s40, s40, s41
    s_add_u32 s40, s40, 9961472
    s_add_u32 s41, s40, 32768
    s_branch L_pfs_149
L_pfs_148:
    s_lshr_b32 s40, s12, 2
    s_sub_u32 s41, s8, 4
    s_mul_i32 s41, s41, 16384
    s_add_u32 s41, s41, 49152
    s_mul_i32 s40, s40, 229376
    s_add_u32 s40, s40, s41
    s_add_u32 s40, s40, 12582912
    s_add_u32 s41, s40, 114688
L_pfs_149:
    v_mfma_f32_32x32x16_bf16 v[44:59], v[24:27], v[12:15], 0
    ds_read_b128 v[20:23], v16 offset:4096
    ds_read_b64_tr_b16 v[116:117], v17 offset:3072
    ds_read_b64_tr_b16 v[118:119], v17 offset:3328
    ds_read_b64_tr_b16 v[120:121], v17 offset:3584
    ds_read_b64_tr_b16 v[122:123], v17 offset:3840
    s_cmp_ge_u32 s8, 4
    s_cbranch_scc1 L_pfh_150
    buffer_load_dwordx4 v[124:127], v2, s[4:7], s40 offen offset:0
    s_branch L_pfe_151
L_pfh_150:
    buffer_load_dwordx4 v[124:127], v2, s[4:7], s40 offen offset:0
L_pfe_151:
    v_exp_f32 v28, v28
    v_exp_f32 v29, v29
    v_exp_f32 v30, v30
    v_exp_f32 v31, v31
    v_exp_f32 v32, v32
    v_exp_f32 v33, v33
    v_exp_f32 v34, v34
    v_exp_f32 v35, v35
    v_mfma_f32_32x32x16_bf16 v[92:107], v[108:111], v[68:71], v[92:107]
    v_cvt_pk_bf16_f32 v60, v28, v29
    v_cvt_pk_bf16_f32 v61, v30, v31
    v_cvt_pk_bf16_f32 v62, v32, v33
    v_cvt_pk_bf16_f32 v63, v34, v35
    v_exp_f32 v36, v36
    v_exp_f32 v37, v37
    v_exp_f32 v38, v38
    v_exp_f32 v39, v39
    v_mfma_f32_32x32x16_bf16 v[92:107], v[112:115], v[72:75], v[92:107]
    v_exp_f32 v40, v40
    v_exp_f32 v41, v41
    v_exp_f32 v42, v42
    v_exp_f32 v43, v43
    v_cvt_pk_bf16_f32 v64, v36, v37
    v_cvt_pk_bf16_f32 v65, v38, v39
    v_cvt_pk_bf16_f32 v66, v40, v41
    v_cvt_pk_bf16_f32 v67, v42, v43
    s_waitcnt lgkmcnt(0)
    v_mfma_f32_32x32x16_bf16 v[28:43], v[20:23], v[8:11], 0
    s_cmp_ge_u32 s8, 4
    s_cbranch_scc1 L_pfh_152
    buffer_load_dwordx4 v[128:131], v2, s[4:7], s41 offen offset:0
    s_branch L_pfe_153
L_pfh_152:
    buffer_load_dwordx4 v[128:131], v2, s[4:7], s41 offen offset:0
L_pfe_153:
    v_exp_f32 v44, v44
    v_exp_f32 v45, v45
    v_exp_f32 v46, v46
    v_exp_f32 v47, v47
    v_exp_f32 v48, v48
    v_exp_f32 v49, v49
    v_exp_f32 v50, v50
    v_exp_f32 v51, v51
    v_mfma_f32_32x32x16_bf16 v[76:91], v[116:119], v[60:63], v[76:91]
    v_cvt_pk_bf16_f32 v68, v44, v45
    v_cvt_pk_bf16_f32 v69, v46, v47
    v_cvt_pk_bf16_f32 v70, v48, v49
    v_cvt_pk_bf16_f32 v71, v50, v51
    v_exp_f32 v52, v52
    v_exp_f32 v53, v53
    v_exp_f32 v54, v54
    v_exp_f32 v55, v55
    v_mfma_f32_32x32x16_bf16 v[76:91], v[120:123], v[64:67], v[76:91]
    v_exp_f32 v56, v56
    v_exp_f32 v57, v57
    v_exp_f32 v58, v58
    v_exp_f32 v59, v59
    v_cvt_pk_bf16_f32 v72, v52, v53
    v_cvt_pk_bf16_f32 v73, v54, v55
    v_cvt_pk_bf16_f32 v74, v56, v57
    v_cvt_pk_bf16_f32 v75, v58, v59
    v_add_u32 v16, 4096, v16
    v_add_u32 v17, v17, v18
    s_setprio 2
    v_mfma_f32_32x32x16_bf16 v[44:59], v[20:23], v[12:15], 0
    ds_read_b128 v[24:27], v16 offset:1024
    ds_read_b64_tr_b16 v[108:109], v17 offset:0
    ds_read_b64_tr_b16 v[110:111], v17 offset:256
    ds_read_b64_tr_b16 v[112:113], v17 offset:512
    ds_read_b64_tr_b16 v[114:115], v17 offset:768
    s_cmp_ge_u32 s8, 4
    s_cbranch_scc1 L_pfh_154
    buffer_load_dwordx4 v[132:135], v2, s[4:7], s40 offen offset:1024
    s_branch L_pfe_155
L_pfh_154:
    buffer_load_dwordx4 v[132:135], v2, s[4:7], s40 offen offset:1024
L_pfe_155:
    v_exp_f32 v28, v28
    v_exp_f32 v29, v29
    v_exp_f32 v30, v30
    v_exp_f32 v31, v31
    v_exp_f32 v32, v32
    v_exp_f32 v33, v33
    v_exp_f32 v34, v34
    v_exp_f32 v35, v35
    v_mfma_f32_32x32x16_bf16 v[92:107], v[116:119], v[68:71], v[92:107]
    v_cvt_pk_bf16_f32 v60, v28, v29
    v_cvt_pk_bf16_f32 v61, v30, v31
    v_cvt_pk_bf16_f32 v62, v32, v33
    v_cvt_pk_bf16_f32 v63, v34, v35
    v_exp_f32 v36, v36
    v_exp_f32 v37, v37
    v_exp_f32 v38, v38
    v_exp_f32 v39, v39
    v_mfma_f32_32x32x16_bf16 v[92:107], v[120:123], v[72:75], v[92:107]
    v_exp_f32 v40, v40
    v_exp_f32 v41, v41
    v_exp_f32 v42, v42
    v_exp_f32 v43, v43
    v_cvt_pk_bf16_f32 v64, v36, v37
    v_cvt_pk_bf16_f32 v65, v38, v39
    v_cvt_pk_bf16_f32 v66, v40, v41
    v_cvt_pk_bf16_f32 v67, v42, v43
    s_waitcnt lgkmcnt(0)
    v_mfma_f32_32x32x16_bf16 v[28:43], v[24:27], v[8:11], 0
    s_cmp_ge_u32 s8, 4
    s_cbranch_scc1 L_pfh_156
    buffer_load_dwordx4 v[136:139], v2, s[4:7], s41 offen offset:1024
    s_branch L_pfe_157
L_pfh_156:
    buffer_load_dwordx4 v[136:139], v2, s[4:7], s41 offen offset:1024
L_pfe_157:
    v_exp_f32 v44, v44
    v_exp_f32 v45, v45
    v_exp_f32 v46, v46
    v_exp_f32 v47, v47
    v_exp_f32 v48, v48
    v_exp_f32 v49, v49
    v_exp_f32 v50, v50
    v_exp_f32 v51, v51
    v_mfma_f32_32x32x16_bf16 v[76:91], v[108:111], v[60:63], v[76:91]
    v_cvt_pk_bf16_f32 v68, v44, v45
    v_cvt_pk_bf16_f32 v69, v46, v47
    v_cvt_pk_bf16_f32 v70, v48, v49
    v_cvt_pk_bf16_f32 v71, v50, v51
    v_exp_f32 v52, v52
    v_exp_f32 v53, v53
    v_exp_f32 v54, v54
    v_exp_f32 v55, v55
    v_mfma_f32_32x32x16_bf16 v[76:91], v[112:115], v[64:67], v[76:91]
    v_exp_f32 v56, v56
    v_exp_f32 v57, v57
    v_exp_f32 v58, v58
    v_exp_f32 v59, v59
    v_cvt_pk_bf16_f32 v72, v52, v53
    v_cvt_pk_bf16_f32 v73, v54, v55
    v_cvt_pk_bf16_f32 v74, v56, v57
    v_cvt_pk_bf16_f32 v75, v58, v59
    v_mfma_f32_32x32x16_bf16 v[44:59], v[24:27], v[12:15], 0
    ds_read_b128 v[20:23], v16 offset:2048
    ds_read_b64_tr_b16 v[116:117], v17 offset:1024
    ds_read_b64_tr_b16 v[118:119], v17 offset:1280
    ds_read_b64_tr_b16 v[120:121], v17 offset:1536
    ds_read_b64_tr_b16 v[122:123], v17 offset:1792
    s_cmp_ge_u32 s8, 4
    s_cbranch_scc1 L_pfh_158
    buffer_load_dwordx4 v[140:143], v2, s[4:7], s40 offen offset:2048
    s_branch L_pfe_159
L_pfh_158:
    buffer_load_dwordx4 v[140:143], v2, s[4:7], s40 offen offset:2048
L_pfe_159:
    v_exp_f32 v28, v28
    v_exp_f32 v29, v29
    v_exp_f32 v30, v30
    v_exp_f32 v31, v31
    v_exp_f32 v32, v32
    v_exp_f32 v33, v33
    v_exp_f32 v34, v34
    v_exp_f32 v35, v35
    v_mfma_f32_32x32x16_bf16 v[92:107], v[108:111], v[68:71], v[92:107]
    v_cvt_pk_bf16_f32 v60, v28, v29
    v_cvt_pk_bf16_f32 v61, v30, v31
    v_cvt_pk_bf16_f32 v62, v32, v33
    v_cvt_pk_bf16_f32 v63, v34, v35
    v_exp_f32 v36, v36
    v_exp_f32 v37, v37
    v_exp_f32 v38, v38
    v_exp_f32 v39, v39
    v_mfma_f32_32x32x16_bf16 v[92:107], v[112:115], v[72:75], v[92:107]
    v_exp_f32 v40, v40
    v_exp_f32 v41, v41
    v_exp_f32 v42, v42
    v_exp_f32 v43, v43
    v_cvt_pk_bf16_f32 v64, v36, v37
    v_cvt_pk_bf16_f32 v65, v38, v39
    v_cvt_pk_bf16_f32 v66, v40, v41
    v_cvt_pk_bf16_f32 v67, v42, v43
    s_waitcnt lgkmcnt(0)
    v_mfma_f32_32x32x16_bf16 v[28:43], v[20:23], v[8:11], 0
    s_cmp_ge_u32 s8, 4
    s_cbranch_scc1 L_pfh_160
    buffer_load_dwordx4 v[144:147], v2, s[4:7], s41 offen offset:2048
    s_branch L_pfe_161
L_pfh_160:
    buffer_load_dwordx4 v[144:147], v2, s[4:7], s41 offen offset:2048
L_pfe_161:
    v_exp_f32 v44, v44
    v_exp_f32 v45, v45
    v_exp_f32 v46, v46
    v_exp_f32 v47, v47
    v_exp_f32 v48, v48
    v_exp_f32 v49, v49
    v_exp_f32 v50, v50
    v_exp_f32 v51, v51
    v_mfma_f32_32x32x16_bf16 v[76:91], v[116:119], v[60:63], v[76:91]
    v_cvt_pk_bf16_f32 v68, v44, v45
    v_cvt_pk_bf16_f32 v69, v46, v47
    v_cvt_pk_bf16_f32 v70, v48, v49
    v_cvt_pk_bf16_f32 v71, v50, v51
    v_exp_f32 v52, v52
    v_exp_f32 v53, v53
    v_exp_f32 v54, v54
    v_exp_f32 v55, v55
    v_mfma_f32_32x32x16_bf16 v[76:91], v[120:123], v[64:67], v[76:91]
    v_exp_f32 v56, v56
    v_exp_f32 v57, v57
    v_exp_f32 v58, v58
    v_exp_f32 v59, v59
    v_cvt_pk_bf16_f32 v72, v52, v53
    v_cvt_pk_bf16_f32 v73, v54, v55
    v_cvt_pk_bf16_f32 v74, v56, v57
    v_cvt_pk_bf16_f32 v75, v58, v59
    v_mfma_f32_32x32x16_bf16 v[44:59], v[20:23], v[12:15], 0
    ds_read_b128 v[24:27], v16 offset:3072
    ds_read_b64_tr_b16 v[108:109], v17 offset:2048
    ds_read_b64_tr_b16 v[110:111], v17 offset:2304
    ds_read_b64_tr_b16 v[112:113], v17 offset:2560
    ds_read_b64_tr_b16 v[114:115], v17 offset:2816
    s_cmp_ge_u32 s8, 4
    s_cbranch_scc1 L_pfh_162
    buffer_load_dwordx4 v[148:151], v2, s[4:7], s40 offen offset:3072
    s_branch L_pfe_163
L_pfh_162:
    buffer_load_dwordx4 v[148:151], v2, s[4:7], s40 offen offset:3072
L_pfe_163:
    v_exp_f32 v28, v28
    v_exp_f32 v29, v29
    v_exp_f32 v30, v30
    v_exp_f32 v31, v31
    v_exp_f32 v32, v32
    v_exp_f32 v33, v33
    v_exp_f32 v34, v34
    v_exp_f32 v35, v35
    v_mfma_f32_32x32x16_bf16 v[92:107], v[116:119], v[68:71], v[92:107]
    v_cvt_pk_bf16_f32 v60, v28, v29
    v_cvt_pk_bf16_f32 v61, v30, v31
    v_cvt_pk_bf16_f32 v62, v32, v33
    v_cvt_pk_bf16_f32 v63, v34, v35
    v_exp_f32 v36, v36
    v_exp_f32 v37, v37
    v_exp_f32 v38, v38
    v_exp_f32 v39, v39
    v_mfma_f32_32x32x16_bf16 v[92:107], v[120:123], v[72:75], v[92:107]
    v_exp_f32 v40, v40
    v_exp_f32 v41, v41
    v_exp_f32 v42, v42
    v_exp_f32 v43, v43
    v_cvt_pk_bf16_f32 v64, v36, v37
    v_cvt_pk_bf16_f32 v65, v38, v39
    v_cvt_pk_bf16_f32 v66, v40, v41
    v_cvt_pk_bf16_f32 v67, v42, v43
    s_waitcnt lgkmcnt(0)
    v_mfma_f32_32x32x16_bf16 v[28:43], v[24:27], v[8:11], 0
    s_cmp_ge_u32 s8, 4
    s_cbranch_scc1 L_pfh_164
    buffer_load_dwordx4 v[152:155], v2, s[4:7], s41 offen offset:3072
    s_branch L_pfe_165
L_pfh_164:
    buffer_load_dwordx4 v[152:155], v2, s[4:7], s41 offen offset:3072
L_pfe_165:
    v_exp_f32 v44, v44
    v_exp_f32 v45, v45
    v_exp_f32 v46, v46
    v_exp_f32 v47, v47
    v_exp_f32 v48, v48
    v_exp_f32 v49, v49
    v_exp_f32 v50, v50
    v_exp_f32 v51, v51
    v_mfma_f32_32x32x16_bf16 v[76:91], v[108:111], v[60:63], v[76:91]
    v_cvt_pk_bf16_f32 v68, v44, v45
    v_cvt_pk_bf16_f32 v69, v46, v47
    v_cvt_pk_bf16_f32 v70, v48, v49
    v_cvt_pk_bf16_f32 v71, v50, v51
    v_exp_f32 v52, v52
    v_exp_f32 v53, v53
    v_exp_f32 v54, v54
    v_exp_f32 v55, v55
    v_mfma_f32_32x32x16_bf16 v[76:91], v[112:115], v[64:67], v[76:91]
    v_exp_f32 v56, v56
    v_exp_f32 v57, v57
    v_exp_f32 v58, v58
    v_exp_f32 v59, v59
    v_cvt_pk_bf16_f32 v72, v52, v53
    v_cvt_pk_bf16_f32 v73, v54, v55
    v_cvt_pk_bf16_f32 v74, v56, v57
    v_cvt_pk_bf16_f32 v75, v58, v59
    v_mfma_f32_32x32x16_bf16 v[44:59], v[24:27], v[12:15], 0
    ds_read_b128 v[20:23], v16 offset:4096
    ds_read_b64_tr_b16 v[116:117], v17 offset:3072
    ds_read_b64_tr_b16 v[118:119], v17 offset:3328
    ds_read_b64_tr_b16 v[120:121], v17 offset:3584
    ds_read_b64_tr_b16 v[122:123], v17 offset:3840
    s_cmp_ge_u32 s8, 4
    s_cbranch_scc1 L_pfh_166
    s_add_u32 s40, s40, 4096
    s_add_u32 s41, s41, 4096
    buffer_load_dwordx4 v[156:159], v2, s[4:7], s40 offen offset:0
    s_branch L_pfe_167
L_pfh_166:
    s_add_u32 s40, s40, 4096
    s_add_u32 s41, s41, 4096
    buffer_load_dwordx4 v[156:159], v2, s[4:7], s40 offen offset:0
L_pfe_167:
    v_exp_f32 v28, v28
    v_exp_f32 v29, v29
    v_exp_f32 v30, v30
    v_exp_f32 v31, v31
    v_exp_f32 v32, v32
    v_exp_f32 v33, v33
    v_exp_f32 v34, v34
    v_exp_f32 v35, v35
    v_mfma_f32_32x32x16_bf16 v[92:107], v[108:111], v[68:71], v[92:107]
    v_cvt_pk_bf16_f32 v60, v28, v29
    v_cvt_pk_bf16_f32 v61, v30, v31
    v_cvt_pk_bf16_f32 v62, v32, v33
    v_cvt_pk_bf16_f32 v63, v34, v35
    v_exp_f32 v36, v36
    v_exp_f32 v37, v37
    v_exp_f32 v38, v38
    v_exp_f32 v39, v39
    v_mfma_f32_32x32x16_bf16 v[92:107], v[112:115], v[72:75], v[92:107]
    v_exp_f32 v40, v40
    v_exp_f32 v41, v41
    v_exp_f32 v42, v42
    v_exp_f32 v43, v43
    v_cvt_pk_bf16_f32 v64, v36, v37
    v_cvt_pk_bf16_f32 v65, v38, v39
    v_cvt_pk_bf16_f32 v66, v40, v41
    v_cvt_pk_bf16_f32 v67, v42, v43
    s_waitcnt lgkmcnt(0)
    v_mfma_f32_32x32x16_bf16 v[28:43], v[20:23], v[8:11], 0
    s_cmp_ge_u32 s8, 4
    s_cbranch_scc1 L_pfh_168
    buffer_load_dwordx4 v[160:163], v2, s[4:7], s41 offen offset:0
    s_branch L_pfe_169
L_pfh_168:
    buffer_load_dwordx4 v[160:163], v2, s[4:7], s41 offen offset:0
L_pfe_169:
    v_exp_f32 v44, v44
    v_exp_f32 v45, v45
    v_exp_f32 v46, v46
    v_exp_f32 v47, v47
    v_exp_f32 v48, v48
    v_exp_f32 v49, v49
    v_exp_f32 v50, v50
    v_exp_f32 v51, v51
    v_mfma_f32_32x32x16_bf16 v[76:91], v[116:119], v[60:63], v[76:91]
    v_cvt_pk_bf16_f32 v68, v44, v45
    v_cvt_pk_bf16_f32 v69, v46, v47
    v_cvt_pk_bf16_f32 v70, v48, v49
    v_cvt_pk_bf16_f32 v71, v50, v51
    v_exp_f32 v52, v52
    v_exp_f32 v53, v53
    v_exp_f32 v54, v54
    v_exp_f32 v55, v55
    v_mfma_f32_32x32x16_bf16 v[76:91], v[120:123], v[64:67], v[76:91]
    v_exp_f32 v56, v56
    v_exp_f32 v57, v57
    v_exp_f32 v58, v58
    v_exp_f32 v59, v59
    v_cvt_pk_bf16_f32 v72, v52, v53
    v_cvt_pk_bf16_f32 v73, v54, v55
    v_cvt_pk_bf16_f32 v74, v56, v57
    v_cvt_pk_bf16_f32 v75, v58, v59
    v_add_u32 v16, 4096, v16
    v_add_u32 v17, v17, v18
    s_cmp_ge_u32 s8, 4
    s_cbranch_scc1 L_tp_170
    s_setprio 1
    s_branch L_tp_171
L_tp_170:
    s_setprio 2
L_tp_171:
    v_mfma_f32_32x32x16_bf16 v[44:59], v[20:23], v[12:15], 0
    ds_read_b128 v[24:27], v16 offset:1024
    ds_read_b64_tr_b16 v[108:109], v17 offset:0
    ds_read_b64_tr_b16 v[110:111], v17 offset:256
    ds_read_b64_tr_b16 v[112:113], v17 offset:512
    ds_read_b64_tr_b16 v[114:115], v17 offset:768
    s_cmp_ge_u32 s8, 4
    s_cbranch_scc1 L_pfh_172
    buffer_load_dwordx4 v[164:167], v2, s[4:7], s40 offen offset:1024
    s_branch L_pfe_173
L_pfh_172:
    buffer_load_dwordx4 v[164:167], v2, s[4:7], s40 offen offset:1024
L_pfe_173:
    v_exp_f32 v28, v28
    v_exp_f32 v29, v29
    v_exp_f32 v30, v30
    v_exp_f32 v31, v31
    v_exp_f32 v32, v32
    v_exp_f32 v33, v33
    v_exp_f32 v34, v34
    v_exp_f32 v35, v35
    v_mfma_f32_32x32x16_bf16 v[92:107], v[116:119], v[68:71], v[92:107]
    v_cvt_pk_bf16_f32 v60, v28, v29
    v_cvt_pk_bf16_f32 v61, v30, v31
    v_cvt_pk_bf16_f32 v62, v32, v33
    v_cvt_pk_bf16_f32 v63, v34, v35
    v_exp_f32 v36, v36
    v_exp_f32 v37, v37
    v_exp_f32 v38, v38
    v_exp_f32 v39, v39
    v_mfma_f32_32x32x16_bf16 v[92:107], v[120:123], v[72:75], v[92:107]
    v_exp_f32 v40, v40
    v_exp_f32 v41, v41
    v_exp_f32 v42, v42
    v_exp_f32 v43, v43
    v_cvt_pk_bf16_f32 v64, v36, v37
    v_cvt_pk_bf16_f32 v65, v38, v39
    v_cvt_pk_bf16_f32 v66, v40, v41
    v_cvt_pk_bf16_f32 v67, v42, v43
    s_waitcnt lgkmcnt(0)
    v_mfma_f32_32x32x16_bf16 v[28:43], v[24:27], v[8:11], 0
    s_cmp_ge_u32 s8, 4
    s_cbranch_scc1 L_pfh_174
    buffer_load_dwordx4 v[168:171], v2, s[4:7], s41 offen offset:1024
    s_branch L_pfe_175
L_pfh_174:
    buffer_load_dwordx4 v[168:171], v2, s[4:7], s41 offen offset:1024
L_pfe_175:
    v_exp_f32 v44, v44
    v_exp_f32 v45, v45
    v_exp_f32 v46, v46
    v_exp_f32 v47, v47
    v_exp_f32 v48, v48
    v_exp_f32 v49, v49
    v_exp_f32 v50, v50
    v_exp_f32 v51, v51
    v_mfma_f32_32x32x16_bf16 v[76:91], v[108:111], v[60:63], v[76:91]
    v_cvt_pk_bf16_f32 v68, v44, v45
    v_cvt_pk_bf16_f32 v69, v46, v47
    v_cvt_pk_bf16_f32 v70, v48, v49
    v_cvt_pk_bf16_f32 v71, v50, v51
    v_exp_f32 v52, v52
    v_exp_f32 v53, v53
    v_exp_f32 v54, v54
    v_exp_f32 v55, v55
    v_mfma_f32_32x32x16_bf16 v[76:91], v[112:115], v[64:67], v[76:91]
    v_exp_f32 v56, v56
    v_exp_f32 v57, v57
    v_exp_f32 v58, v58
    v_exp_f32 v59, v59
    v_cvt_pk_bf16_f32 v72, v52, v53
    v_cvt_pk_bf16_f32 v73, v54, v55
    v_cvt_pk_bf16_f32 v74, v56, v57
    v_cvt_pk_bf16_f32 v75, v58, v59
    v_mfma_f32_32x32x16_bf16 v[44:59], v[24:27], v[12:15], 0
    ds_read_b128 v[20:23], v16 offset:2048
    ds_read_b64_tr_b16 v[116:117], v17 offset:1024
    ds_read_b64_tr_b16 v[118:119], v17 offset:1280
    ds_read_b64_tr_b16 v[120:121], v17 offset:1536
    ds_read_b64_tr_b16 v[122:123], v17 offset:1792
    s_cmp_ge_u32 s8, 4
    s_cbranch_scc1 L_pfh_176
    buffer_load_dwordx4 v[172:175], v2, s[4:7], s40 offen offset:2048
    s_branch L_pfe_177
L_pfh_176:
    buffer_load_dwordx4 v[172:175], v2, s[4:7], s40 offen offset:2048
L_pfe_177:
    v_exp_f32 v28, v28
    v_exp_f32 v29, v29
    v_exp_f32 v30, v30
    v_exp_f32 v31, v31
    v_exp_f32 v32, v32
    v_exp_f32 v33, v33
    v_exp_f32 v34, v34
    v_exp_f32 v35, v35
    v_mfma_f32_32x32x16_bf16 v[92:107], v[108:111], v[68:71], v[92:107]
    v_cvt_pk_bf16_f32 v60, v28, v29
    v_cvt_pk_bf16_f32 v61, v30, v31
    v_cvt_pk_bf16_f32 v62, v32, v33
    v_cvt_pk_bf16_f32 v63, v34, v35
    v_exp_f32 v36, v36
    v_exp_f32 v37, v37
    v_exp_f32 v38, v38
    v_exp_f32 v39, v39
    v_mfma_f32_32x32x16_bf16 v[92:107], v[112:115], v[72:75], v[92:107]
    v_exp_f32 v40, v40
    v_exp_f32 v41, v41
    v_exp_f32 v42, v42
    v_exp_f32 v43, v43
    v_cvt_pk_bf16_f32 v64, v36, v37
    v_cvt_pk_bf16_f32 v65, v38, v39
    v_cvt_pk_bf16_f32 v66, v40, v41
    v_cvt_pk_bf16_f32 v67, v42, v43
    s_waitcnt lgkmcnt(0)
    v_mfma_f32_32x32x16_bf16 v[28:43], v[20:23], v[8:11], 0
    s_cmp_ge_u32 s8, 4
    s_cbranch_scc1 L_pfh_178
    buffer_load_dwordx4 v[176:179], v2, s[4:7], s41 offen offset:2048
    s_branch L_pfe_179
L_pfh_178:
    buffer_load_dwordx4 v[176:179], v2, s[4:7], s41 offen offset:2048
L_pfe_179:
    v_exp_f32 v44, v44
    v_exp_f32 v45, v45
    v_exp_f32 v46, v46
    v_exp_f32 v47, v47
    v_exp_f32 v48, v48
    v_exp_f32 v49, v49
    v_exp_f32 v50, v50
    v_exp_f32 v51, v51
    v_mfma_f32_32x32x16_bf16 v[76:91], v[116:119], v[60:63], v[76:91]
    v_cvt_pk_bf16_f32 v68, v44, v45
    v_cvt_pk_bf16_f32 v69, v46, v47
    v_cvt_pk_bf16_f32 v70, v48, v49
    v_cvt_pk_bf16_f32 v71, v50, v51
    v_exp_f32 v52, v52
    v_exp_f32 v53, v53
    v_exp_f32 v54, v54
    v_exp_f32 v55, v55
    v_mfma_f32_32x32x16_bf16 v[76:91], v[120:123], v[64:67], v[76:91]
    v_exp_f32 v56, v56
    v_exp_f32 v57, v57
    v_exp_f32 v58, v58
    v_exp_f32 v59, v59
    v_cvt_pk_bf16_f32 v72, v52, v53
    v_cvt_pk_bf16_f32 v73, v54, v55
    v_cvt_pk_bf16_f32 v74, v56, v57
    v_cvt_pk_bf16_f32 v75, v58, v59
    v_mfma_f32_32x32x16_bf16 v[44:59], v[20:23], v[12:15], 0
    ds_read_b128 v[24:27], v16 offset:3072
    ds_read_b64_tr_b16 v[108:109], v17 offset:2048
    ds_read_b64_tr_b16 v[110:111], v17 offset:2304
    ds_read_b64_tr_b16 v[112:113], v17 offset:2560
    ds_read_b64_tr_b16 v[114:115], v17 offset:2816
    s_cmp_ge_u32 s8, 4
    s_cbranch_scc1 L_pfh_180
    buffer_load_dwordx4 v[180:183], v2, s[4:7], s40 offen offset:3072
    s_branch L_pfe_181
L_pfh_180:
    buffer_load_dwordx4 v[180:183], v2, s[4:7], s40 offen offset:3072
L_pfe_181:
    v_exp_f32 v28, v28
    v_exp_f32 v29, v29
    v_exp_f32 v30, v30
    v_exp_f32 v31, v31
    v_exp_f32 v32, v32
    v_exp_f32 v33, v33
    v_exp_f32 v34, v34
    v_exp_f32 v35, v35
    v_mfma_f32_32x32x16_bf16 v[92:107], v[116:119], v[68:71], v[92:107]
    v_cvt_pk_bf16_f32 v60, v28, v29
    v_cvt_pk_bf16_f32 v61, v30, v31
    v_cvt_pk_bf16_f32 v62, v32, v33
    v_cvt_pk_bf16_f32 v63, v34, v35
    v_exp_f32 v36, v36
    v_exp_f32 v37, v37
    v_exp_f32 v38, v38
    v_exp_f32 v39, v39
    v_mfma_f32_32x32x16_bf16 v[92:107], v[120:123], v[72:75], v[92:107]
    v_exp_f32 v40, v40
    v_exp_f32 v41, v41
    v_exp_f32 v42, v42
    v_exp_f32 v43, v43
    v_cvt_pk_bf16_f32 v64, v36, v37
    v_cvt_pk_bf16_f32 v65, v38, v39
    v_cvt_pk_bf16_f32 v66, v40, v41
    v_cvt_pk_bf16_f32 v67, v42, v43
    s_waitcnt lgkmcnt(0)
    v_mfma_f32_32x32x16_bf16 v[28:43], v[24:27], v[8:11], 0
    s_cmp_ge_u32 s8, 4
    s_cbranch_scc1 L_pfh_182
    buffer_load_dwordx4 v[184:187], v2, s[4:7], s41 offen offset:3072
    s_branch L_pfe_183
L_pfh_182:
    buffer_load_dwordx4 v[184:187], v2, s[4:7], s41 offen offset:3072
L_pfe_183:
    v_exp_f32 v44, v44
    v_exp_f32 v45, v45
    v_exp_f32 v46, v46
    v_exp_f32 v47, v47
    v_exp_f32 v48, v48
    v_exp_f32 v49, v49
    v_exp_f32 v50, v50
    v_exp_f32 v51, v51
    v_mfma_f32_32x32x16_bf16 v[76:91], v[108:111], v[60:63], v[76:91]
    v_cvt_pk_bf16_f32 v68, v44, v45
    v_cvt_pk_bf16_f32 v69, v46, v47
    v_cvt_pk_bf16_f32 v70, v48, v49
    v_cvt_pk_bf16_f32 v71, v50, v51
    v_exp_f32 v52, v52
    v_exp_f32 v53, v53
    v_exp_f32 v54, v54
    v_exp_f32 v55, v55
    v_mfma_f32_32x32x16_bf16 v[76:91], v[112:115], v[64:67], v[76:91]
    v_exp_f32 v56, v56
    v_exp_f32 v57, v57
    v_exp_f32 v58, v58
    v_exp_f32 v59, v59
    v_cvt_pk_bf16_f32 v72, v52, v53
    v_cvt_pk_bf16_f32 v73, v54, v55
    v_cvt_pk_bf16_f32 v74, v56, v57
    v_cvt_pk_bf16_f32 v75, v58, v59
    s_waitcnt vmcnt(16)
    s_barrier
    s_lshr_b32 s42, s12, 1
    s_lshl_b32 s42, s42, 17
    s_add_u32 s42, s42, 10485760
    s_lshl_b32 s43, s8, 11
    s_add_u32 s42, s42, s43
    v_mfma_f32_32x32x16_bf16 v[44:59], v[24:27], v[12:15], 0
    ds_read_b128 v[20:23], v16 offset:4096
    ds_read_b64_tr_b16 v[116:117], v17 offset:3072
    ds_read_b64_tr_b16 v[118:119], v17 offset:3328
    ds_read_b64_tr_b16 v[120:121], v17 offset:3584
    ds_read_b64_tr_b16 v[122:123], v17 offset:3840
    s_cmp_ge_u32 s12, 28
    s_cbranch_scc1 L_w1p_184
    s_add_u32 m0, s43, 0
    s_add_u32 s19, s42, 0
    buffer_load_dwordx4 v2, s[4:7], s19 offen lds
L_w1p_184:
    s_cmp_ge_u32 s8, 4
    s_cbranch_scc1 L_pfh_185
    s_add_u32 s40, s40, 4096
    s_add_u32 s41, s41, 4096
    buffer_load_dwordx4 v[188:191], v2, s[4:7], s40 offen offset:0
    s_branch L_pfe_186
L_pfh_185:
    s_add_u32 s40, s40, 4096
    s_add_u32 s41, s41, 4096
    buffer_load_dwordx4 v[188:191], v2, s[4:7], s40 offen offset:0
L_pfe_186:
    v_exp_f32 v28, v28
    v_exp_f32 v29, v29
    v_exp_f32 v30, v30
    v_exp_f32 v31, v31
    v_exp_f32 v32, v32
    v_exp_f32 v33, v33
    v_exp_f32 v34, v34
    v_exp_f32 v35, v35
    v_mfma_f32_32x32x16_bf16 v[92:107], v[108:111], v[68:71], v[92:107]
    v_cvt_pk_bf16_f32 v60, v28, v29
    v_cvt_pk_bf16_f32 v61, v30, v31
    v_cvt_pk_bf16_f32 v62, v32, v33
    v_cvt_pk_bf16_f32 v63, v34, v35
    v_exp_f32 v36, v36
    v_exp_f32 v37, v37
    v_exp_f32 v38, v38
    v_exp_f32 v39, v39
    v_mfma_f32_32x32x16_bf16 v[92:107], v[112:115], v[72:75], v[92:107]
    v_exp_f32 v40, v40
    v_exp_f32 v41, v41
    v_exp_f32 v42, v42
    v_exp_f32 v43, v43
    v_cvt_pk_bf16_f32 v64, v36, v37
    v_cvt_pk_bf16_f32 v65, v38, v39
    v_cvt_pk_bf16_f32 v66, v40, v41
    v_cvt_pk_bf16_f32 v67, v42, v43
    s_waitcnt lgkmcnt(0)
    v_mfma_f32_32x32x16_bf16 v[28:43], v[20:23], v[8:11], 0
    s_cmp_ge_u32 s12, 28
    s_cbranch_scc1 L_w1p_187
    s_add_u32 m0, s43, 1024
    s_add_u32 s19, s42, 1024
    buffer_load_dwordx4 v2, s[4:7], s19 offen lds
L_w1p_187:
    s_cmp_ge_u32 s8, 4
    s_cbranch_scc1 L_pfh_188
    buffer_load_dwordx4 v[192:195], v2, s[4:7], s41 offen offset:0
    s_branch L_pfe_189
L_pfh_188:
    buffer_load_dwordx4 v[192:195], v2, s[4:7], s41 offen offset:0
L_pfe_189:
    v_exp_f32 v44, v44
    v_exp_f32 v45, v45
    v_exp_f32 v46, v46
    v_exp_f32 v47, v47
    v_exp_f32 v48, v48
    v_exp_f32 v49, v49
    v_exp_f32 v50, v50
    v_exp_f32 v51, v51
    v_mfma_f32_32x32x16_bf16 v[76:91], v[116:119], v[60:63], v[76:91]
    v_cvt_pk_bf16_f32 v68, v44, v45
    v_cvt_pk_bf16_f32 v69, v46, v47
    v_cvt_pk_bf16_f32 v70, v48, v49
    v_cvt_pk_bf16_f32 v71, v50, v51
    v_exp_f32 v52, v52
    v_exp_f32 v53, v53
    v_exp_f32 v54, v54
    v_exp_f32 v55, v55
    v_mfma_f32_32x32x16_bf16 v[76:91], v[120:123], v[64:67], v[76:91]
    v_exp_f32 v56, v56
    v_exp_f32 v57, v57
    v_exp_f32 v58, v58
    v_exp_f32 v59, v59
    v_cvt_pk_bf16_f32 v72, v52, v53
    v_cvt_pk_bf16_f32 v73, v54, v55
    v_cvt_pk_bf16_f32 v74, v56, v57
    v_cvt_pk_bf16_f32 v75, v58, v59
    v_add_u32 v16, 4096, v16
    v_add_u32 v17, v17, v18
    s_setprio 1
    v_mfma_f32_32x32x16_bf16 v[44:59], v[20:23], v[12:15], 0
    ds_read_b128 v[24:27], v16 offset:1024
    ds_read_b64_tr_b16 v[108:109], v17 offset:0
    ds_read_b64_tr_b16 v[110:111], v17 offset:256
    ds_read_b64_tr_b16 v[112:113], v17 offset:512
    ds_read_b64_tr_b16 v[114:115], v17 offset:768
    s_cmp_ge_u32 s12, 28
    s_cbranch_scc1 L_w1p_190
    s_add_u32 m0, s43, 32768
    s_add_u32 s19, s42, 32768
    buffer_load_dwordx4 v2, s[4:7], s19 offen lds
L_w1p_190:
    s_cmp_ge_u32 s8, 4
    s_cbranch_scc1 L_pfh_191
    buffer_load_dwordx4 v[196:199], v2, s[4:7], s40 offen offset:1024
    s_branch L_pfe_192
L_pfh_191:
    buffer_load_dwordx4 v[196:199], v2, s[4:7], s40 offen offset:1024
L_pfe_192:
    v_exp_f32 v28, v28
    v_exp_f32 v29, v29
    v_exp_f32 v30, v30
    v_exp_f32 v31, v31
    v_exp_f32 v32, v32
    v_exp_f32 v33, v33
    v_exp_f32 v34, v34
    v_exp_f32 v35, v35
    v_mfma_f32_32x32x16_bf16 v[92:107], v[116:119], v[68:71], v[92:107]
    v_cvt_pk_bf16_f32 v60, v28, v29
    v_cvt_pk_bf16_f32 v61, v30, v31
    v_cvt_pk_bf16_f32 v62, v32, v33
    v_cvt_pk_bf16_f32 v63, v34, v35
    v_exp_f32 v36, v36
    v_exp_f32 v37, v37
    v_exp_f32 v38, v38
    v_exp_f32 v39, v39
    v_mfma_f32_32x32x16_bf16 v[92:107], v[120:123], v[72:75], v[92:107]
    v_exp_f32 v40, v40
    v_exp_f32 v41, v41
    v_exp_f32 v42, v42
    v_exp_f32 v43, v43
    v_cvt_pk_bf16_f32 v64, v36, v37
    v_cvt_pk_bf16_f32 v65, v38, v39
    v_cvt_pk_bf16_f32 v66, v40, v41
    v_cvt_pk_bf16_f32 v67, v42, v43
    s_waitcnt lgkmcnt(0)
    v_mfma_f32_32x32x16_bf16 v[28:43], v[24:27], v[8:11], 0
    s_cmp_ge_u32 s12, 28
    s_cbranch_scc1 L_w1p_193
    s_add_u32 m0, s43, 33792
    s_add_u32 s19, s42, 33792
    buffer_load_dwordx4 v2, s[4:7], s19 offen lds
L_w1p_193:
    s_cmp_ge_u32 s8, 4
    s_cbranch_scc1 L_pfh_194
    buffer_load_dwordx4 v[200:203], v2, s[4:7], s41 offen offset:1024
    s_branch L_pfe_195
L_pfh_194:
    buffer_load_dwordx4 v[200:203], v2, s[4:7], s41 offen offset:1024
L_pfe_195:
    v_exp_f32 v44, v44
    v_exp_f32 v45, v45
    v_exp_f32 v46, v46
    v_exp_f32 v47, v47
    v_exp_f32 v48, v48
    v_exp_f32 v49, v49
    v_exp_f32 v50, v50
    v_exp_f32 v51, v51
    v_mfma_f32_32x32x16_bf16 v[76:91], v[108:111], v[60:63], v[76:91]
    v_cvt_pk_bf16_f32 v68, v44, v45
    v_cvt_pk_bf16_f32 v69, v46, v47
    v_cvt_pk_bf16_f32 v70, v48, v49
    v_cvt_pk_bf16_f32 v71, v50, v51
    v_exp_f32 v52, v52
    v_exp_f32 v53, v53
    v_exp_f32 v54, v54
    v_exp_f32 v55, v55
    v_mfma_f32_32x32x16_bf16 v[76:91], v[112:115], v[64:67], v[76:91]
    v_exp_f32 v56, v56
    v_exp_f32 v57, v57
    v_exp_f32 v58, v58
    v_exp_f32 v59, v59
    v_cvt_pk_bf16_f32 v72, v52, v53
    v_cvt_pk_bf16_f32 v73, v54, v55
    v_cvt_pk_bf16_f32 v74, v56, v57
    v_cvt_pk_bf16_f32 v75, v58, v59
    v_mfma_f32_32x32x16_bf16 v[44:59], v[24:27], v[12:15], 0
    ds_read_b128 v[20:23], v16 offset:2048
    ds_read_b64_tr_b16 v[116:117], v17 offset:1024
    ds_read_b64_tr_b16 v[118:119], v17 offset:1280
    ds_read_b64_tr_b16 v[120:121], v17 offset:1536
    ds_read_b64_tr_b16 v[122:123], v17 offset:1792
    s_cmp_ge_u32 s12, 28
    s_cbranch_scc1 L_w1p_196
    s_add_u32 m0, s43, 65536
    s_add_u32 s19, s42, 65536
    buffer_load_dwordx4 v2, s[4:7], s19 offen lds
L_w1p_196:
    s_cmp_ge_u32 s8, 4
    s_cbranch_scc1 L_pfh_197
    buffer_load_dwordx4 v[204:207], v2, s[4:7], s40 offen offset:2048
    s_branch L_pfe_198
L_pfh_197:
    buffer_load_dwordx4 v[204:207], v2, s[4:7], s40 offen offset:2048
L_pfe_198:
    v_exp_f32 v28, v28
    v_exp_f32 v29, v29
    v_exp_f32 v30, v30
    v_exp_f32 v31, v31
    v_exp_f32 v32, v32
    v_exp_f32 v33, v33
    v_exp_f32 v34, v34
    v_exp_f32 v35, v35
    v_mfma_f32_32x32x16_bf16 v[92:107], v[108:111], v[68:71], v[92:107]
    v_cvt_pk_bf16_f32 v60, v28, v29
    v_cvt_pk_bf16_f32 v61, v30, v31
    v_cvt_pk_bf16_f32 v62, v32, v33
    v_cvt_pk_bf16_f32 v63, v34, v35
    v_exp_f32 v36, v36
    v_exp_f32 v37, v37
    v_exp_f32 v38, v38
    v_exp_f32 v39, v39
    v_mfma_f32_32x32x16_bf16 v[92:107], v[112:115], v[72:75], v[92:107]
    v_exp_f32 v40, v40
    v_exp_f32 v41, v41
    v_exp_f32 v42, v42
    v_exp_f32 v43, v43
    v_cvt_pk_bf16_f32 v64, v36, v37
    v_cvt_pk_bf16_f32 v65, v38, v39
    v_cvt_pk_bf16_f32 v66, v40, v41
    v_cvt_pk_bf16_f32 v67, v42, v43
    s_waitcnt lgkmcnt(0)
    v_mfma_f32_32x32x16_bf16 v[28:43], v[20:23], v[8:11], 0
    s_cmp_ge_u32 s12, 28
    s_cbranch_scc1 L_w1p_199
    s_add_u32 m0, s43, 66560
    s_add_u32 s19, s42, 66560
    buffer_load_dwordx4 v2, s[4:7], s19 offen lds
L_w1p_199:
    s_cmp_ge_u32 s8, 4
    s_cbranch_scc1 L_pfh_200
    buffer_load_dwordx4 v[208:211], v2, s[4:7], s41 offen offset:2048
    s_branch L_pfe_201
L_pfh_200:
    buffer_load_dwordx4 v[208:211], v2, s[4:7], s41 offen offset:2048
L_pfe_201:
    v_exp_f32 v44, v44
    v_exp_f32 v45, v45
    v_exp_f32 v46, v46
    v_exp_f32 v47, v47
    v_exp_f32 v48, v48
    v_exp_f32 v49, v49
    v_exp_f32 v50, v50
    v_exp_f32 v51, v51
    v_mfma_f32_32x32x16_bf16 v[76:91], v[116:119], v[60:63], v[76:91]
    v_cvt_pk_bf16_f32 v68, v44, v45
    v_cvt_pk_bf16_f32 v69, v46, v47
    v_cvt_pk_bf16_f32 v70, v48, v49
    v_cvt_pk_bf16_f32 v71, v50, v51
    v_exp_f32 v52, v52
    v_exp_f32 v53, v53
    v_exp_f32 v54, v54
    v_exp_f32 v55, v55
    v_mfma_f32_32x32x16_bf16 v[76:91], v[120:123], v[64:67], v[76:91]
    v_exp_f32 v56, v56
    v_exp_f32 v57, v57
    v_exp_f32 v58, v58
    v_exp_f32 v59, v59
    v_cvt_pk_bf16_f32 v72, v52, v53
    v_cvt_pk_bf16_f32 v73, v54, v55
    v_cvt_pk_bf16_f32 v74, v56, v57
    v_cvt_pk_bf16_f32 v75, v58, v59
    v_mfma_f32_32x32x16_bf16 v[44:59], v[20:23], v[12:15], 0
    ds_read_b128 v[24:27], v16 offset:3072
    ds_read_b64_tr_b16 v[108:109], v17 offset:2048
    ds_read_b64_tr_b16 v[110:111], v17 offset:2304
    ds_read_b64_tr_b16 v[112:113], v17 offset:2560
    ds_read_b64_tr_b16 v[114:115], v17 offset:2816
    s_cmp_ge_u32 s12, 28
    s_cbranch_scc1 L_w1p_202
    s_add_u32 m0, s43, 98304
    s_add_u32 s19, s42, 98304
    buffer_load_dwordx4 v2, s[4:7], s19 offen lds
L_w1p_202:
    s_cmp_ge_u32 s8, 4
    s_cbranch_scc1 L_pfh_203
    buffer_load_dwordx4 v[212:215], v2, s[4:7], s40 offen offset:3072
    s_branch L_pfe_204
L_pfh_203:
    buffer_load_dwordx4 v[212:215], v2, s[4:7], s40 offen offset:3072
L_pfe_204:
    v_exp_f32 v28, v28
    v_exp_f32 v29, v29
    v_exp_f32 v30, v30
    v_exp_f32 v31, v31
    v_exp_f32 v32, v32
    v_exp_f32 v33, v33
    v_exp_f32 v34, v34
    v_exp_f32 v35, v35
    v_mfma_f32_32x32x16_bf16 v[92:107], v[116:119], v[68:71], v[92:107]
    v_cvt_pk_bf16_f32 v60, v28, v29
    v_cvt_pk_bf16_f32 v61, v30, v31
    v_cvt_pk_bf16_f32 v62, v32, v33
    v_cvt_pk_bf16_f32 v63, v34, v35
    v_exp_f32 v36, v36
    v_exp_f32 v37, v37
    v_exp_f32 v38, v38
    v_exp_f32 v39, v39
    v_mfma_f32_32x32x16_bf16 v[92:107], v[120:123], v[72:75], v[92:107]
    v_exp_f32 v40, v40
    v_exp_f32 v41, v41
    v_exp_f32 v42, v42
    v_exp_f32 v43, v43
    v_cvt_pk_bf16_f32 v64, v36, v37
    v_cvt_pk_bf16_f32 v65, v38, v39
    v_cvt_pk_bf16_f32 v66, v40, v41
    v_cvt_pk_bf16_f32 v67, v42, v43
    s_waitcnt lgkmcnt(0)
    v_mfma_f32_32x32x16_bf16 v[28:43], v[24:27], v[8:11], 0
    s_cmp_ge_u32 s12, 28
    s_cbranch_scc1 L_w1p_205
    s_add_u32 m0, s43, 99328
    s_add_u32 s19, s42, 99328
    buffer_load_dwordx4 v2, s[4:7], s19 offen lds
L_w1p_205:
    s_cmp_ge_u32 s8, 4
    s_cbranch_scc1 L_pfh_206
    buffer_load_dwordx4 v[216:219], v2, s[4:7], s41 offen offset:3072
    s_branch L_pfe_207
L_pfh_206:
    buffer_load_dwordx4 v[216:219], v2, s[4:7], s41 offen offset:3072
L_pfe_207:
    v_exp_f32 v44, v44
    v_exp_f32 v45, v45
    v_exp_f32 v46, v46
    v_exp_f32 v47, v47
    v_exp_f32 v48, v48
    v_exp_f32 v49, v49
    v_exp_f32 v50, v50
    v_exp_f32 v51, v51
    v_mfma_f32_32x32x16_bf16 v[76:91], v[108:111], v[60:63], v[76:91]
    v_cvt_pk_bf16_f32 v68, v44, v45
    v_cvt_pk_bf16_f32 v69, v46, v47
    v_cvt_pk_bf16_f32 v70, v48, v49
    v_cvt_pk_bf16_f32 v71, v50, v51
    v_exp_f32 v52, v52
    v_exp_f32 v53, v53
    v_exp_f32 v54, v54
    v_exp_f32 v55, v55
    v_mfma_f32_32x32x16_bf16 v[76:91], v[112:115], v[64:67], v[76:91]
    v_exp_f32 v56, v56
    v_exp_f32 v57, v57
    v_exp_f32 v58, v58
    v_exp_f32 v59, v59
    v_cvt_pk_bf16_f32 v72, v52, v53
    v_cvt_pk_bf16_f32 v73, v54, v55
    v_cvt_pk_bf16_f32 v74, v56, v57
    v_cvt_pk_bf16_f32 v75, v58, v59
    v_mfma_f32_32x32x16_bf16 v[44:59], v[24:27], v[12:15], 0
    ds_read_b128 v[20:23], v16 offset:4096
    ds_read_b64_tr_b16 v[116:117], v17 offset:3072
    ds_read_b64_tr_b16 v[118:119], v17 offset:3328
    ds_read_b64_tr_b16 v[120:121], v17 offset:3584
    ds_read_b64_tr_b16 v[122:123], v17 offset:3840
    s_cmp_ge_u32 s8, 4
    s_cbranch_scc1 L_pfh_208
    s_add_u32 s40, s40, 4096
    s_add_u32 s41, s41, 4096
    buffer_load_dwordx4 v[220:223], v2, s[4:7], s40 offen offset:0
    s_branch L_pfe_209
L_pfh_208:
    s_add_u32 s40, s40, 4096
    s_add_u32 s41, s41, 4096
    buffer_load_dwordx4 v[220:223], v2, s[4:7], s40 offen offset:0
L_pfe_209:
    v_exp_f32 v28, v28
    v_exp_f32 v29, v29
    v_exp_f32 v30, v30
    v_exp_f32 v31, v31
    v_exp_f32 v32, v32
    v_exp_f32 v33, v33
    v_exp_f32 v34, v34
    v_exp_f32 v35, v35
    v_mfma_f32_32x32x16_bf16 v[92:107], v[108:111], v[68:71], v[92:107]
    v_cvt_pk_bf16_f32 v60, v28, v29
    v_cvt_pk_bf16_f32 v61, v30, v31
    v_cvt_pk_bf16_f32 v62, v32, v33
    v_cvt_pk_bf16_f32 v63, v34, v35
    v_exp_f32 v36, v36
    v_exp_f32 v37, v37
    v_exp_f32 v38, v38
    v_exp_f32 v39, v39
    v_mfma_f32_32x32x16_bf16 v[92:107], v[112:115], v[72:75], v[92:107]
    v_exp_f32 v40, v40
    v_exp_f32 v41, v41
    v_exp_f32 v42, v42
    v_exp_f32 v43, v43
    v_cvt_pk_bf16_f32 v64, v36, v37
    v_cvt_pk_bf16_f32 v65, v38, v39
    v_cvt_pk_bf16_f32 v66, v40, v41
    v_cvt_pk_bf16_f32 v67, v42, v43
    s_waitcnt lgkmcnt(0)
    v_mfma_f32_32x32x16_bf16 v[28:43], v[20:23], v[8:11], 0
    s_cmp_ge_u32 s8, 4
    s_cbranch_scc1 L_pfh_210
    buffer_load_dwordx4 v[224:227], v2, s[4:7], s41 offen offset:0
    s_branch L_pfe_211
L_pfh_210:
    buffer_load_dwordx4 v[224:227], v2, s[4:7], s41 offen offset:0
L_pfe_211:
    v_exp_f32 v44, v44
    v_exp_f32 v45, v45
    v_exp_f32 v46, v46
    v_exp_f32 v47, v47
    v_exp_f32 v48, v48
    v_exp_f32 v49, v49
    v_exp_f32 v50, v50
    v_exp_f32 v51, v51
    v_mfma_f32_32x32x16_bf16 v[76:91], v[116:119], v[60:63], v[76:91]
    v_cvt_pk_bf16_f32 v68, v44, v45
    v_cvt_pk_bf16_f32 v69, v46, v47
    v_cvt_pk_bf16_f32 v70, v48, v49
    v_cvt_pk_bf16_f32 v71, v50, v51
    v_exp_f32 v52, v52
    v_exp_f32 v53, v53
    v_exp_f32 v54, v54
    v_exp_f32 v55, v55
    v_mfma_f32_32x32x16_bf16 v[76:91], v[120:123], v[64:67], v[76:91]
    v_exp_f32 v56, v56
    v_exp_f32 v57, v57
    v_exp_f32 v58, v58
    v_exp_f32 v59, v59
    v_cvt_pk_bf16_f32 v72, v52, v53
    v_cvt_pk_bf16_f32 v73, v54, v55
    v_cvt_pk_bf16_f32 v74, v56, v57
    v_cvt_pk_bf16_f32 v75, v58, v59
    v_add_u32 v16, 4096, v16
    v_add_u32 v17, v17, v18
    s_cmp_ge_u32 s8, 4
    s_cbranch_scc1 L_tp_212
    s_setprio 0
    s_branch L_tp_213
L_tp_212:
    s_setprio 1
L_tp_213:
    v_mfma_f32_32x32x16_bf16 v[44:59], v[20:23], v[12:15], 0
    ds_read_b128 v[24:27], v16 offset:1024
    ds_read_b64_tr_b16 v[108:109], v17 offset:0
    ds_read_b64_tr_b16 v[110:111], v17 offset:256
    ds_read_b64_tr_b16 v[112:113], v17 offset:512
    ds_read_b64_tr_b16 v[114:115], v17 offset:768
    s_cmp_ge_u32 s8, 4
    s_cbranch_scc1 L_pfh_214
    buffer_load_dwordx4 v[228:231], v2, s[4:7], s40 offen offset:1024
    s_branch L_pfe_215
L_pfh_214:
    buffer_load_dwordx4 v[228:231], v2, s[4:7], s40 offen offset:1024
L_pfe_215:
    v_exp_f32 v28, v28
    v_exp_f32 v29, v29
    v_exp_f32 v30, v30
    v_exp_f32 v31, v31
    v_exp_f32 v32, v32
    v_exp_f32 v33, v33
    v_exp_f32 v34, v34
    v_exp_f32 v35, v35
    v_mfma_f32_32x32x16_bf16 v[92:107], v[116:119], v[68:71], v[92:107]
    v_cvt_pk_bf16_f32 v60, v28, v29
    v_cvt_pk_bf16_f32 v61, v30, v31
    v_cvt_pk_bf16_f32 v62, v32, v33
    v_cvt_pk_bf16_f32 v63, v34, v35
    v_exp_f32 v36, v36
    v_exp_f32 v37, v37
    v_exp_f32 v38, v38
    v_exp_f32 v39, v39
    v_mfma_f32_32x32x16_bf16 v[92:107], v[120:123], v[72:75], v[92:107]
    v_exp_f32 v40, v40
    v_exp_f32 v41, v41
    v_exp_f32 v42, v42
    v_exp_f32 v43, v43
    v_cvt_pk_bf16_f32 v64, v36, v37
    v_cvt_pk_bf16_f32 v65, v38, v39
    v_cvt_pk_bf16_f32 v66, v40, v41
    v_cvt_pk_bf16_f32 v67, v42, v43
    s_waitcnt lgkmcnt(0)
    v_mfma_f32_32x32x16_bf16 v[28:43], v[24:27], v[8:11], 0
    s_cmp_ge_u32 s8, 4
    s_cbranch_scc1 L_pfh_216
    buffer_load_dwordx4 v[232:235], v2, s[4:7], s41 offen offset:1024
    s_branch L_pfe_217
L_pfh_216:
    buffer_load_dwordx4 v[232:235], v2, s[4:7], s41 offen offset:1024
L_pfe_217:
    v_exp_f32 v44, v44
    v_exp_f32 v45, v45
    v_exp_f32 v46, v46
    v_exp_f32 v47, v47
    v_exp_f32 v48, v48
    v_exp_f32 v49, v49
    v_exp_f32 v50, v50
    v_exp_f32 v51, v51
    v_mfma_f32_32x32x16_bf16 v[76:91], v[108:111], v[60:63], v[76:91]
    v_cvt_pk_bf16_f32 v68, v44, v45
    v_cvt_pk_bf16_f32 v69, v46, v47
    v_cvt_pk_bf16_f32 v70, v48, v49
    v_cvt_pk_bf16_f32 v71, v50, v51
    v_exp_f32 v52, v52
    v_exp_f32 v53, v53
    v_exp_f32 v54, v54
    v_exp_f32 v55, v55
    v_mfma_f32_32x32x16_bf16 v[76:91], v[112:115], v[64:67], v[76:91]
    v_exp_f32 v56, v56
    v_exp_f32 v57, v57
    v_exp_f32 v58, v58
    v_exp_f32 v59, v59
    v_cvt_pk_bf16_f32 v72, v52, v53
    v_cvt_pk_bf16_f32 v73, v54, v55
    v_cvt_pk_bf16_f32 v74, v56, v57
    v_cvt_pk_bf16_f32 v75, v58, v59
    v_mfma_f32_32x32x16_bf16 v[44:59], v[24:27], v[12:15], 0
    ds_read_b128 v[20:23], v16 offset:2048
    ds_read_b64_tr_b16 v[116:117], v17 offset:1024
    ds_read_b64_tr_b16 v[118:119], v17 offset:1280
    ds_read_b64_tr_b16 v[120:121], v17 offset:1536
    ds_read_b64_tr_b16 v[122:123], v17 offset:1792
    s_cmp_ge_u32 s8, 4
    s_cbranch_scc1 L_pfh_218
    buffer_load_dwordx4 v[236:239], v2, s[4:7], s40 offen offset:2048
    s_branch L_pfe_219
L_pfh_218:
    buffer_load_dwordx4 v[236:239], v2, s[4:7], s40 offen offset:2048
L_pfe_219:
    v_exp_f32 v28, v28
    v_exp_f32 v29, v29
    v_exp_f32 v30, v30
    v_exp_f32 v31, v31
    v_exp_f32 v32, v32
    v_exp_f32 v33, v33
    v_exp_f32 v34, v34
    v_exp_f32 v35, v35
    v_mfma_f32_32x32x16_bf16 v[92:107], v[108:111], v[68:71], v[92:107]
    v_cvt_pk_bf16_f32 v60, v28, v29
    v_cvt_pk_bf16_f32 v61, v30, v31
    v_cvt_pk_bf16_f32 v62, v32, v33
    v_cvt_pk_bf16_f32 v63, v34, v35
    v_exp_f32 v36, v36
    v_exp_f32 v37, v37
    v_exp_f32 v38, v38
    v_exp_f32 v39, v39
    v_mfma_f32_32x32x16_bf16 v[92:107], v[112:115], v[72:75], v[92:107]
    v_exp_f32 v40, v40
    v_exp_f32 v41, v41
    v_exp_f32 v42, v42
    v_exp_f32 v43, v43
    v_cvt_pk_bf16_f32 v64, v36, v37
    v_cvt_pk_bf16_f32 v65, v38, v39
    v_cvt_pk_bf16_f32 v66, v40, v41
    v_cvt_pk_bf16_f32 v67, v42, v43
    s_waitcnt lgkmcnt(0)
    v_mfma_f32_32x32x16_bf16 v[28:43], v[20:23], v[8:11], 0
    s_cmp_ge_u32 s8, 4
    s_cbranch_scc1 L_pfh_220
    buffer_load_dwordx4 v[240:243], v2, s[4:7], s41 offen offset:2048
    s_branch L_pfe_221
L_pfh_220:
    buffer_load_dwordx4 v[240:243], v2, s[4:7], s41 offen offset:2048
L_pfe_221:
    v_exp_f32 v44, v44
    v_exp_f32 v45, v45
    v_exp_f32 v46, v46
    v_exp_f32 v47, v47
    v_exp_f32 v48, v48
    v_exp_f32 v49, v49
    v_exp_f32 v50, v50
    v_exp_f32 v51, v51
    v_mfma_f32_32x32x16_bf16 v[76:91], v[116:119], v[60:63], v[76:91]
    v_cvt_pk_bf16_f32 v68, v44, v45
    v_cvt_pk_bf16_f32 v69, v46, v47
    v_cvt_pk_bf16_f32 v70, v48, v49
    v_cvt_pk_bf16_f32 v71, v50, v51
    v_exp_f32 v52, v52
    v_exp_f32 v53, v53
    v_exp_f32 v54, v54
    v_exp_f32 v55, v55
    v_mfma_f32_32x32x16_bf16 v[76:91], v[120:123], v[64:67], v[76:91]
    v_exp_f32 v56, v56
    v_exp_f32 v57, v57
    v_exp_f32 v58, v58
    v_exp_f32 v59, v59
    v_cvt_pk_bf16_f32 v72, v52, v53
    v_cvt_pk_bf16_f32 v73, v54, v55
    v_cvt_pk_bf16_f32 v74, v56, v57
    v_cvt_pk_bf16_f32 v75, v58, v59
    v_mfma_f32_32x32x16_bf16 v[44:59], v[20:23], v[12:15], 0
    ds_read_b128 v[24:27], v16 offset:3072
    ds_read_b64_tr_b16 v[108:109], v17 offset:2048
    ds_read_b64_tr_b16 v[110:111], v17 offset:2304
    ds_read_b64_tr_b16 v[112:113], v17 offset:2560
    ds_read_b64_tr_b16 v[114:115], v17 offset:2816
    s_cmp_ge_u32 s8, 4
    s_cbranch_scc1 L_pfh_222
    buffer_load_dwordx4 v[244:247], v2, s[4:7], s40 offen offset:3072
    s_branch L_pfe_223
L_pfh_222:
    buffer_load_dwordx4 v[244:247], v2, s[4:7], s40 offen offset:3072
L_pfe_223:
    v_exp_f32 v28, v28
    v_exp_f32 v29, v29
    v_exp_f32 v30, v30
    v_exp_f32 v31, v31
    v_exp_f32 v32, v32
    v_exp_f32 v33, v33
    v_exp_f32 v34, v34
    v_exp_f32 v35, v35
    v_mfma_f32_32x32x16_bf16 v[92:107], v[116:119], v[68:71], v[92:107]
    v_cvt_pk_bf16_f32 v60, v28, v29
    v_cvt_pk_bf16_f32 v61, v30, v31
    v_cvt_pk_bf16_f32 v62, v32, v33
    v_cvt_pk_bf16_f32 v63, v34, v35
    v_exp_f32 v36, v36
    v_exp_f32 v37, v37
    v_exp_f32 v38, v38
    v_exp_f32 v39, v39
    v_mfma_f32_32x32x16_bf16 v[92:107], v[120:123], v[72:75], v[92:107]
    v_exp_f32 v40, v40
    v_exp_f32 v41, v41
    v_exp_f32 v42, v42
    v_exp_f32 v43, v43
    v_cvt_pk_bf16_f32 v64, v36, v37
    v_cvt_pk_bf16_f32 v65, v38, v39
    v_cvt_pk_bf16_f32 v66, v40, v41
    v_cvt_pk_bf16_f32 v67, v42, v43
    s_waitcnt lgkmcnt(0)
    v_mfma_f32_32x32x16_bf16 v[28:43], v[24:27], v[8:11], 0
    s_cmp_ge_u32 s8, 4
    s_cbranch_scc1 L_pfh_224
    buffer_load_dwordx4 v[248:251], v2, s[4:7], s41 offen offset:3072
    s_branch L_pfe_225
L_pfh_224:
    buffer_load_dwordx4 v[248:251], v2, s[4:7], s41 offen offset:3072
L_pfe_225:
    v_exp_f32 v44, v44
    v_exp_f32 v45, v45
    v_exp_f32 v46, v46
    v_exp_f32 v47, v47
    v_exp_f32 v48, v48
    v_exp_f32 v49, v49
    v_exp_f32 v50, v50
    v_exp_f32 v51, v51
    v_mfma_f32_32x32x16_bf16 v[76:91], v[108:111], v[60:63], v[76:91]
    v_cvt_pk_bf16_f32 v68, v44, v45
    v_cvt_pk_bf16_f32 v69, v46, v47
    v_cvt_pk_bf16_f32 v70, v48, v49
    v_cvt_pk_bf16_f32 v71, v50, v51
    v_exp_f32 v52, v52
    v_exp_f32 v53, v53
    v_exp_f32 v54, v54
    v_exp_f32 v55, v55
    v_mfma_f32_32x32x16_bf16 v[76:91], v[112:115], v[64:67], v[76:91]
    v_exp_f32 v56, v56
    v_exp_f32 v57, v57
    v_exp_f32 v58, v58
    v_exp_f32 v59, v59
    v_cvt_pk_bf16_f32 v72, v52, v53
    v_cvt_pk_bf16_f32 v73, v54, v55
    v_cvt_pk_bf16_f32 v74, v56, v57
    v_cvt_pk_bf16_f32 v75, v58, v59
    v_mfma_f32_32x32x16_bf16 v[44:59], v[24:27], v[12:15], 0
    ds_read_b128 v[20:23], v16 offset:4096
    ds_read_b64_tr_b16 v[116:117], v17 offset:3072
    ds_read_b64_tr_b16 v[118:119], v17 offset:3328
    ds_read_b64_tr_b16 v[120:121], v17 offset:3584
    ds_read_b64_tr_b16 v[122:123], v17 offset:3840
    v_exp_f32 v28, v28
    v_exp_f32 v29, v29
    v_exp_f32 v30, v30
    v_exp_f32 v31, v31
    v_exp_f32 v32, v32
    v_exp_f32 v33, v33
    v_exp_f32 v34, v34
    v_exp_f32 v35, v35
    v_mfma_f32_32x32x16_bf16 v[92:107], v[108:111], v[68:71], v[92:107]
    v_cvt_pk_bf16_f32 v60, v28, v29
    v_cvt_pk_bf16_f32 v61, v30, v31
    v_cvt_pk_bf16_f32 v62, v32, v33
    v_cvt_pk_bf16_f32 v63, v34, v35
    v_exp_f32 v36, v36
    v_exp_f32 v37, v37
    v_exp_f32 v38, v38
    v_exp_f32 v39, v39
    v_mfma_f32_32x32x16_bf16 v[92:107], v[112:115], v[72:75], v[92:107]
    v_exp_f32 v40, v40
    v_exp_f32 v41, v41
    v_exp_f32 v42, v42
    v_exp_f32 v43, v43
    v_cvt_pk_bf16_f32 v64, v36, v37
    v_cvt_pk_bf16_f32 v65, v38, v39
    v_cvt_pk_bf16_f32 v66, v40, v41
    v_cvt_pk_bf16_f32 v67, v42, v43
    s_waitcnt lgkmcnt(0)
    v_mfma_f32_32x32x16_bf16 v[28:43], v[20:23], v[8:11], 0
    v_exp_f32 v44, v44
    v_exp_f32 v45, v45
    v_exp_f32 v46, v46
    v_exp_f32 v47, v47
    v_exp_f32 v48, v48
    v_exp_f32 v49, v49
    v_exp_f32 v50, v50
    v_exp_f32 v51, v51
    v_mfma_f32_32x32x16_bf16 v[76:91], v[116:119], v[60:63], v[76:91]
    v_cvt_pk_bf16_f32 v68, v44, v45
    v_cvt_pk_bf16_f32 v69, v46, v47
    v_cvt_pk_bf16_f32 v70, v48, v49
    v_cvt_pk_bf16_f32 v71, v50, v51
    v_exp_f32 v52, v52
    v_exp_f32 v53, v53
    v_exp_f32 v54, v54
    v_exp_f32 v55, v55
    v_mfma_f32_32x32x16_bf16 v[76:91], v[120:123], v[64:67], v[76:91]
    v_exp_f32 v56, v56
    v_exp_f32 v57, v57
    v_exp_f32 v58, v58
    v_exp_f32 v59, v59
    v_cvt_pk_bf16_f32 v72, v52, v53
    v_cvt_pk_bf16_f32 v73, v54, v55
    v_cvt_pk_bf16_f32 v74, v56, v57
    v_cvt_pk_bf16_f32 v75, v58, v59
    v_add_u32 v16, 4096, v16
    v_add_u32 v17, v17, v18
    s_setprio 0
    v_mfma_f32_32x32x16_bf16 v[44:59], v[20:23], v[12:15], 0
    ds_read_b128 v[24:27], v16 offset:1024
    ds_read_b64_tr_b16 v[108:109], v17 offset:0
    ds_read_b64_tr_b16 v[110:111], v17 offset:256
    ds_read_b64_tr_b16 v[112:113], v17 offset:512
    ds_read_b64_tr_b16 v[114:115], v17 offset:768
    v_exp_f32 v28, v28
    v_exp_f32 v29, v29
    v_exp_f32 v30, v30
    v_exp_f32 v31, v31
    v_exp_f32 v32, v32
    v_exp_f32 v33, v33
    v_exp_f32 v34, v34
    v_exp_f32 v35, v35
    v_mfma_f32_32x32x16_bf16 v[92:107], v[116:119], v[68:71], v[92:107]
    v_cvt_pk_bf16_f32 v60, v28, v29
    v_cvt_pk_bf16_f32 v61, v30, v31
    v_cvt_pk_bf16_f32 v62, v32, v33
    v_cvt_pk_bf16_f32 v63, v34, v35
    v_exp_f32 v36, v36
    v_exp_f32 v37, v37
    v_exp_f32 v38, v38
    v_exp_f32 v39, v39
    v_mfma_f32_32x32x16_bf16 v[92:107], v[120:123], v[72:75], v[92:107]
    v_exp_f32 v40, v40
    v_exp_f32 v41, v41
    v_exp_f32 v42, v42
    v_exp_f32 v43, v43
    v_cvt_pk_bf16_f32 v64, v36, v37
    v_cvt_pk_bf16_f32 v65, v38, v39
    v_cvt_pk_bf16_f32 v66, v40, v41
    v_cvt_pk_bf16_f32 v67, v42, v43
    s_waitcnt lgkmcnt(0)
    v_mfma_f32_32x32x16_bf16 v[28:43], v[24:27], v[8:11], 0
    v_exp_f32 v44, v44
    v_exp_f32 v45, v45
    v_exp_f32 v46, v46
    v_exp_f32 v47, v47
    v_exp_f32 v48, v48
    v_exp_f32 v49, v49
    v_exp_f32 v50, v50
    v_exp_f32 v51, v51
    v_mfma_f32_32x32x16_bf16 v[76:91], v[108:111], v[60:63], v[76:91]
    v_cvt_pk_bf16_f32 v68, v44, v45
    v_cvt_pk_bf16_f32 v69, v46, v47
    v_cvt_pk_bf16_f32 v70, v48, v49
    v_cvt_pk_bf16_f32 v71, v50, v51
    v_exp_f32 v52, v52
    v_exp_f32 v53, v53
    v_exp_f32 v54, v54
    v_exp_f32 v55, v55
    v_mfma_f32_32x32x16_bf16 v[76:91], v[112:115], v[64:67], v[76:91]
    v_exp_f32 v56, v56
    v_exp_f32 v57, v57
    v_exp_f32 v58, v58
    v_exp_f32 v59, v59
    v_cvt_pk_bf16_f32 v72, v52, v53
    v_cvt_pk_bf16_f32 v73, v54, v55
    v_cvt_pk_bf16_f32 v74, v56, v57
    v_cvt_pk_bf16_f32 v75, v58, v59
    v_mfma_f32_32x32x16_bf16 v[44:59], v[24:27], v[12:15], 0
    ds_read_b128 v[20:23], v16 offset:2048
    ds_read_b64_tr_b16 v[116:117], v17 offset:1024
    ds_read_b64_tr_b16 v[118:119], v17 offset:1280
    ds_read_b64_tr_b16 v[120:121], v17 offset:1536
    ds_read_b64_tr_b16 v[122:123], v17 offset:1792
    v_exp_f32 v28, v28
    v_exp_f32 v29, v29
    v_exp_f32 v30, v30
    v_exp_f32 v31, v31
    v_exp_f32 v32, v32
    v_exp_f32 v33, v33
    v_exp_f32 v34, v34
    v_exp_f32 v35, v35
    v_mfma_f32_32x32x16_bf16 v[92:107], v[108:111], v[68:71], v[92:107]
    v_cvt_pk_bf16_f32 v60, v28, v29
    v_cvt_pk_bf16_f32 v61, v30, v31
    v_cvt_pk_bf16_f32 v62, v32, v33
    v_cvt_pk_bf16_f32 v63, v34, v35
    v_exp_f32 v36, v36
    v_exp_f32 v37, v37
    v_exp_f32 v38, v38
    v_exp_f32 v39, v39
    v_mfma_f32_32x32x16_bf16 v[92:107], v[112:115], v[72:75], v[92:107]
    v_exp_f32 v40, v40
    v_exp_f32 v41, v41
    v_exp_f32 v42, v42
    v_exp_f32 v43, v43
    v_cvt_pk_bf16_f32 v64, v36, v37
    v_cvt_pk_bf16_f32 v65, v38, v39
    v_cvt_pk_bf16_f32 v66, v40, v41
    v_cvt_pk_bf16_f32 v67, v42, v43
    s_waitcnt lgkmcnt(0)
    v_mfma_f32_32x32x16_bf16 v[28:43], v[20:23], v[8:11], 0
    v_exp_f32 v44, v44
    v_exp_f32 v45, v45
    v_exp_f32 v46, v46
    v_exp_f32 v47, v47
    v_exp_f32 v48, v48
    v_exp_f32 v49, v49
    v_exp_f32 v50, v50
    v_exp_f32 v51, v51
    v_mfma_f32_32x32x16_bf16 v[76:91], v[116:119], v[60:63], v[76:91]
    v_cvt_pk_bf16_f32 v68, v44, v45
    v_cvt_pk_bf16_f32 v69, v46, v47
    v_cvt_pk_bf16_f32 v70, v48, v49
    v_cvt_pk_bf16_f32 v71, v50, v51
    v_exp_f32 v52, v52
    v_exp_f32 v53, v53
    v_exp_f32 v54, v54
    v_exp_f32 v55, v55
    v_mfma_f32_32x32x16_bf16 v[76:91], v[120:123], v[64:67], v[76:91]
    v_exp_f32 v56, v56
    v_exp_f32 v57, v57
    v_exp_f32 v58, v58
    v_exp_f32 v59, v59
    v_cvt_pk_bf16_f32 v72, v52, v53
    v_cvt_pk_bf16_f32 v73, v54, v55
    v_cvt_pk_bf16_f32 v74, v56, v57
    v_cvt_pk_bf16_f32 v75, v58, v59
    v_mfma_f32_32x32x16_bf16 v[44:59], v[20:23], v[12:15], 0
    ds_read_b128 v[24:27], v16 offset:3072
    ds_read_b64_tr_b16 v[108:109], v17 offset:2048
    ds_read_b64_tr_b16 v[110:111], v17 offset:2304
    ds_read_b64_tr_b16 v[112:113], v17 offset:2560
    ds_read_b64_tr_b16 v[114:115], v17 offset:2816
    v_exp_f32 v28, v28
    v_exp_f32 v29, v29
    v_exp_f32 v30, v30
    v_exp_f32 v31, v31
    v_exp_f32 v32, v32
    v_exp_f32 v33, v33
    v_exp_f32 v34, v34
    v_exp_f32 v35, v35
    v_mfma_f32_32x32x16_bf16 v[92:107], v[116:119], v[68:71], v[92:107]
    v_cvt_pk_bf16_f32 v60, v28, v29
    v_cvt_pk_bf16_f32 v61, v30, v31
    v_cvt_pk_bf16_f32 v62, v32, v33
    v_cvt_pk_bf16_f32 v63, v34, v35
    v_exp_f32 v36, v36
    v_exp_f32 v37, v37
    v_exp_f32 v38, v38
    v_exp_f32 v39, v39
    v_mfma_f32_32x32x16_bf16 v[92:107], v[120:123], v[72:75], v[92:107]
    v_exp_f32 v40, v40
    v_exp_f32 v41, v41
    v_exp_f32 v42, v42
    v_exp_f32 v43, v43
    v_cvt_pk_bf16_f32 v64, v36, v37
    v_cvt_pk_bf16_f32 v65, v38, v39
    v_cvt_pk_bf16_f32 v66, v40, v41
    v_cvt_pk_bf16_f32 v67, v42, v43
    s_waitcnt lgkmcnt(0)
    v_mfma_f32_32x32x16_bf16 v[28:43], v[24:27], v[8:11], 0
    v_exp_f32 v44, v44
    v_exp_f32 v45, v45
    v_exp_f32 v46, v46
    v_exp_f32 v47, v47
    v_exp_f32 v48, v48
    v_exp_f32 v49, v49
    v_exp_f32 v50, v50
    v_exp_f32 v51, v51
    v_mfma_f32_32x32x16_bf16 v[76:91], v[108:111], v[60:63], v[76:91]
    v_cvt_pk_bf16_f32 v68, v44, v45
    v_cvt_pk_bf16_f32 v69, v46, v47
    v_cvt_pk_bf16_f32 v70, v48, v49
    v_cvt_pk_bf16_f32 v71, v50, v51
    v_exp_f32 v52, v52
    v_exp_f32 v53, v53
    v_exp_f32 v54, v54
    v_exp_f32 v55, v55
    v_mfma_f32_32x32x16_bf16 v[76:91], v[112:115], v[64:67], v[76:91]
    v_exp_f32 v56, v56
    v_exp_f32 v57, v57
    v_exp_f32 v58, v58
    v_exp_f32 v59, v59
    v_cvt_pk_bf16_f32 v72, v52, v53
    v_cvt_pk_bf16_f32 v73, v54, v55
    v_cvt_pk_bf16_f32 v74, v56, v57
    v_cvt_pk_bf16_f32 v75, v58, v59
    v_mfma_f32_32x32x16_bf16 v[44:59], v[24:27], v[12:15], 0
    ds_read_b64_tr_b16 v[116:117], v17 offset:3072
    ds_read_b64_tr_b16 v[118:119], v17 offset:3328
    ds_read_b64_tr_b16 v[120:121], v17 offset:3584
    ds_read_b64_tr_b16 v[122:123], v17 offset:3840
    v_exp_f32 v28, v28
    v_exp_f32 v29, v29
    v_exp_f32 v30, v30
    v_exp_f32 v31, v31
    v_exp_f32 v32, v32
    v_exp_f32 v33, v33
    v_exp_f32 v34, v34
    v_exp_f32 v35, v35
    v_mfma_f32_32x32x16_bf16 v[92:107], v[108:111], v[68:71], v[92:107]
    v_cvt_pk_bf16_f32 v60, v28, v29
    v_cvt_pk_bf16_f32 v61, v30, v31
    v_cvt_pk_bf16_f32 v62, v32, v33
    v_cvt_pk_bf16_f32 v63, v34, v35
    v_exp_f32 v36, v36
    v_exp_f32 v37, v37
    v_exp_f32 v38, v38
    v_exp_f32 v39, v39
    v_mfma_f32_32x32x16_bf16 v[92:107], v[112:115], v[72:75], v[92:107]
    v_exp_f32 v40, v40
    v_exp_f32 v41, v41
    v_exp_f32 v42, v42
    v_exp_f32 v43, v43
    v_cvt_pk_bf16_f32 v64, v36, v37
    v_cvt_pk_bf16_f32 v65, v38, v39
    v_cvt_pk_bf16_f32 v66, v40, v41
    v_cvt_pk_bf16_f32 v67, v42, v43
    s_waitcnt lgkmcnt(0)
    v_exp_f32 v44, v44
    v_exp_f32 v45, v45
    v_exp_f32 v46, v46
    v_exp_f32 v47, v47
    v_exp_f32 v48, v48
    v_exp_f32 v49, v49
    v_exp_f32 v50, v50
    v_exp_f32 v51, v51
    v_mfma_f32_32x32x16_bf16 v[76:91], v[116:119], v[60:63], v[76:91]
    v_cvt_pk_bf16_f32 v68, v44, v45
    v_cvt_pk_bf16_f32 v69, v46, v47
    v_cvt_pk_bf16_f32 v70, v48, v49
    v_cvt_pk_bf16_f32 v71, v50, v51
    v_exp_f32 v52, v52
    v_exp_f32 v53, v53
    v_exp_f32 v54, v54
    v_exp_f32 v55, v55
    v_mfma_f32_32x32x16_bf16 v[76:91], v[120:123], v[64:67], v[76:91]
    v_exp_f32 v56, v56
    v_exp_f32 v57, v57
    v_exp_f32 v58, v58
    v_exp_f32 v59, v59
    v_cvt_pk_bf16_f32 v72, v52, v53
    v_cvt_pk_bf16_f32 v73, v54, v55
    v_cvt_pk_bf16_f32 v74, v56, v57
    v_cvt_pk_bf16_f32 v75, v58, v59
    s_nop 1
    v_mfma_f32_32x32x16_bf16 v[92:107], v[116:119], v[68:71], v[92:107]
    v_mfma_f32_32x32x16_bf16 v[92:107], v[120:123], v[72:75], v[92:107]
    s_setprio 0
    s_nop 7
    s_nop 7
    s_mov_b32 s23, 0x2b000000
    s_mov_b32 s24, 0x53000000
    s_mov_b32 s25, 0x7b000000
    v_max3_f32 v6, |v76|, |v77|, |v78|
    v_max3_f32 v7, |v79|, |v80|, |v81|
    v_max3_f32 v6, |v82|, |v83|, v6
    v_max_f32 v6, v6, v7
    v_cmp_nge_f32 vcc, v84, s23
    v_cmp_nle_f32 s[26:27], v84, s24
    s_or_b64 vcc, vcc, s[26:27]
    v_cmp_nle_f32 s[26:27], v6, s25
    s_or_b64 vcc, vcc, s[26:27]
    v_max3_f32 v6, |v92|, |v93|, |v94|
    v_max3_f32 v7, |v95|, |v96|, |v97|
    v_max3_f32 v6, |v98|, |v99|, v6
    v_max_f32 v6, v6, v7
    v_cmp_nge_f32 s[28:29], v100, s23
    s_or_b64 vcc, vcc, s[28:29]
    v_cmp_nle_f32 s[26:27], v100, s24
    s_or_b64 vcc, vcc, s[26:27]
    v_cmp_nle_f32 s[26:27], v6, s25
    s_or_b64 vcc, vcc, s[26:27]
    s_cmp_eq_u64 vcc, 0
    s_cbranch_scc1 L_att_nb_226
    v_mov_b32 v6, 137248
    v_mov_b32 v7, 1
    s_mov_b64 exec, 1
    ds_add_u32 v6, v7
    s_mov_b64 exec, -1
L_att_nb_226:
    s_mul_i32 s23, s8, 3072
    s_add_u32 s23, s23, 139264
    v_add_u32 v4, s23, v2
    s_xor_b32 s24, s8, 4
    s_mul_i32 s24, s24, 3072
    s_add_u32 s24, s24, 139264
    v_add_u32 v5, s24, v2
    s_cmp_lg_u32 s16, 0
    s_cbranch_scc1 L_ex1_227
    ds_write_b128 v4, v[92:95] offset:0
    ds_write_b128 v4, v[96:99] offset:1024
    ds_write_b128 v4, v[100:103] offset:2048
    s_branch L_ex2_228
L_ex1_227:
    ds_write_b128 v4, v[76:79] offset:0
    ds_write_b128 v4, v[80:83] offset:1024
    ds_write_b128 v4, v[84:87] offset:2048
    v_pk_mov_b32 v[76:77], v[92:93], v[92:93] op_sel:[0,1]
    v_pk_mov_b32 v[78:79], v[94:95], v[94:95] op_sel:[0,1]
    v_pk_mov_b32 v[80:81], v[96:97], v[96:97] op_sel:[0,1]
    v_pk_mov_b32 v[82:83], v[98:99], v[98:99] op_sel:[0,1]
    v_pk_mov_b32 v[84:85], v[100:101], v[100:101] op_sel:[0,1]
    v_mov_b32 v8, v12
    v_mov_b32 v9, v13
    v_mov_b32 v10, v14
    v_mov_b32 v11, v15
L_ex2_228:
    s_waitcnt lgkmcnt(0)
    s_barrier
    ds_read_b128 v[28:31], v5 offset:0
    ds_read_b128 v[32:35], v5 offset:1024
    ds_read_b128 v[36:39], v5 offset:2048
    v_mov_b32 v4, 137248
    ds_read_b32 v7, v4
    s_waitcnt lgkmcnt(0)
    v_readfirstlane_b32 s23, v7
    v_pk_add_f32 v[76:77], v[76:77], v[28:29]
    v_pk_add_f32 v[78:79], v[78:79], v[30:31]
    v_pk_add_f32 v[80:81], v[80:81], v[32:33]
    v_pk_add_f32 v[82:83], v[82:83], v[34:35]
    v_pk_add_f32 v[84:85], v[84:85], v[36:37]
    s_cmp_eq_u32 s23, 0
    s_cbranch_scc1 L_att_ok_229
    s_waitcnt vmcnt(0)
    s_barrier
    s_add_u32 s19, s14, 0
    s_and_b32 s19, s19, 7
    s_lshl_b32 s19, s19, 13
    s_add_u32 s19, s19, s44
    s_add_u32 m0, s20, 0
    s_nop 0
    buffer_load_dwordx4 v2, s[4:7], s19 offen lds
    s_add_u32 s19, s14, 0
    s_and_b32 s19, s19, 7
    s_lshl_b32 s19, s19, 13
    s_add_u32 s19, s19, s45
    s_add_u32 m0, s20, 65536
    s_nop 0
    buffer_load_dwordx4 v3, s[4:7], s19 offen lds
    s_add_u32 s19, s14, 1
    s_and_b32 s19, s19, 7
    s_lshl_b32 s19, s19, 13
    s_add_u32 s19, s19, s44
    s_add_u32 m0, s20, 4096
    s_nop 0
    buffer_load_dwordx4 v2, s[4:7], s19 offen lds
    s_add_u32 s19, s14, 1
    s_and_b32 s19, s19, 7
    s_lshl_b32 s19, s19, 13
    s_add_u32 s19, s19, s45
    s_add_u32 m0, s20, 69632
    s_nop 0
    buffer_load_dwordx4 v3, s[4:7], s19 offen lds
    s_add_u32 s19, s14, 2
    s_and_b32 s19, s19, 7
    s_lshl_b32 s19, s19, 13
    s_add_u32 s19, s19, s44
    s_add_u32 m0, s20, 8192
    s_nop 0
    buffer_load_dwordx4 v2, s[4:7], s19 offen lds
    s_add_u32 s19, s14, 2
    s_and_b32 s19, s19, 7
    s_lshl_b32 s19, s19, 13
    s_add_u32 s19, s19, s45
    s_add_u32 m0, s20, 73728
    s_nop 0
    buffer_load_dwordx4 v3, s[4:7], s19 offen lds
    s_add_u32 s19, s14, 3
    s_and_b32 s19, s19, 7
    s_lshl_b32 s19, s19, 13
    s_add_u32 s19, s19, s44
    s_add_u32 m0, s20, 12288
    s_nop 0
    buffer_load_dwordx4 v2, s[4:7], s19 offen lds
    s_add_u32 s19, s14, 3
    s_and_b32 s19, s19, 7
    s_lshl_b32 s19, s19, 13
    s_add_u32 s19, s19, s45
    s_add_u32 m0, s20, 77824
    s_nop 0
    buffer_load_dwordx4 v3, s[4:7], s19 offen lds
    s_add_u32 s19, s14, 4
    s_and_b32 s19, s19, 7
    s_lshl_b32 s19, s19, 13
    s_add_u32 s19, s19, s44
    s_add_u32 m0, s20, 16384
    s_nop 0
    buffer_load_dwordx4 v2, s[4:7], s19 offen lds
    s_add_u32 s19, s14, 4
    s_and_b32 s19, s19, 7
    s_lshl_b32 s19, s19, 13
    s_add_u32 s19, s19, s45
    s_add_u32 m0, s20, 81920
    s_nop 0
    buffer_load_dwordx4 v3, s[4:7], s19 offen lds
    s_add_u32 s19, s14, 5
    s_and_b32 s19, s19, 7
    s_lshl_b32 s19, s19, 13
    s_add_u32 s19, s19, s44
    s_add_u32 m0, s20, 20480
    s_nop 0
    buffer_load_dwordx4 v2, s[4:7], s19 offen lds
    s_add_u32 s19, s14, 5
    s_and_b32 s19, s19, 7
    s_lshl_b32 s19, s19, 13
    s_add_u32 s19, s19, s45
    s_add_u32 m0, s20, 86016
    s_nop 0
    buffer_load_dwordx4 v3, s[4:7], s19 offen lds
    s_add_u32 s19, s14, 6
    s_and_b32 s19, s19, 7
    s_lshl_b32 s19, s19, 13
    s_add_u32 s19, s19, s44
    s_add_u32 m0, s20, 24576
    s_nop 0
    buffer_load_dwordx4 v2, s[4:7], s19 offen lds
    s_add_u32 s19, s14, 6
    s_and_b32 s19, s19, 7
    s_lshl_b32 s19, s19, 13
    s_add_u32 s19, s19, s45
    s_add_u32 m0, s20, 90112
    s_nop 0
    buffer_load_dwordx4 v3, s[4:7], s19 offen lds
    s_add_u32 s19, s14, 7
    s_and_b32 s19, s19, 7
    s_lshl_b32 s19, s19, 13
    s_add_u32 s19, s19, s44
    s_add_u32 m0, s20, 28672
    s_nop 0
    buffer_load_dwordx4 v2, s[4:7], s19 offen lds
    s_add_u32 s19, s14, 7
    s_and_b32 s19, s19, 7
    s_lshl_b32 s19, s19, 13
    s_add_u32 s19, s19, s45
    s_add_u32 m0, s20, 94208
    s_nop 0
    buffer_load_dwordx4 v3, s[4:7], s19 offen lds
    s_waitcnt vmcnt(0)
    s_barrier
    v_mov_b32 v68, 0xff800000
    v_mov_b32 v16, v2
    s_mov_b32 s24, 0
L_sp1_230:
    ds_read_b128 v[20:23], v16 offset:0
    s_waitcnt lgkmcnt(0)
    v_mfma_f32_32x32x16_bf16 v[28:43], v[20:23], v[8:11], 0
    s_nop 7
    s_nop 7
    v_max3_f32 v68, v28, v29, v68
    v_max3_f32 v68, v30, v31, v68
    v_max3_f32 v68, v32, v33, v68
    v_max3_f32 v68, v34, v35, v68
    v_max3_f32 v68, v36, v37, v68
    v_max3_f32 v68, v38, v39, v68
    v_max3_f32 v68, v40, v41, v68
    v_max3_f32 v68, v42, v43, v68
    v_add_u32 v16, 1024, v16
    s_add_u32 s24, s24, 1
    s_cmp_lt_u32 s24, 64
    s_cbranch_scc1 L_sp1_230
    v_mov_b32 v69, v68
    s_nop 1
    v_permlane32_swap_b32 v68, v69
    s_nop 1
    v_max_f32 v68, v68, v69
    v_sub_f32 v44, 0, v68
    v_sub_f32 v45, 0, v68
    v_sub_f32 v46, 0, v68
    v_sub_f32 v47, 0, v68
    v_sub_f32 v48, 0, v68
    v_sub_f32 v49, 0, v68
    v_sub_f32 v50, 0, v68
    v_sub_f32 v51, 0, v68
    v_sub_f32 v52, 0, v68
    v_sub_f32 v53, 0, v68
    v_sub_f32 v54, 0, v68
    v_sub_f32 v55, 0, v68
    v_sub_f32 v56, 0, v68
    v_sub_f32 v57, 0, v68
    v_sub_f32 v58, 0, v68
    v_sub_f32 v59, 0, v68
    v_mov_b32 v76, 0
    v_mov_b32 v77, 0
    v_mov_b32 v78, 0
    v_mov_b32 v79, 0
    v_mov_b32 v80, 0
    v_mov_b32 v81, 0
    v_mov_b32 v82, 0
    v_mov_b32 v83, 0
    v_mov_b32 v84, 0
    v_mov_b32 v85, 0
    v_mov_b32 v86, 0
    v_mov_b32 v87, 0
    v_mov_b32 v88, 0
    v_mov_b32 v89, 0
    v_mov_b32 v90, 0
    v_mov_b32 v91, 0
    v_mov_b32 v16, v2
    s_mov_b32 s24, 0
    v_lshrrev_b32 v70, 2, v18
L_sp2_231:
    ds_read_b128 v[20:23], v16 offset:0
    ds_read_b64_tr_b16 v[108:109], v19 offset:0
    ds_read_b64_tr_b16 v[110:111], v19 offset:256
    ds_read_b64_tr_b16 v[112:113], v19 offset:512
    ds_read_b64_tr_b16 v[114:115], v19 offset:768
    s_waitcnt lgkmcnt(0)
    v_mfma_f32_32x32x16_bf16 v[28:43], v[20:23], v[8:11], v[44:59]
    s_nop 7
    s_nop 7
    v_exp_f32 v28, v28
    v_exp_f32 v29, v29
    v_exp_f32 v30, v30
    v_exp_f32 v31, v31
    v_exp_f32 v32, v32
    v_exp_f32 v33, v33
    v_exp_f32 v34, v34
    v_exp_f32 v35, v35
    v_exp_f32 v36, v36
    v_exp_f32 v37, v37
    v_exp_f32 v38, v38
    v_exp_f32 v39, v39
    v_exp_f32 v40, v40
    v_exp_f32 v41, v41
    v_exp_f32 v42, v42
    v_exp_f32 v43, v43
    s_nop 0
    v_cvt_pk_bf16_f32 v60, v28, v29
    v_cvt_pk_bf16_f32 v61, v30, v31
    v_cvt_pk_bf16_f32 v62, v32, v33
    v_cvt_pk_bf16_f32 v63, v34, v35
    v_cvt_pk_bf16_f32 v64, v36, v37
    v_cvt_pk_bf16_f32 v65, v38, v39
    v_cvt_pk_bf16_f32 v66, v40, v41
    v_cvt_pk_bf16_f32 v67, v42, v43
    s_nop 1
    v_mfma_f32_32x32x16_bf16 v[76:91], v[108:111], v[60:63], v[76:91]
    v_mfma_f32_32x32x16_bf16 v[76:91], v[112:115], v[64:67], v[76:91]
    v_add_u32 v16, 1024, v16
    v_add_u32 v19, v19, v70
    s_add_u32 s24, s24, 1
    s_cmp_lt_u32 s24, 64
    s_cbranch_scc1 L_sp2_231
    s_nop 7
    s_nop 7
L_att_ok_229:
    v_rcp_f32 v4, v84
    s_nop 0
    v_mul_f32 v76, v4, v76
    v_mul_f32 v77, v4, v77
    v_mul_f32 v78, v4, v78
    v_mul_f32 v79, v4, v79
    v_mul_f32 v80, v4, v80
    v_mul_f32 v81, v4, v81
    v_mul_f32 v82, v4, v82
    v_mul_f32 v83, v4, v83
    v_cvt_pk_bf16_f32 v60, v76, v77
    v_cvt_pk_bf16_f32 v61, v78, v79
    v_cvt_pk_bf16_f32 v62, v80, v81
    v_cvt_pk_bf16_f32 v63, v82, v83
    s_add_u32 s17, s17, s16
    s_lshl_b32 s17, s17, 15
    s_lshl_b32 s19, s13, 10
    s_add_u32 s17, s17, s19
    s_lshl_b32 s19, s10, 21
    s_add_u32 s17, s17, s19
    s_add_u32 s17, s17, 27262976
    buffer_store_dwordx4 v[60:63], v2, s[4:7], s17 offen sc1
    s_mul_i32 s35, s10, 5
    s_add_u32 s35, s35, 2
    s_add_u32 s34, s9, s35
    s_lshl_b32 s35, s35, 8
    s_add_u32 s35, s35, s36
    s_lshl_b32 s35, s35, 7
    s_add_u32 s35, s35, 51380224
    s_waitcnt vmcnt(0)
    s_barrier
    s_cmp_lg_u32 s8, 7
    s_cbranch_scc1 L_sig_232
    v_mov_b32 v4, s34
    v_mov_b32 v5, 0
    s_mov_b64 exec, 1
    buffer_store_dword v4, v5, s[4:7], s35 offen sc1
    s_mov_b64 exec, -1
L_sig_232:
    s_and_b32 s13, s12, 3
    s_lshl_b32 s14, s11, 2
    s_add_u32 s13, s13, s14
    s_lshr_b32 s14, s12, 2
    s_cmp_ge_u32 s8, 4
    s_cbranch_scc1 L_wo_idle_234
    v_mov_b32 v4, 137240
    s_mov_b32 s29, 0
L_lw_236:
    ds_read_b32 v5, v4
    s_waitcnt lgkmcnt(0)
    v_readfirstlane_b32 s28, v5
    s_nop 0
    s_cmp_ge_u32 s28, 1
    s_cbranch_scc1 L_lwd_237
    s_sleep 2
    s_add_u32 s29, s29, 1
    s_cmp_lt_u32 s29, 262144
    s_cbranch_scc1 L_lw_236
L_lwd_237:
    s_setprio 2
    s_lshr_b32 s20, s8, 1
    s_lshl_b32 s22, s13, 1
    s_add_u32 s20, s22, s20
    s_and_b32 s15, s8, 1
    s_lshl_b32 s21, s14, 1
    s_add_u32 s21, s21, s15
    s_lshl_b32 s16, s20, 15
    s_lshl_b32 s17, s15, 14
    s_add_u32 s16, s16, s17
    s_lshl_b32 s17, s10, 21
    s_add_u32 s16, s16, s17
    s_add_u32 s16, s16, 27262976
    buffer_load_dwordx4 v[16:19], v2, s[4:7], s16 offen offset:0
    buffer_load_dwordx4 v[20:23], v2, s[4:7], s16 offen offset:1024
    buffer_load_dwordx4 v[24:27], v2, s[4:7], s16 offen offset:2048
    buffer_load_dwordx4 v[28:31], v2, s[4:7], s16 offen offset:3072
    s_add_u32 s16, s16, 4096
    buffer_load_dwordx4 v[32:35], v2, s[4:7], s16 offen offset:0
    buffer_load_dwordx4 v[36:39], v2, s[4:7], s16 offen offset:1024
    buffer_load_dwordx4 v[40:43], v2, s[4:7], s16 offen offset:2048
    buffer_load_dwordx4 v[44:47], v2, s[4:7], s16 offen offset:3072
    s_add_u32 s16, s16, 4096
    buffer_load_dwordx4 v[48:51], v2, s[4:7], s16 offen offset:0
    buffer_load_dwordx4 v[52:55], v2, s[4:7], s16 offen offset:1024
    buffer_load_dwordx4 v[56:59], v2, s[4:7], s16 offen offset:2048
    buffer_load_dwordx4 v[60:63], v2, s[4:7], s16 offen offset:3072
    s_add_u32 s16, s16, 4096
    buffer_load_dwordx4 v[64:67], v2, s[4:7], s16 offen offset:0
    buffer_load_dwordx4 v[68:71], v2, s[4:7], s16 offen offset:1024
    buffer_load_dwordx4 v[72:75], v2, s[4:7], s16 offen offset:2048
    buffer_load_dwordx4 v[76:79], v2, s[4:7], s16 offen offset:3072
    s_lshl_b32 s22, s20, 15
    s_lshl_b32 s23, s21, 11
    s_add_u32 s22, s22, s23
    s_cmp_lg_u32 s10, 0
    s_cbranch_scc1 L_wr0_238
    v_and_b32 v4, 31, v1
    v_lshlrev_b32 v4, 10, v4
    v_lshrrev_b32 v5, 5, v1
    v_lshl_add_u32 v4, v5, 3, v4
    s_lshl_b32 s23, s20, 15
    s_lshl_b32 s24, s21, 6
    s_add_u32 s23, s23, s24
    buffer_load_dwordx2 v[8:9], v4, s[48:51], s23 offen offset:0
    buffer_load_dwordx2 v[10:11], v4, s[48:51], s23 offen offset:16
    buffer_load_dwordx2 v[12:13], v4, s[48:51], s23 offen offset:32
    buffer_load_dwordx2 v[14:15], v4, s[48:51], s23 offen offset:48
    s_branch L_wr1_239
L_wr0_238:
    s_add_u32 s23, s22, 4194304
    buffer_load_dwordx2 v[8:9], v2, s[4:7], s23 offen offset:0
    buffer_load_dwordx2 v[10:11], v2, s[4:7], s23 offen offset:8
    buffer_load_dwordx2 v[12:13], v2, s[4:7], s23 offen offset:1024
    buffer_load_dwordx2 v[14:15], v2, s[4:7], s23 offen offset:1032
L_wr1_239:
    s_waitcnt vmcnt(19)
    v_mfma_f32_32x32x16_bf16 v[80:95], v[124:127], v[16:19], 0
    v_mfma_f32_32x32x16_bf16 v[96:111], v[128:131], v[16:19], 0
    s_waitcnt vmcnt(18)
    v_mfma_f32_32x32x16_bf16 v[80:95], v[132:135], v[20:23], v[80:95]
    v_mfma_f32_32x32x16_bf16 v[96:111], v[136:139], v[20:23], v[96:111]
    s_waitcnt vmcnt(17)
    v_mfma_f32_32x32x16_bf16 v[80:95], v[140:143], v[24:27], v[80:95]
    v_mfma_f32_32x32x16_bf16 v[96:111], v[144:147], v[24:27], v[96:111]
    s_waitcnt vmcnt(16)
    v_mfma_f32_32x32x16_bf16 v[80:95], v[148:151], v[28:31], v[80:95]
    v_mfma_f32_32x32x16_bf16 v[96:111], v[152:155], v[28:31], v[96:111]
    s_waitcnt vmcnt(15)
    v_mfma_f32_32x32x16_bf16 v[80:95], v[156:159], v[32:35], v[80:95]
    v_mfma_f32_32x32x16_bf16 v[96:111], v[160:163], v[32:35], v[96:111]
    s_waitcnt vmcnt(14)
    v_mfma_f32_32x32x16_bf16 v[80:95], v[164:167], v[36:39], v[80:95]
    v_mfma_f32_32x32x16_bf16 v[96:111], v[168:171], v[36:39], v[96:111]
    s_waitcnt vmcnt(13)
    v_mfma_f32_32x32x16_bf16 v[80:95], v[172:175], v[40:43], v[80:95]
    v_mfma_f32_32x32x16_bf16 v[96:111], v[176:179], v[40:43], v[96:111]
    s_waitcnt vmcnt(12)
    v_mfma_f32_32x32x16_bf16 v[80:95], v[180:183], v[44:47], v[80:95]
    v_mfma_f32_32x32x16_bf16 v[96:111], v[184:187], v[44:47], v[96:111]
    s_waitcnt vmcnt(11)
    v_mfma_f32_32x32x16_bf16 v[80:95], v[188:191], v[48:51], v[80:95]
    v_mfma_f32_32x32x16_bf16 v[96:111], v[192:195], v[48:51], v[96:111]
    s_waitcnt vmcnt(10)
    v_mfma_f32_32x32x16_bf16 v[80:95], v[196:199], v[52:55], v[80:95]
    v_mfma_f32_32x32x16_bf16 v[96:111], v[200:203], v[52:55], v[96:111]
    s_waitcnt vmcnt(9)
    v_mfma_f32_32x32x16_bf16 v[80:95], v[204:207], v[56:59], v[80:95]
    v_mfma_f32_32x32x16_bf16 v[96:111], v[208:211], v[56:59], v[96:111]
    s_waitcnt vmcnt(8)
    v_mfma_f32_32x32x16_bf16 v[80:95], v[212:215], v[60:63], v[80:95]
    v_mfma_f32_32x32x16_bf16 v[96:111], v[216:219], v[60:63], v[96:111]
    s_waitcnt vmcnt(7)
    v_mfma_f32_32x32x16_bf16 v[80:95], v[220:223], v[64:67], v[80:95]
    v_mfma_f32_32x32x16_bf16 v[96:111], v[224:227], v[64:67], v[96:111]
    s_waitcnt vmcnt(6)
    v_mfma_f32_32x32x16_bf16 v[80:95], v[228:231], v[68:71], v[80:95]
    v_mfma_f32_32x32x16_bf16 v[96:111], v[232:235], v[68:71], v[96:111]
    s_waitcnt vmcnt(5)
    v_mfma_f32_32x32x16_bf16 v[80:95], v[236:239], v[72:75], v[80:95]
    v_mfma_f32_32x32x16_bf16 v[96:111], v[240:243], v[72:75], v[96:111]
    s_waitcnt vmcnt(4)
    v_mfma_f32_32x32x16_bf16 v[80:95], v[244:247], v[76:79], v[80:95]
    v_mfma_f32_32x32x16_bf16 v[96:111], v[248:251], v[76:79], v[96:111]
    s_lshl_b32 s26, s8, 12
    s_add_u32 s26, s26, 147456
    v_add_u32 v3, s26, v2
    s_xor_b32 s27, s8, 1
    s_lshl_b32 s30, s27, 12
    s_add_u32 s30, s30, 147456
    v_add_u32 v6, s30, v2
    s_nop 7
    s_nop 1
    s_cmp_lg_u32 s15, 0
    s_cbranch_scc1 L_wo_a_240
    ds_write_b128 v3, v[96:99] offset:0
    ds_write_b128 v3, v[100:103] offset:1024
    ds_write_b128 v3, v[104:107] offset:2048
    ds_write_b128 v3, v[108:111] offset:3072
    v_pk_mov_b32 v[16:17], v[80:81], v[80:81] op_sel:[0,1]
    v_pk_mov_b32 v[18:19], v[82:83], v[82:83] op_sel:[0,1]
    v_pk_mov_b32 v[20:21], v[84:85], v[84:85] op_sel:[0,1]
    v_pk_mov_b32 v[22:23], v[86:87], v[86:87] op_sel:[0,1]
    v_pk_mov_b32 v[24:25], v[88:89], v[88:89] op_sel:[0,1]
    v_pk_mov_b32 v[26:27], v[90:91], v[90:91] op_sel:[0,1]
    v_pk_mov_b32 v[28:29], v[92:93], v[92:93] op_sel:[0,1]
    v_pk_mov_b32 v[30:31], v[94:95], v[94:95] op_sel:[0,1]
    s_branch L_wo_b_241
L_wo_a_240:
    ds_write_b128 v3, v[80:83] offset:0
    ds_write_b128 v3, v[84:87] offset:1024
    ds_write_b128 v3, v[88:91] offset:2048
    ds_write_b128 v3, v[92:95] offset:3072
    v_pk_mov_b32 v[16:17], v[96:97], v[96:97] op_sel:[0,1]
    v_pk_mov_b32 v[18:19], v[98:99], v[98:99] op_sel:[0,1]
    v_pk_mov_b32 v[20:21], v[100:101], v[100:101] op_sel:[0,1]
    v_pk_mov_b32 v[22:23], v[102:103], v[102:103] op_sel:[0,1]
    v_pk_mov_b32 v[24:25], v[104:105], v[104:105] op_sel:[0,1]
    v_pk_mov_b32 v[26:27], v[106:107], v[106:107] op_sel:[0,1]
    v_pk_mov_b32 v[28:29], v[108:109], v[108:109] op_sel:[0,1]
    v_pk_mov_b32 v[30:31], v[110:111], v[110:111] op_sel:[0,1]
L_wo_b_241:
    s_waitcnt lgkmcnt(0)
    s_lshl_b32 s26, s8, 2
    s_add_u32 s26, s26, 137224
    v_mov_b32 v4, s26
    v_mov_b32 v5, 1
    s_mov_b64 exec, 1
    ds_write_b32 v4, v5
    s_mov_b64 exec, -1
    s_waitcnt vmcnt(0)
    v_lshlrev_b32 v48, 16, v8
    v_and_b32 v49, 0xffff0000, v8
    v_lshlrev_b32 v50, 16, v9
    v_and_b32 v51, 0xffff0000, v9
    v_lshlrev_b32 v52, 16, v10
    v_and_b32 v53, 0xffff0000, v10
    v_lshlrev_b32 v54, 16, v11
    v_and_b32 v55, 0xffff0000, v11
    v_lshlrev_b32 v56, 16, v12
    v_and_b32 v57, 0xffff0000, v12
    v_lshlrev_b32 v58, 16, v13
    v_and_b32 v59, 0xffff0000, v13
    v_lshlrev_b32 v60, 16, v14
    v_and_b32 v61, 0xffff0000, v14
    v_lshlrev_b32 v62, 16, v15
    v_and_b32 v63, 0xffff0000, v15
    v_pk_add_f32 v[16:17], v[16:17], v[48:49]
    v_pk_add_f32 v[18:19], v[18:19], v[50:51]
    v_pk_add_f32 v[20:21], v[20:21], v[52:53]
    v_pk_add_f32 v[22:23], v[22:23], v[54:55]
    v_pk_add_f32 v[24:25], v[24:25], v[56:57]
    v_pk_add_f32 v[26:27], v[26:27], v[58:59]
    v_pk_add_f32 v[28:29], v[28:29], v[60:61]
    v_pk_add_f32 v[30:31], v[30:31], v[62:63]
    s_lshl_b32 s27, s27, 2
    s_add_u32 s27, s27, 137224
    v_mov_b32 v4, s27
    s_mov_b32 s29, 0
L_lw_242:
    ds_read_b32 v5, v4
    s_waitcnt lgkmcnt(0)
    v_readfirstlane_b32 s28, v5
    s_nop 0
    s_cmp_ge_u32 s28, 1
    s_cbranch_scc1 L_lwd_243
    s_sleep 2
    s_add_u32 s29, s29, 1
    s_cmp_lt_u32 s29, 262144
    s_cbranch_scc1 L_lw_242
L_lwd_243:
    ds_read_b128 v[32:35], v6 offset:0
    ds_read_b128 v[36:39], v6 offset:1024
    ds_read_b128 v[40:43], v6 offset:2048
    ds_read_b128 v[44:47], v6 offset:3072
    s_waitcnt lgkmcnt(0)
    v_pk_add_f32 v[16:17], v[16:17], v[32:33]
    v_pk_add_f32 v[18:19], v[18:19], v[34:35]
    v_pk_add_f32 v[20:21], v[20:21], v[36:37]
    v_pk_add_f32 v[22:23], v[22:23], v[38:39]
    v_pk_add_f32 v[24:25], v[24:25], v[40:41]
    v_pk_add_f32 v[26:27], v[26:27], v[42:43]
    v_pk_add_f32 v[28:29], v[28:29], v[44:45]
    v_pk_add_f32 v[30:31], v[30:31], v[46:47]
    v_cvt_pk_bf16_f32 v64, v16, v17
    v_cvt_pk_bf16_f32 v65, v18, v19
    v_cvt_pk_bf16_f32 v66, v20, v21
    v_cvt_pk_bf16_f32 v67, v22, v23
    v_cvt_pk_bf16_f32 v68, v24, v25
    v_cvt_pk_bf16_f32 v69, v26, v27
    v_cvt_pk_bf16_f32 v70, v28, v29
    v_cvt_pk_bf16_f32 v71, v30, v31
    s_lshl_b32 s23, s10, 22
    s_add_u32 s23, s23, s22
    s_add_u32 s23, s23, 2097152
    buffer_store_dwordx4 v[64:67], v2, s[4:7], s23 offen sc1
    buffer_store_dwordx4 v[68:71], v2, s[4:7], s23 offen offset:1024 sc1
    v_mov_b32 v76, 0x3f803f80
    v_mov_b32 v72, 0
    v_mov_b32 v73, 0
    s_nop 0
    v_dot2_f32_bf16 v72, v64, v76, v72
    v_dot2_f32_bf16 v73, v64, v64, v73
    v_dot2_f32_bf16 v72, v65, v76, v72
    v_dot2_f32_bf16 v73, v65, v65, v73
    v_dot2_f32_bf16 v72, v66, v76, v72
    v_dot2_f32_bf16 v73, v66, v66, v73
    v_dot2_f32_bf16 v72, v67, v76, v72
    v_dot2_f32_bf16 v73, v67, v67, v73
    v_dot2_f32_bf16 v72, v68, v76, v72
    v_dot2_f32_bf16 v73, v68, v68, v73
    v_dot2_f32_bf16 v72, v69, v76, v72
    v_dot2_f32_bf16 v73, v69, v69, v73
    v_dot2_f32_bf16 v72, v70, v76, v72
    v_dot2_f32_bf16 v73, v70, v70, v73
    v_dot2_f32_bf16 v72, v71, v76, v72
    v_dot2_f32_bf16 v73, v71, v71, v73
    s_nop 2
    v_mov_b32 v74, v72
    v_mov_b32 v75, v73
    s_nop 1
    v_permlane32_swap_b32 v72, v74
    v_permlane32_swap_b32 v73, v75
    s_nop 1
    v_add_f32 v72, v72, v74
    v_add_f32 v73, v73, v75
    s_lshl_b32 s26, s21, 14
    s_lshl_b32 s27, s20, 8
    s_add_u32 s26, s26, s27
    s_lshl_b32 s27, s10, 20
    s_add_u32 s26, s26, s27
    s_add_u32 s26, s26, 48758784
    v_lshlrev_b32 v77, 3, v1
    s_mov_b32 exec_lo, 0xffffffff
    s_mov_b32 exec_hi, 0x0
    buffer_store_dwordx2 v[72:73], v77, s[4:7], s26 offen sc1
    s_mov_b64 exec, -1
    s_waitcnt vmcnt(0)
    v_mov_b32 v4, 137220
    v_mov_b32 v5, 1
    s_mov_b64 exec, 1
    ds_add_u32 v4, v5
    s_mov_b64 exec, -1
    s_setprio 0
    s_branch L_wo_end_233
L_wo_idle_234:
    s_cmp_eq_u32 s8, 7
    s_cbranch_scc1 L_wo_sync_235
    s_cmp_ge_u32 s12, 28
    s_cbranch_scc1 L_wo_end_233
    s_lshr_b32 s30, s12, 1
    s_lshl_b32 s31, s30, 17
    s_add_u32 s31, s31, 10485760
    s_cmp_lg_u32 s8, 4
    s_cbranch_scc1 L_wod_244
    s_mov_b32 m0, 16384
    s_add_u32 s33, s31, 16384
    buffer_load_dwordx4 v2, s[4:7], s33 offen offset:0 lds
    buffer_load_dwordx4 v2, s[4:7], s33 offen offset:1024 lds
    buffer_load_dwordx4 v2, s[4:7], s33 offen offset:2048 lds
    buffer_load_dwordx4 v2, s[4:7], s33 offen offset:3072 lds
    s_waitcnt vmcnt(4)
    s_mov_b32 m0, 114688
    s_add_u32 s33, s31, 114688
    buffer_load_dwordx4 v2, s[4:7], s33 offen offset:0 lds
    buffer_load_dwordx4 v2, s[4:7], s33 offen offset:1024 lds
    buffer_load_dwordx4 v2, s[4:7], s33 offen offset:2048 lds
    buffer_load_dwordx4 v2, s[4:7], s33 offen offset:3072 lds
    s_waitcnt vmcnt(4)
    s_mov_b32 m0, 86016
    s_add_u32 s33, s31, 86016
    buffer_load_dwordx4 v2, s[4:7], s33 offen offset:0 lds
    buffer_load_dwordx4 v2, s[4:7], s33 offen offset:1024 lds
    buffer_load_dwordx4 v2, s[4:7], s33 offen offset:2048 lds
    buffer_load_dwordx4 v2, s[4:7], s33 offen offset:3072 lds
    s_waitcnt vmcnt(4)
    s_mov_b32 m0, 57344
    s_add_u32 s33, s31, 57344
    buffer_load_dwordx4 v2, s[4:7], s33 offen offset:0 lds
    buffer_load_dwordx4 v2, s[4:7], s33 offen offset:1024 lds
    buffer_load_dwordx4 v2, s[4:7], s33 offen offset:2048 lds
    buffer_load_dwordx4 v2, s[4:7], s33 offen offset:3072 lds
    s_waitcnt vmcnt(4)
    s_mov_b32 m0, 28672
    s_add_u32 s33, s31, 28672
    buffer_load_dwordx4 v2, s[4:7], s33 offen offset:0 lds
    buffer_load_dwordx4 v2, s[4:7], s33 offen offset:1024 lds
    buffer_load_dwordx4 v2, s[4:7], s33 offen offset:2048 lds
    buffer_load_dwordx4 v2, s[4:7], s33 offen offset:3072 lds
    s_waitcnt vmcnt(4)
    s_mov_b32 m0, 126976
    s_add_u32 s33, s31, 126976
    buffer_load_dwordx4 v2, s[4:7], s33 offen offset:0 lds
    buffer_load_dwordx4 v2, s[4:7], s33 offen offset:1024 lds
    buffer_load_dwordx4 v2, s[4:7], s33 offen offset:2048 lds
    buffer_load_dwordx4 v2, s[4:7], s33 offen offset:3072 lds
    s_waitcnt vmcnt(4)
    v_mov_b32 v4, 137248
    ds_read_b32 v5, v4
    s_waitcnt lgkmcnt(0)
    v_readfirstlane_b32 s28, v5
    s_nop 0
    s_cmp_eq_u32 s28, 0
    s_cbranch_scc1 L_wob_245
    s_mov_b32 m0, 0
    s_add_u32 s33, s31, 0
    buffer_load_dwordx4 v2, s[4:7], s33 offen offset:0 lds
    buffer_load_dwordx4 v2, s[4:7], s33 offen offset:1024 lds
    buffer_load_dwordx4 v2, s[4:7], s33 offen offset:2048 lds
    buffer_load_dwordx4 v2, s[4:7], s33 offen offset:3072 lds
    s_waitcnt vmcnt(4)
    s_mov_b32 m0, 98304
    s_add_u32 s33, s31, 98304
    buffer_load_dwordx4 v2, s[4:7], s33 offen offset:0 lds
    buffer_load_dwordx4 v2, s[4:7], s33 offen offset:1024 lds
    buffer_load_dwordx4 v2, s[4:7], s33 offen offset:2048 lds
    buffer_load_dwordx4 v2, s[4:7], s33 offen offset:3072 lds
    s_waitcnt vmcnt(4)
    s_mov_b32 m0, 69632
    s_add_u32 s33, s31, 69632
    buffer_load_dwordx4 v2, s[4:7], s33 offen offset:0 lds
    buffer_load_dwordx4 v2, s[4:7], s33 offen offset:1024 lds
    buffer_load_dwordx4 v2, s[4:7], s33 offen offset:2048 lds
    buffer_load_dwordx4 v2, s[4:7], s33 offen offset:3072 lds
    s_waitcnt vmcnt(4)
    s_mov_b32 m0, 40960
    s_add_u32 s33, s31, 40960
    buffer_load_dwordx4 v2, s[4:7], s33 offen offset:0 lds
    buffer_load_dwordx4 v2, s[4:7], s33 offen offset:1024 lds
    buffer_load_dwordx4 v2, s[4:7], s33 offen offset:2048 lds
    buffer_load_dwordx4 v2, s[4:7], s33 offen offset:3072 lds
    s_waitcnt vmcnt(4)
    s_mov_b32 m0, 12288
    s_add_u32 s33, s31, 12288
    buffer_load_dwordx4 v2, s[4:7], s33 offen offset:0 lds
    buffer_load_dwordx4 v2, s[4:7], s33 offen offset:1024 lds
    buffer_load_dwordx4 v2, s[4:7], s33 offen offset:2048 lds
    buffer_load_dwordx4 v2, s[4:7], s33 offen offset:3072 lds
    s_waitcnt vmcnt(4)
    s_mov_b32 m0, 110592
    s_add_u32 s33, s31, 110592
    buffer_load_dwordx4 v2, s[4:7], s33 offen offset:0 lds
    buffer_load_dwordx4 v2, s[4:7], s33 offen offset:1024 lds
    buffer_load_dwordx4 v2, s[4:7], s33 offen offset:2048 lds
    buffer_load_dwordx4 v2, s[4:7], s33 offen offset:3072 lds
    s_waitcnt vmcnt(4)
L_wob_245:
    s_branch L_wo_end_233
L_wod_244:
    s_cmp_lg_u32 s8, 5
    s_cbranch_scc1 L_wod_246
    s_mov_b32 m0, 49152
    s_add_u32 s33, s31, 49152
    buffer_load_dwordx4 v2, s[4:7], s33 offen offset:0 lds
    buffer_load_dwordx4 v2, s[4:7], s33 offen offset:1024 lds
    buffer_load_dwordx4 v2, s[4:7], s33 offen offset:2048 lds
    buffer_load_dwordx4 v2, s[4:7], s33 offen offset:3072 lds
    s_waitcnt vmcnt(4)
    s_mov_b32 m0, 20480
    s_add_u32 s33, s31, 20480
    buffer_load_dwordx4 v2, s[4:7], s33 offen offset:0 lds
    buffer_load_dwordx4 v2, s[4:7], s33 offen offset:1024 lds
    buffer_load_dwordx4 v2, s[4:7], s33 offen offset:2048 lds
    buffer_load_dwordx4 v2, s[4:7], s33 offen offset:3072 lds
    s_waitcnt vmcnt(4)
    s_mov_b32 m0, 118784
    s_add_u32 s33, s31, 118784
    buffer_load_dwordx4 v2, s[4:7], s33 offen offset:0 lds
    buffer_load_dwordx4 v2, s[4:7], s33 offen offset:1024 lds
    buffer_load_dwordx4 v2, s[4:7], s33 offen offset:2048 lds
    buffer_load_dwordx4 v2, s[4:7], s33 offen offset:3072 lds
    s_waitcnt vmcnt(4)
    s_mov_b32 m0, 90112
    s_add_u32 s33, s31, 90112
    buffer_load_dwordx4 v2, s[4:7], s33 offen offset:0 lds
    buffer_load_dwordx4 v2, s[4:7], s33 offen offset:1024 lds
    buffer_load_dwordx4 v2, s[4:7], s33 offen offset:2048 lds
    buffer_load_dwordx4 v2, s[4:7], s33 offen offset:3072 lds
    s_waitcnt vmcnt(4)
    s_mov_b32 m0, 61440
    s_add_u32 s33, s31, 61440
    buffer_load_dwordx4 v2, s[4:7], s33 offen offset:0 lds
    buffer_load_dwordx4 v2, s[4:7], s33 offen offset:1024 lds
    buffer_load_dwordx4 v2, s[4:7], s33 offen offset:2048 lds
    buffer_load_dwordx4 v2, s[4:7], s33 offen offset:3072 lds
    s_waitcnt vmcnt(4)
    v_mov_b32 v4, 137248
    ds_read_b32 v5, v4
    s_waitcnt lgkmcnt(0)
    v_readfirstlane_b32 s28, v5
    s_nop 0
    s_cmp_eq_u32 s28, 0
    s_cbranch_scc1 L_wob_247
    s_mov_b32 m0, 32768
    s_add_u32 s33, s31, 32768
    buffer_load_dwordx4 v2, s[4:7], s33 offen offset:0 lds
    buffer_load_dwordx4 v2, s[4:7], s33 offen offset:1024 lds
    buffer_load_dwordx4 v2, s[4:7], s33 offen offset:2048 lds
    buffer_load_dwordx4 v2, s[4:7], s33 offen offset:3072 lds
    s_waitcnt vmcnt(4)
    s_mov_b32 m0, 4096
    s_add_u32 s33, s31, 4096
    buffer_load_dwordx4 v2, s[4:7], s33 offen offset:0 lds
    buffer_load_dwordx4 v2, s[4:7], s33 offen offset:1024 lds
    buffer_load_dwordx4 v2, s[4:7], s33 offen offset:2048 lds
    buffer_load_dwordx4 v2, s[4:7], s33 offen offset:3072 lds
    s_waitcnt vmcnt(4)
    s_mov_b32 m0, 102400
    s_add_u32 s33, s31, 102400
    buffer_load_dwordx4 v2, s[4:7], s33 offen offset:0 lds
    buffer_load_dwordx4 v2, s[4:7], s33 offen offset:1024 lds
    buffer_load_dwordx4 v2, s[4:7], s33 offen offset:2048 lds
    buffer_load_dwordx4 v2, s[4:7], s33 offen offset:3072 lds
    s_waitcnt vmcnt(4)
    s_mov_b32 m0, 73728
    s_add_u32 s33, s31, 73728
    buffer_load_dwordx4 v2, s[4:7], s33 offen offset:0 lds
    buffer_load_dwordx4 v2, s[4:7], s33 offen offset:1024 lds
    buffer_load_dwordx4 v2, s[4:7], s33 offen offset:2048 lds
    buffer_load_dwordx4 v2, s[4:7], s33 offen offset:3072 lds
    s_waitcnt vmcnt(4)
    s_mov_b32 m0, 45056
    s_add_u32 s33, s31, 45056
    buffer_load_dwordx4 v2, s[4:7], s33 offen offset:0 lds
    buffer_load_dwordx4 v2, s[4:7], s33 offen offset:1024 lds
    buffer_load_dwordx4 v2, s[4:7], s33 offen offset:2048 lds
    buffer_load_dwordx4 v2, s[4:7], s33 offen offset:3072 lds
    s_waitcnt vmcnt(4)
L_wob_247:
    s_branch L_wo_end_233
L_wod_246:
    s_cmp_lg_u32 s8, 6
    s_cbranch_scc1 L_wod_248
    s_mov_b32 m0, 81920
    s_add_u32 s33, s31, 81920
    buffer_load_dwordx4 v2, s[4:7], s33 offen offset:0 lds
    buffer_load_dwordx4 v2, s[4:7], s33 offen offset:1024 lds
    buffer_load_dwordx4 v2, s[4:7], s33 offen offset:2048 lds
    buffer_load_dwordx4 v2, s[4:7], s33 offen offset:3072 lds
    s_waitcnt vmcnt(4)
    s_mov_b32 m0, 53248
    s_add_u32 s33, s31, 53248
    buffer_load_dwordx4 v2, s[4:7], s33 offen offset:0 lds
    buffer_load_dwordx4 v2, s[4:7], s33 offen offset:1024 lds
    buffer_load_dwordx4 v2, s[4:7], s33 offen offset:2048 lds
    buffer_load_dwordx4 v2, s[4:7], s33 offen offset:3072 lds
    s_waitcnt vmcnt(4)
    s_mov_b32 m0, 24576
    s_add_u32 s33, s31, 24576
    buffer_load_dwordx4 v2, s[4:7], s33 offen offset:0 lds
    buffer_load_dwordx4 v2, s[4:7], s33 offen offset:1024 lds
    buffer_load_dwordx4 v2, s[4:7], s33 offen offset:2048 lds
    buffer_load_dwordx4 v2, s[4:7], s33 offen offset:3072 lds
    s_waitcnt vmcnt(4)
    s_mov_b32 m0, 122880
    s_add_u32 s33, s31, 122880
    buffer_load_dwordx4 v2, s[4:7], s33 offen offset:0 lds
    buffer_load_dwordx4 v2, s[4:7], s33 offen offset:1024 lds
    buffer_load_dwordx4 v2, s[4:7], s33 offen offset:2048 lds
    buffer_load_dwordx4 v2, s[4:7], s33 offen offset:3072 lds
    s_waitcnt vmcnt(4)
    s_mov_b32 m0, 94208
    s_add_u32 s33, s31, 94208
    buffer_load_dwordx4 v2, s[4:7], s33 offen offset:0 lds
    buffer_load_dwordx4 v2, s[4:7], s33 offen offset:1024 lds
    buffer_load_dwordx4 v2, s[4:7], s33 offen offset:2048 lds
    buffer_load_dwordx4 v2, s[4:7], s33 offen offset:3072 lds
    s_waitcnt vmcnt(4)
    v_mov_b32 v4, 137248
    ds_read_b32 v5, v4
    s_waitcnt lgkmcnt(0)
    v_readfirstlane_b32 s28, v5
    s_nop 0
    s_cmp_eq_u32 s28, 0
    s_cbranch_scc1 L_wob_249
    s_mov_b32 m0, 65536
    s_add_u32 s33, s31, 65536
    buffer_load_dwordx4 v2, s[4:7], s33 offen offset:0 lds
    buffer_load_dwordx4 v2, s[4:7], s33 offen offset:1024 lds
    buffer_load_dwordx4 v2, s[4:7], s33 offen offset:2048 lds
    buffer_load_dwordx4 v2, s[4:7], s33 offen offset:3072 lds
    s_waitcnt vmcnt(4)
    s_mov_b32 m0, 36864
    s_add_u32 s33, s31, 36864
    buffer_load_dwordx4 v2, s[4:7], s33 offen offset:0 lds
    buffer_load_dwordx4 v2, s[4:7], s33 offen offset:1024 lds
    buffer_load_dwordx4 v2, s[4:7], s33 offen offset:2048 lds
    buffer_load_dwordx4 v2, s[4:7], s33 offen offset:3072 lds
    s_waitcnt vmcnt(4)
    s_mov_b32 m0, 8192
    s_add_u32 s33, s31, 8192
    buffer_load_dwordx4 v2, s[4:7], s33 offen offset:0 lds
    buffer_load_dwordx4 v2, s[4:7], s33 offen offset:1024 lds
    buffer_load_dwordx4 v2, s[4:7], s33 offen offset:2048 lds
    buffer_load_dwordx4 v2, s[4:7], s33 offen offset:3072 lds
    s_waitcnt vmcnt(4)
    s_mov_b32 m0, 106496
    s_add_u32 s33, s31, 106496
    buffer_load_dwordx4 v2, s[4:7], s33 offen offset:0 lds
    buffer_load_dwordx4 v2, s[4:7], s33 offen offset:1024 lds
    buffer_load_dwordx4 v2, s[4:7], s33 offen offset:2048 lds
    buffer_load_dwordx4 v2, s[4:7], s33 offen offset:3072 lds
    s_waitcnt vmcnt(4)
    s_mov_b32 m0, 77824
    s_add_u32 s33, s31, 77824
    buffer_load_dwordx4 v2, s[4:7], s33 offen offset:0 lds
    buffer_load_dwordx4 v2, s[4:7], s33 offen offset:1024 lds
    buffer_load_dwordx4 v2, s[4:7], s33 offen offset:2048 lds
    buffer_load_dwordx4 v2, s[4:7], s33 offen offset:3072 lds
    s_waitcnt vmcnt(4)
L_wob_249:
    s_branch L_wo_end_233
L_wod_248:
    s_branch L_wo_end_233
L_wo_sync_235:
    v_lshrrev_b32 v4, 2, v1
    v_lshlrev_b32 v4, 5, v4
    v_and_b32 v5, 3, v1
    s_lshl_b32 s19, s11, 2
    v_add3_u32 v4, v4, v5, s19
    s_mul_i32 s19, s10, 5
    s_add_u32 s19, s19, 2
    s_add_u32 s21, s9, s19
    s_lshl_b32 s20, s19, 15
    s_add_u32 s20, s20, 51380224
    v_lshlrev_b32 v4, 7, v4
    s_mov_b32 exec_lo, 0xffffffff
    s_mov_b32 exec_hi, 0x0
    s_mov_b32 s22, 0
L_poll_250:
    buffer_load_dword v5, v4, s[4:7], s20 offen sc1
    s_waitcnt vmcnt(0)
    v_cmp_ne_u32 vcc, s21, v5
    s_cmp_eq_u64 vcc, 0
    s_cbranch_scc1 L_polld_251
    s_sleep 1
    s_add_u32 s22, s22, 1
    s_cmp_lt_u32 s22, 262144
    s_cbranch_scc1 L_poll_250
L_polld_251:
    s_mov_b64 exec, -1
    v_mov_b32 v6, 137240
    v_mov_b32 v7, 1
    s_mov_b64 exec, 1
    ds_add_u32 v6, v7
    s_mov_b64 exec, -1
    s_mul_i32 s35, s10, 5
    s_add_u32 s35, s35, 3
    s_add_u32 s34, s9, s35
    s_lshl_b32 s35, s35, 8
    s_add_u32 s35, s35, s36
    s_lshl_b32 s35, s35, 7
    s_add_u32 s35, s35, 51380224
    v_mov_b32 v4, 137220
    s_mov_b32 s29, 0
L_lw_252:
    ds_read_b32 v5, v4
    s_waitcnt lgkmcnt(0)
    v_readfirstlane_b32 s28, v5
    s_nop 0
    s_cmp_ge_u32 s28, 4
    s_cbranch_scc1 L_lwd_253
    s_sleep 2
    s_add_u32 s29, s29, 1
    s_cmp_lt_u32 s29, 262144
    s_cbranch_scc1 L_lw_252
L_lwd_253:
    v_mov_b32 v4, s34
    v_mov_b32 v5, 0
    s_mov_b64 exec, 1
    s_cmp_eq_u32 s3, 0
    s_cbranch_scc1 L_sg_254
    buffer_store_dword v4, v5, s[4:7], s35 offen
    s_branch L_sg_255
L_sg_254:
    buffer_store_dword v4, v5, s[4:7], s35 offen sc1
L_sg_255:
    s_mov_b64 exec, -1
L_wo_end_233:
    s_cmp_ge_u32 s12, 28
    s_cbranch_scc1 L_ga_skip_256
    s_and_b32 s13, s12, 1
    s_lshl_b32 s14, s11, 1
    s_add_u32 s13, s13, s14
    s_lshr_b32 s14, s12, 1
    s_cmp_lg_u32 s8, 4
    s_cbranch_scc1 L_w_257
    s_mul_i32 s18, s14, 512
    s_add_u32 s18, s18, 50364416
    v_lshlrev_b32 v4, 2, v1
    buffer_load_dword v8, v4, s[4:7], s18 offen
    buffer_load_dword v9, v4, s[4:7], s18 offen offset:256
    s_add_u32 s18, s18, 7168
    buffer_load_dword v10, v4, s[4:7], s18 offen
    buffer_load_dword v11, v4, s[4:7], s18 offen offset:256
    s_add_u32 s18, s18, 7168
    buffer_load_dword v12, v4, s[4:7], s18 offen
    buffer_load_dword v13, v4, s[4:7], s18 offen offset:256
    s_add_u32 s18, s18, 7168
    buffer_load_dword v14, v4, s[4:7], s18 offen
    buffer_load_dword v15, v4, s[4:7], s18 offen offset:256
    s_waitcnt vmcnt(0)
    v_pk_add_f32 v[8:9], v[8:9], v[10:11]
    v_pk_add_f32 v[12:13], v[12:13], v[14:15]
    v_pk_add_f32 v[8:9], v[8:9], v[12:13]
    v_add_u32 v4, 139264, v4
    ds_write_b32 v4, v8
    ds_write_b32 v4, v9 offset:256
    s_waitcnt lgkmcnt(0)
L_w_257:
    s_cmp_lg_u32 s8, 7
    s_cbranch_scc1 L_w_258
    s_and_b32 s19, s12, 1
    s_lshl_b32 s19, s19, 1
    s_lshl_b32 s23, s11, 5
    s_add_u32 s19, s19, s23
    v_lshrrev_b32 v4, 1, v1
    v_lshlrev_b32 v4, 2, v4
    v_and_b32 v5, 1, v1
    v_add3_u32 v4, v4, v5, s19
    s_mul_i32 s19, s10, 5
    s_add_u32 s19, s19, 3
    s_add_u32 s21, s9, s19
    s_lshl_b32 s20, s19, 15
    s_add_u32 s20, s20, 51380224
    v_lshlrev_b32 v4, 7, v4
    s_mov_b32 exec_lo, 0xffff
    s_mov_b32 exec_hi, 0x0
    s_mov_b32 s22, 0
L_poll_259:
    buffer_load_dword v5, v4, s[4:7], s20 offen sc1
    s_waitcnt vmcnt(0)
    v_cmp_ne_u32 vcc, s21, v5
    s_cmp_eq_u64 vcc, 0
    s_cbranch_scc1 L_polld_260
    s_sleep 1
    s_add_u32 s22, s22, 1
    s_cmp_lt_u32 s22, 262144
    s_cbranch_scc1 L_poll_259
L_polld_260:
    s_mov_b64 exec, -1
L_w_258:
    s_waitcnt vmcnt(0)
    s_barrier
    s_cmp_lt_u32 s8, 4
    s_cbranch_scc1 L_ga_comp_261
    s_lshl_b32 s15, s13, 2
    s_add_u32 s15, s15, s8
    s_sub_u32 s15, s15, 4
    s_lshl_b32 s19, s10, 20
    s_add_u32 s19, s19, 48758784
    v_lshrrev_b32 v8, 5, v1
    v_mul_u32_u24 v8, 131072, v8
    v_and_b32 v16, 31, v1
    v_lshl_add_u32 v8, v16, 3, v8
    s_lshl_b32 s18, s15, 8
    s_add_u32 s18, s18, s19
    buffer_load_dwordx2 v[16:17], v8, s[4:7], s18 offen
    s_add_u32 s18, s18, 16384
    buffer_load_dwordx2 v[18:19], v8, s[4:7], s18 offen
    s_add_u32 s18, s18, 16384
    buffer_load_dwordx2 v[20:21], v8, s[4:7], s18 offen
    s_add_u32 s18, s18, 16384
    buffer_load_dwordx2 v[22:23], v8, s[4:7], s18 offen
    s_add_u32 s18, s18, 16384
    buffer_load_dwordx2 v[24:25], v8, s[4:7], s18 offen
    s_add_u32 s18, s18, 16384
    buffer_load_dwordx2 v[26:27], v8, s[4:7], s18 offen
    s_add_u32 s18, s18, 16384
    buffer_load_dwordx2 v[28:29], v8, s[4:7], s18 offen
    s_add_u32 s18, s18, 16384
    buffer_load_dwordx2 v[30:31], v8, s[4:7], s18 offen
    s_waitcnt vmcnt(0)
    v_pk_add_f32 v[16:17], v[16:17], v[18:19]
    v_pk_add_f32 v[16:17], v[16:17], v[20:21]
    v_pk_add_f32 v[16:17], v[16:17], v[22:23]
    v_pk_add_f32 v[16:17], v[16:17], v[24:25]
    v_pk_add_f32 v[16:17], v[16:17], v[26:27]
    v_pk_add_f32 v[16:17], v[16:17], v[28:29]
    v_pk_add_f32 v[16:17], v[16:17], v[30:31]
    v_mov_b32 v18, v16
    v_mov_b32 v19, v17
    s_nop 1
    v_permlane32_swap_b32 v16, v18
    v_permlane32_swap_b32 v17, v19
    s_nop 1
    v_add_f32 v16, v16, v18
    v_add_f32 v17, v17, v19
    v_mul_f32 v10, 0xbb000000, v16
    v_mul_f32 v17, 0x3b000000, v17
    v_fma_f32 v17, -v10, v10, v17
    v_max_f32 v17, 0, v17
    v_add_f32 v17, 0x3727c5ac, v17
    v_rsq_f32 v11, v17
    s_nop 0
    s_sub_u32 s20, s8, 4
    s_lshl_b32 s20, s20, 8
    s_add_u32 s20, s20, 139776
    v_and_b32 v12, 31, v1
    v_lshlrev_b32 v12, 3, v12
    v_add_u32 v12, s20, v12
    ds_write_b64 v12, v[10:11]
    s_waitcnt lgkmcnt(0)
    s_barrier
    s_branch L_ga_end_262
L_ga_comp_261:
    s_setprio 2
    v_add_u32 v3, 0x10000, v2
    s_lshl_b32 s15, s13, 2
    s_add_u32 s15, s15, s8
    s_lshl_b32 s16, s10, 22
    s_add_u32 s16, s16, 2097152
    s_lshl_b32 s17, s15, 15
    s_add_u32 s16, s16, s17
    buffer_load_dwordx4 v[16:19], v2, s[4:7], s16 offen offset:0
    buffer_load_dwordx4 v[20:23], v2, s[4:7], s16 offen offset:1024
    buffer_load_dwordx4 v[24:27], v2, s[4:7], s16 offen offset:2048
    buffer_load_dwordx4 v[28:31], v2, s[4:7], s16 offen offset:3072
    ds_read_b128 v[144:147], v2 offset:0
    ds_read_b128 v[148:151], v2 offset:32768
    ds_read_b128 v[152:155], v3 offset:0
    ds_read_b128 v[156:159], v3 offset:32768
    ds_read_b128 v[160:163], v2 offset:1024
    ds_read_b128 v[164:167], v2 offset:33792
    ds_read_b128 v[168:171], v3 offset:1024
    ds_read_b128 v[172:175], v3 offset:33792
    s_add_u32 s16, s16, 4096
    buffer_load_dwordx4 v[32:35], v2, s[4:7], s16 offen offset:0
    buffer_load_dwordx4 v[36:39], v2, s[4:7], s16 offen offset:1024
    buffer_load_dwordx4 v[40:43], v2, s[4:7], s16 offen offset:2048
    buffer_load_dwordx4 v[44:47], v2, s[4:7], s16 offen offset:3072
    s_add_u32 s16, s16, 4096
    buffer_load_dwordx4 v[48:51], v2, s[4:7], s16 offen offset:0
    s_waitcnt vmcnt(8) lgkmcnt(4)
    v_mfma_f32_32x32x16_bf16 v[80:95], v[144:147], v[16:19], 0
    ds_read_b128 v[176:179], v2 offset:2048
    v_mfma_f32_32x32x16_bf16 v[96:111], v[148:151], v[16:19], 0
    ds_read_b128 v[180:183], v2 offset:34816
    v_mfma_f32_32x32x16_bf16 v[112:127], v[152:155], v[16:19], 0
    ds_read_b128 v[184:187], v3 offset:2048
    v_mfma_f32_32x32x16_bf16 v[128:143], v[156:159], v[16:19], 0
    ds_read_b128 v[188:191], v3 offset:34816
    s_waitcnt vmcnt(7) lgkmcnt(4)
    v_mfma_f32_32x32x16_bf16 v[80:95], v[160:163], v[20:23], v[80:95]
    ds_read_b128 v[144:147], v2 offset:3072
    v_mfma_f32_32x32x16_bf16 v[96:111], v[164:167], v[20:23], v[96:111]
    ds_read_b128 v[148:151], v2 offset:35840
    buffer_load_dwordx4 v[52:55], v2, s[4:7], s16 offen offset:1024
    v_mfma_f32_32x32x16_bf16 v[112:127], v[168:171], v[20:23], v[112:127]
    ds_read_b128 v[152:155], v3 offset:3072
    v_mfma_f32_32x32x16_bf16 v[128:143], v[172:175], v[20:23], v[128:143]
    ds_read_b128 v[156:159], v3 offset:35840
    s_waitcnt vmcnt(7) lgkmcnt(4)
    v_mfma_f32_32x32x16_bf16 v[80:95], v[176:179], v[24:27], v[80:95]
    ds_read_b128 v[160:163], v2 offset:4096
    v_mfma_f32_32x32x16_bf16 v[96:111], v[180:183], v[24:27], v[96:111]
    ds_read_b128 v[164:167], v2 offset:36864
    buffer_load_dwordx4 v[56:59], v2, s[4:7], s16 offen offset:2048
    v_mfma_f32_32x32x16_bf16 v[112:127], v[184:187], v[24:27], v[112:127]
    ds_read_b128 v[168:171], v3 offset:4096
    v_mfma_f32_32x32x16_bf16 v[128:143], v[188:191], v[24:27], v[128:143]
    ds_read_b128 v[172:175], v3 offset:36864
    s_waitcnt vmcnt(7) lgkmcnt(4)
    v_mfma_f32_32x32x16_bf16 v[80:95], v[144:147], v[28:31], v[80:95]
    ds_read_b128 v[176:179], v2 offset:5120
    v_mfma_f32_32x32x16_bf16 v[96:111], v[148:151], v[28:31], v[96:111]
    ds_read_b128 v[180:183], v2 offset:37888
    buffer_load_dwordx4 v[60:63], v2, s[4:7], s16 offen offset:3072
    v_mfma_f32_32x32x16_bf16 v[112:127], v[152:155], v[28:31], v[112:127]
    ds_read_b128 v[184:187], v3 offset:5120
    v_mfma_f32_32x32x16_bf16 v[128:143], v[156:159], v[28:31], v[128:143]
    ds_read_b128 v[188:191], v3 offset:37888
    s_waitcnt vmcnt(7) lgkmcnt(4)
    v_mfma_f32_32x32x16_bf16 v[80:95], v[160:163], v[32:35], v[80:95]
    ds_read_b128 v[144:147], v2 offset:6144
    v_mfma_f32_32x32x16_bf16 v[96:111], v[164:167], v[32:35], v[96:111]
    ds_read_b128 v[148:151], v2 offset:38912
    s_add_u32 s16, s16, 4096
    buffer_load_dwordx4 v[64:67], v2, s[4:7], s16 offen offset:0
    v_mfma_f32_32x32x16_bf16 v[112:127], v[168:171], v[32:35], v[112:127]
    ds_read_b128 v[152:155], v3 offset:6144
    v_mfma_f32_32x32x16_bf16 v[128:143], v[172:175], v[32:35], v[128:143]
    ds_read_b128 v[156:159], v3 offset:38912
    s_waitcnt vmcnt(7) lgkmcnt(4)
    v_mfma_f32_32x32x16_bf16 v[80:95], v[176:179], v[36:39], v[80:95]
    ds_read_b128 v[160:163], v2 offset:7168
    v_mfma_f32_32x32x16_bf16 v[96:111], v[180:183], v[36:39], v[96:111]
    ds_read_b128 v[164:167], v2 offset:39936
    buffer_load_dwordx4 v[68:71], v2, s[4:7], s16 offen offset:1024
    v_mfma_f32_32x32x16_bf16 v[112:127], v[184:187], v[36:39], v[112:127]
    ds_read_b128 v[168:171], v3 offset:7168
    v_mfma_f32_32x32x16_bf16 v[128:143], v[188:191], v[36:39], v[128:143]
    ds_read_b128 v[172:175], v3 offset:39936
    s_waitcnt vmcnt(7) lgkmcnt(4)
    v_mfma_f32_32x32x16_bf16 v[80:95], v[144:147], v[40:43], v[80:95]
    ds_read_b128 v[176:179], v2 offset:8192
    v_mfma_f32_32x32x16_bf16 v[96:111], v[148:151], v[40:43], v[96:111]
    ds_read_b128 v[180:183], v2 offset:40960
    buffer_load_dwordx4 v[72:75], v2, s[4:7], s16 offen offset:2048
    v_mfma_f32_32x32x16_bf16 v[112:127], v[152:155], v[40:43], v[112:127]
    ds_read_b128 v[184:187], v3 offset:8192
    v_mfma_f32_32x32x16_bf16 v[128:143], v[156:159], v[40:43], v[128:143]
    ds_read_b128 v[188:191], v3 offset:40960
    s_waitcnt vmcnt(7) lgkmcnt(4)
    v_mfma_f32_32x32x16_bf16 v[80:95], v[160:163], v[44:47], v[80:95]
    ds_read_b128 v[144:147], v2 offset:9216
    v_mfma_f32_32x32x16_bf16 v[96:111], v[164:167], v[44:47], v[96:111]
    ds_read_b128 v[148:151], v2 offset:41984
    buffer_load_dwordx4 v[76:79], v2, s[4:7], s16 offen offset:3072
    v_mfma_f32_32x32x16_bf16 v[112:127], v[168:171], v[44:47], v[112:127]
    ds_read_b128 v[152:155], v3 offset:9216
    v_mfma_f32_32x32x16_bf16 v[128:143], v[172:175], v[44:47], v[128:143]
    ds_read_b128 v[156:159], v3 offset:41984
    s_waitcnt vmcnt(7) lgkmcnt(4)
    v_mfma_f32_32x32x16_bf16 v[80:95], v[176:179], v[48:51], v[80:95]
    ds_read_b128 v[160:163], v2 offset:10240
    v_mfma_f32_32x32x16_bf16 v[96:111], v[180:183], v[48:51], v[96:111]
    ds_read_b128 v[164:167], v2 offset:43008
    s_add_u32 s16, s16, 4096
    buffer_load_dwordx4 v[16:19], v2, s[4:7], s16 offen offset:0
    v_mfma_f32_32x32x16_bf16 v[112:127], v[184:187], v[48:51], v[112:127]
    ds_read_b128 v[168:171], v3 offset:10240
    v_mfma_f32_32x32x16_bf16 v[128:143], v[188:191], v[48:51], v[128:143]
    ds_read_b128 v[172:175], v3 offset:43008
    s_lshr_b32 s40, s12, 2
    s_mul_i32 s41, s8, 12288
    s_mul_i32 s40, s40, 229376
    s_add_u32 s40, s40, s41
    s_add_u32 s40, s40, 12582912
    s_add_u32 s41, s40, 114688
    s_waitcnt vmcnt(7) lgkmcnt(4)
    v_mfma_f32_32x32x16_bf16 v[80:95], v[144:147], v[52:55], v[80:95]
    ds_read_b128 v[176:179], v2 offset:11264
    v_mfma_f32_32x32x16_bf16 v[96:111], v[148:151], v[52:55], v[96:111]
    ds_read_b128 v[180:183], v2 offset:44032
    buffer_load_dwordx4 v[20:23], v2, s[4:7], s16 offen offset:1024
    v_mfma_f32_32x32x16_bf16 v[112:127], v[152:155], v[52:55], v[112:127]
    ds_read_b128 v[184:187], v3 offset:11264
    v_mfma_f32_32x32x16_bf16 v[128:143], v[156:159], v[52:55], v[128:143]
    ds_read_b128 v[188:191], v3 offset:44032
    s_add_u32 s42, s40, 0
    buffer_load_dwordx4 v[196:199], v2, s[4:7], s42 offen offset:0
    s_waitcnt vmcnt(8) lgkmcnt(4)
    v_mfma_f32_32x32x16_bf16 v[80:95], v[160:163], v[56:59], v[80:95]
    ds_read_b128 v[144:147], v2 offset:12288
    v_mfma_f32_32x32x16_bf16 v[96:111], v[164:167], v[56:59], v[96:111]
    ds_read_b128 v[148:151], v2 offset:45056
    buffer_load_dwordx4 v[24:27], v2, s[4:7], s16 offen offset:2048
    v_mfma_f32_32x32x16_bf16 v[112:127], v[168:171], v[56:59], v[112:127]
    ds_read_b128 v[152:155], v3 offset:12288
    v_mfma_f32_32x32x16_bf16 v[128:143], v[172:175], v[56:59], v[128:143]
    ds_read_b128 v[156:159], v3 offset:45056
    s_add_u32 s42, s41, 0
    buffer_load_dwordx4 v[200:203], v2, s[4:7], s42 offen offset:0
    s_waitcnt vmcnt(9) lgkmcnt(4)
    v_mfma_f32_32x32x16_bf16 v[80:95], v[176:179], v[60:63], v[80:95]
    ds_read_b128 v[160:163], v2 offset:13312
    v_mfma_f32_32x32x16_bf16 v[96:111], v[180:183], v[60:63], v[96:111]
    ds_read_b128 v[164:167], v2 offset:46080
    buffer_load_dwordx4 v[28:31], v2, s[4:7], s16 offen offset:3072
    v_mfma_f32_32x32x16_bf16 v[112:127], v[184:187], v[60:63], v[112:127]
    ds_read_b128 v[168:171], v3 offset:13312
    v_mfma_f32_32x32x16_bf16 v[128:143], v[188:191], v[60:63], v[128:143]
    ds_read_b128 v[172:175], v3 offset:46080
    s_add_u32 s42, s40, 0
    buffer_load_dwordx4 v[204:207], v2, s[4:7], s42 offen offset:1024
    s_waitcnt vmcnt(10) lgkmcnt(4)
    v_mfma_f32_32x32x16_bf16 v[80:95], v[144:147], v[64:67], v[80:95]
    ds_read_b128 v[176:179], v2 offset:14336
    v_mfma_f32_32x32x16_bf16 v[96:111], v[148:151], v[64:67], v[96:111]
    ds_read_b128 v[180:183], v2 offset:47104
    s_add_u32 s16, s16, 4096
    buffer_load_dwordx4 v[32:35], v2, s[4:7], s16 offen offset:0
    v_mfma_f32_32x32x16_bf16 v[112:127], v[152:155], v[64:67], v[112:127]
    ds_read_b128 v[184:187], v3 offset:14336
    v_mfma_f32_32x32x16_bf16 v[128:143], v[156:159], v[64:67], v[128:143]
    ds_read_b128 v[188:191], v3 offset:47104
    s_add_u32 s42, s41, 0
    buffer_load_dwordx4 v[208:211], v2, s[4:7], s42 offen offset:1024
    s_waitcnt vmcnt(11) lgkmcnt(4)
    v_mfma_f32_32x32x16_bf16 v[80:95], v[160:163], v[68:71], v[80:95]
    ds_read_b128 v[144:147], v2 offset:15360
    v_mfma_f32_32x32x16_bf16 v[96:111], v[164:167], v[68:71], v[96:111]
    ds_read_b128 v[148:151], v2 offset:48128
    buffer_load_dwordx4 v[36:39], v2, s[4:7], s16 offen offset:1024
    v_mfma_f32_32x32x16_bf16 v[112:127], v[168:171], v[68:71], v[112:127]
    ds_read_b128 v[152:155], v3 offset:15360
    v_mfma_f32_32x32x16_bf16 v[128:143], v[172:175], v[68:71], v[128:143]
    ds_read_b128 v[156:159], v3 offset:48128
    s_add_u32 s42, s40, 0
    buffer_load_dwordx4 v[212:215], v2, s[4:7], s42 offen offset:2048
    s_waitcnt vmcnt(12) lgkmcnt(4)
    v_mfma_f32_32x32x16_bf16 v[80:95], v[176:179], v[72:75], v[80:95]
    ds_read_b128 v[160:163], v2 offset:16384
    v_mfma_f32_32x32x16_bf16 v[96:111], v[180:183], v[72:75], v[96:111]
    ds_read_b128 v[164:167], v2 offset:49152
    buffer_load_dwordx4 v[40:43], v2, s[4:7], s16 offen offset:2048
    v_mfma_f32_32x32x16_bf16 v[112:127], v[184:187], v[72:75], v[112:127]
    ds_read_b128 v[168:171], v3 offset:16384
    v_mfma_f32_32x32x16_bf16 v[128:143], v[188:191], v[72:75], v[128:143]
    ds_read_b128 v[172:175], v3 offset:49152
    s_add_u32 s42, s41, 0
    buffer_load_dwordx4 v[216:219], v2, s[4:7], s42 offen offset:2048
    s_waitcnt vmcnt(13) lgkmcnt(4)
    v_mfma_f32_32x32x16_bf16 v[80:95], v[144:147], v[76:79], v[80:95]
    ds_read_b128 v[176:179], v2 offset:17408
    v_mfma_f32_32x32x16_bf16 v[96:111], v[148:151], v[76:79], v[96:111]
    ds_read_b128 v[180:183], v2 offset:50176
    buffer_load_dwordx4 v[44:47], v2, s[4:7], s16 offen offset:3072
    v_mfma_f32_32x32x16_bf16 v[112:127], v[152:155], v[76:79], v[112:127]
    ds_read_b128 v[184:187], v3 offset:17408
    v_mfma_f32_32x32x16_bf16 v[128:143], v[156:159], v[76:79], v[128:143]
    ds_read_b128 v[188:191], v3 offset:50176
    s_add_u32 s42, s40, 0
    buffer_load_dwordx4 v[220:223], v2, s[4:7], s42 offen offset:3072
    s_waitcnt vmcnt(14) lgkmcnt(4)
    v_mfma_f32_32x32x16_bf16 v[80:95], v[160:163], v[16:19], v[80:95]
    ds_read_b128 v[144:147], v2 offset:18432
    v_mfma_f32_32x32x16_bf16 v[96:111], v[164:167], v[16:19], v[96:111]
    ds_read_b128 v[148:151], v2 offset:51200
    s_add_u32 s16, s16, 4096
    buffer_load_dwordx4 v[48:51], v2, s[4:7], s16 offen offset:0
    v_mfma_f32_32x32x16_bf16 v[112:127], v[168:171], v[16:19], v[112:127]
    ds_read_b128 v[152:155], v3 offset:18432
    v_mfma_f32_32x32x16_bf16 v[128:143], v[172:175], v[16:19], v[128:143]
    ds_read_b128 v[156:159], v3 offset:51200
    s_add_u32 s42, s41, 0
    buffer_load_dwordx4 v[224:227], v2, s[4:7], s42 offen offset:3072
    s_waitcnt vmcnt(15) lgkmcnt(4)
    v_mfma_f32_32x32x16_bf16 v[80:95], v[176:179], v[20:23], v[80:95]
    ds_read_b128 v[160:163], v2 offset:19456
    v_mfma_f32_32x32x16_bf16 v[96:111], v[180:183], v[20:23], v[96:111]
    ds_read_b128 v[164:167], v2 offset:52224
    buffer_load_dwordx4 v[52:55], v2, s[4:7], s16 offen offset:1024
    v_mfma_f32_32x32x16_bf16 v[112:127], v[184:187], v[20:23], v[112:127]
    ds_read_b128 v[168:171], v3 offset:19456
    v_mfma_f32_32x32x16_bf16 v[128:143], v[188:191], v[20:23], v[128:143]
    ds_read_b128 v[172:175], v3 offset:52224
    s_add_u32 s42, s40, 4096
    buffer_load_dwordx4 v[228:231], v2, s[4:7], s42 offen offset:0
    s_waitcnt vmcnt(15) lgkmcnt(4)
    v_mfma_f32_32x32x16_bf16 v[80:95], v[144:147], v[24:27], v[80:95]
    ds_read_b128 v[176:179], v2 offset:20480
    v_mfma_f32_32x32x16_bf16 v[96:111], v[148:151], v[24:27], v[96:111]
    ds_read_b128 v[180:183], v2 offset:53248
    buffer_load_dwordx4 v[56:59], v2, s[4:7], s16 offen offset:2048
    v_mfma_f32_32x32x16_bf16 v[112:127], v[152:155], v[24:27], v[112:127]
    ds_read_b128 v[184:187], v3 offset:20480
    v_mfma_f32_32x32x16_bf16 v[128:143], v[156:159], v[24:27], v[128:143]
    ds_read_b128 v[188:191], v3 offset:53248
    s_add_u32 s42, s41, 4096
    buffer_load_dwordx4 v[232:235], v2, s[4:7], s42 offen offset:0
    s_waitcnt vmcnt(15) lgkmcnt(4)
    v_mfma_f32_32x32x16_bf16 v[80:95], v[160:163], v[28:31], v[80:95]
    ds_read_b128 v[144:147], v2 offset:21504
    v_mfma_f32_32x32x16_bf16 v[96:111], v[164:167], v[28:31], v[96:111]
    ds_read_b128 v[148:151], v2 offset:54272
    buffer_load_dwordx4 v[60:63], v2, s[4:7], s16 offen offset:3072
    v_mfma_f32_32x32x16_bf16 v[112:127], v[168:171], v[28:31], v[112:127]
    ds_read_b128 v[152:155], v3 offset:21504
    v_mfma_f32_32x32x16_bf16 v[128:143], v[172:175], v[28:31], v[128:143]
    ds_read_b128 v[156:159], v3 offset:54272
    s_add_u32 s42, s40, 4096
    buffer_load_dwordx4 v[236:239], v2, s[4:7], s42 offen offset:1024
    s_waitcnt vmcnt(15) lgkmcnt(4)
    v_mfma_f32_32x32x16_bf16 v[80:95], v[176:179], v[32:35], v[80:95]
    ds_read_b128 v[160:163], v2 offset:22528
    v_mfma_f32_32x32x16_bf16 v[96:111], v[180:183], v[32:35], v[96:111]
    ds_read_b128 v[164:167], v2 offset:55296
    s_add_u32 s16, s16, 4096
    buffer_load_dwordx4 v[64:67], v2, s[4:7], s16 offen offset:0
    v_mfma_f32_32x32x16_bf16 v[112:127], v[184:187], v[32:35], v[112:127]
    ds_read_b128 v[168:171], v3 offset:22528
    v_mfma_f32_32x32x16_bf16 v[128:143], v[188:191], v[32:35], v[128:143]
    ds_read_b128 v[172:175], v3 offset:55296
    s_add_u32 s42, s41, 4096
    buffer_load_dwordx4 v[240:243], v2, s[4:7], s42 offen offset:1024
    s_waitcnt vmcnt(15) lgkmcnt(4)
    v_mfma_f32_32x32x16_bf16 v[80:95], v[144:147], v[36:39], v[80:95]
    ds_read_b128 v[176:179], v2 offset:23552
    v_mfma_f32_32x32x16_bf16 v[96:111], v[148:151], v[36:39], v[96:111]
    ds_read_b128 v[180:183], v2 offset:56320
    buffer_load_dwordx4 v[68:71], v2, s[4:7], s16 offen offset:1024
    v_mfma_f32_32x32x16_bf16 v[112:127], v[152:155], v[36:39], v[112:127]
    ds_read_b128 v[184:187], v3 offset:23552
    v_mfma_f32_32x32x16_bf16 v[128:143], v[156:159], v[36:39], v[128:143]
    ds_read_b128 v[188:191], v3 offset:56320
    s_add_u32 s42, s40, 4096
    buffer_load_dwordx4 v[244:247], v2, s[4:7], s42 offen offset:2048
    s_waitcnt vmcnt(15) lgkmcnt(4)
    v_mfma_f32_32x32x16_bf16 v[80:95], v[160:163], v[40:43], v[80:95]
    ds_read_b128 v[144:147], v2 offset:24576
    v_mfma_f32_32x32x16_bf16 v[96:111], v[164:167], v[40:43], v[96:111]
    ds_read_b128 v[148:151], v2 offset:57344
    buffer_load_dwordx4 v[72:75], v2, s[4:7], s16 offen offset:2048
    v_mfma_f32_32x32x16_bf16 v[112:127], v[168:171], v[40:43], v[112:127]
    ds_read_b128 v[152:155], v3 offset:24576
    v_mfma_f32_32x32x16_bf16 v[128:143], v[172:175], v[40:43], v[128:143]
    ds_read_b128 v[156:159], v3 offset:57344
    s_add_u32 s42, s41, 4096
    buffer_load_dwordx4 v[248:251], v2, s[4:7], s42 offen offset:2048
    s_waitcnt vmcnt(15) lgkmcnt(4)
    v_mfma_f32_32x32x16_bf16 v[80:95], v[176:179], v[44:47], v[80:95]
    ds_read_b128 v[160:163], v2 offset:25600
    v_mfma_f32_32x32x16_bf16 v[96:111], v[180:183], v[44:47], v[96:111]
    ds_read_b128 v[164:167], v2 offset:58368
    buffer_load_dwordx4 v[76:79], v2, s[4:7], s16 offen offset:3072
    v_mfma_f32_32x32x16_bf16 v[112:127], v[184:187], v[44:47], v[112:127]
    ds_read_b128 v[168:171], v3 offset:25600
    v_mfma_f32_32x32x16_bf16 v[128:143], v[188:191], v[44:47], v[128:143]
    ds_read_b128 v[172:175], v3 offset:58368
    s_waitcnt vmcnt(14) lgkmcnt(4)
    v_mfma_f32_32x32x16_bf16 v[80:95], v[144:147], v[48:51], v[80:95]
    ds_read_b128 v[176:179], v2 offset:26624
    v_mfma_f32_32x32x16_bf16 v[96:111], v[148:151], v[48:51], v[96:111]
    ds_read_b128 v[180:183], v2 offset:59392
    v_mfma_f32_32x32x16_bf16 v[112:127], v[152:155], v[48:51], v[112:127]
    ds_read_b128 v[184:187], v3 offset:26624
    v_mfma_f32_32x32x16_bf16 v[128:143], v[156:159], v[48:51], v[128:143]
    ds_read_b128 v[188:191], v3 offset:59392
    s_barrier
    s_waitcnt vmcnt(12) lgkmcnt(4)
    v_mfma_f32_32x32x16_bf16 v[80:95], v[160:163], v[52:55], v[80:95]
    ds_read_b128 v[144:147], v2 offset:27648
    v_mfma_f32_32x32x16_bf16 v[96:111], v[164:167], v[52:55], v[96:111]
    ds_read_b128 v[148:151], v2 offset:60416
    v_mfma_f32_32x32x16_bf16 v[112:127], v[168:171], v[52:55], v[112:127]
    ds_read_b128 v[152:155], v3 offset:27648
    v_mfma_f32_32x32x16_bf16 v[128:143], v[172:175], v[52:55], v[128:143]
    ds_read_b128 v[156:159], v3 offset:60416
    s_waitcnt vmcnt(10) lgkmcnt(4)
    v_mfma_f32_32x32x16_bf16 v[80:95], v[176:179], v[56:59], v[80:95]
    ds_read_b128 v[160:163], v2 offset:28672
    v_mfma_f32_32x32x16_bf16 v[96:111], v[180:183], v[56:59], v[96:111]
    ds_read_b128 v[164:167], v2 offset:61440
    v_mfma_f32_32x32x16_bf16 v[112:127], v[184:187], v[56:59], v[112:127]
    ds_read_b128 v[168:171], v3 offset:28672
    v_mfma_f32_32x32x16_bf16 v[128:143], v[188:191], v[56:59], v[128:143]
    ds_read_b128 v[172:175], v3 offset:61440
    s_waitcnt vmcnt(8) lgkmcnt(4)
    v_mfma_f32_32x32x16_bf16 v[80:95], v[144:147], v[60:63], v[80:95]
    ds_read_b128 v[176:179], v2 offset:29696
    v_mfma_f32_32x32x16_bf16 v[96:111], v[148:151], v[60:63], v[96:111]
    ds_read_b128 v[180:183], v2 offset:62464
    v_mfma_f32_32x32x16_bf16 v[112:127], v[152:155], v[60:63], v[112:127]
    ds_read_b128 v[184:187], v3 offset:29696
    v_mfma_f32_32x32x16_bf16 v[128:143], v[156:159], v[60:63], v[128:143]
    ds_read_b128 v[188:191], v3 offset:62464
    s_waitcnt vmcnt(6) lgkmcnt(4)
    v_mfma_f32_32x32x16_bf16 v[80:95], v[160:163], v[64:67], v[80:95]
    ds_read_b128 v[144:147], v2 offset:30720
    v_mfma_f32_32x32x16_bf16 v[96:111], v[164:167], v[64:67], v[96:111]
    ds_read_b128 v[148:151], v2 offset:63488
    v_mfma_f32_32x32x16_bf16 v[112:127], v[168:171], v[64:67], v[112:127]
    ds_read_b128 v[152:155], v3 offset:30720
    v_mfma_f32_32x32x16_bf16 v[128:143], v[172:175], v[64:67], v[128:143]
    ds_read_b128 v[156:159], v3 offset:63488
    s_waitcnt vmcnt(4) lgkmcnt(4)
    v_mfma_f32_32x32x16_bf16 v[80:95], v[176:179], v[68:71], v[80:95]
    ds_read_b128 v[160:163], v2 offset:31744
    v_mfma_f32_32x32x16_bf16 v[96:111], v[180:183], v[68:71], v[96:111]
    ds_read_b128 v[164:167], v2 offset:64512
    v_mfma_f32_32x32x16_bf16 v[112:127], v[184:187], v[68:71], v[112:127]
    ds_read_b128 v[168:171], v3 offset:31744
    v_mfma_f32_32x32x16_bf16 v[128:143], v[188:191], v[68:71], v[128:143]
    ds_read_b128 v[172:175], v3 offset:64512
    s_waitcnt vmcnt(2) lgkmcnt(4)
    v_mfma_f32_32x32x16_bf16 v[80:95], v[144:147], v[72:75], v[80:95]
    v_mfma_f32_32x32x16_bf16 v[96:111], v[148:151], v[72:75], v[96:111]
    v_mfma_f32_32x32x16_bf16 v[112:127], v[152:155], v[72:75], v[112:127]
    v_mfma_f32_32x32x16_bf16 v[128:143], v[156:159], v[72:75], v[128:143]
    s_waitcnt vmcnt(0) lgkmcnt(0)
    v_mfma_f32_32x32x16_bf16 v[80:95], v[160:163], v[76:79], v[80:95]
    v_mfma_f32_32x32x16_bf16 v[96:111], v[164:167], v[76:79], v[96:111]
    v_mfma_f32_32x32x16_bf16 v[112:127], v[168:171], v[76:79], v[112:127]
    v_mfma_f32_32x32x16_bf16 v[128:143], v[172:175], v[76:79], v[128:143]
    s_lshl_b32 s20, s8, 8
    s_add_u32 s20, s20, 139776
    v_and_b32 v8, 31, v1
    v_lshlrev_b32 v8, 3, v8
    v_add_u32 v8, s20, v8
    ds_read_b64 v[192:193], v8
    v_lshrrev_b32 v8, 5, v1
    v_lshlrev_b32 v8, 4, v8
    v_add_u32 v8, 139264, v8
    ds_read_b128 v[16:19], v8 offset:0
    ds_read_b128 v[20:23], v8 offset:32
    ds_read_b128 v[24:27], v8 offset:64
    ds_read_b128 v[28:31], v8 offset:96
    ds_read_b128 v[32:35], v8 offset:128
    ds_read_b128 v[36:39], v8 offset:160
    ds_read_b128 v[40:43], v8 offset:192
    ds_read_b128 v[44:47], v8 offset:224
    ds_read_b128 v[48:51], v8 offset:256
    ds_read_b128 v[52:55], v8 offset:288
    ds_read_b128 v[56:59], v8 offset:320
    s_waitcnt lgkmcnt(4)
    ds_read_b128 v[60:63], v8 offset:352
    ds_read_b128 v[64:67], v8 offset:384
    ds_read_b128 v[68:71], v8 offset:416
    ds_read_b128 v[72:75], v8 offset:448
    ds_read_b128 v[76:79], v8 offset:480
    s_mul_i32 s21, s15, 114688
    s_mul_i32 s22, s14, 8192
    s_add_u32 s21, s21, s22
    s_lshl_b32 s22, s10, 23
    s_add_u32 s21, s21, s22
    s_add_u32 s21, s21, 31457280
    s_waitcnt lgkmcnt(0)
    v_mov_b32 v4, v192
    v_mov_b32 v6, v193
    s_nop 7
    v_pk_fma_f32 v[80:81], v[16:17], v[4:5], v[80:81] op_sel_hi:[1,0,1]
    v_pk_fma_f32 v[82:83], v[18:19], v[4:5], v[82:83] op_sel_hi:[1,0,1]
    v_pk_fma_f32 v[84:85], v[20:21], v[4:5], v[84:85] op_sel_hi:[1,0,1]
    v_pk_fma_f32 v[86:87], v[22:23], v[4:5], v[86:87] op_sel_hi:[1,0,1]
    v_pk_fma_f32 v[88:89], v[24:25], v[4:5], v[88:89] op_sel_hi:[1,0,1]
    v_pk_fma_f32 v[90:91], v[26:27], v[4:5], v[90:91] op_sel_hi:[1,0,1]
    v_pk_fma_f32 v[92:93], v[28:29], v[4:5], v[92:93] op_sel_hi:[1,0,1]
    v_pk_fma_f32 v[94:95], v[30:31], v[4:5], v[94:95] op_sel_hi:[1,0,1]
    v_pk_mul_f32 v[80:81], v[80:81], v[6:7] op_sel_hi:[1,0]
    v_pk_mul_f32 v[82:83], v[82:83], v[6:7] op_sel_hi:[1,0]
    v_pk_mul_f32 v[84:85], v[84:85], v[6:7] op_sel_hi:[1,0]
    v_pk_mul_f32 v[86:87], v[86:87], v[6:7] op_sel_hi:[1,0]
    v_pk_mul_f32 v[88:89], v[88:89], v[6:7] op_sel_hi:[1,0]
    v_pk_mul_f32 v[90:91], v[90:91], v[6:7] op_sel_hi:[1,0]
    v_pk_mul_f32 v[92:93], v[92:93], v[6:7] op_sel_hi:[1,0]
    v_pk_mul_f32 v[94:95], v[94:95], v[6:7] op_sel_hi:[1,0]
    v_cvt_pk_bf16_f32 v144, v80, v81
    v_cvt_pk_bf16_f32 v145, v82, v83
    v_cvt_pk_bf16_f32 v146, v84, v85
    v_cvt_pk_bf16_f32 v147, v86, v87
    v_cvt_pk_bf16_f32 v148, v88, v89
    v_cvt_pk_bf16_f32 v149, v90, v91
    v_cvt_pk_bf16_f32 v150, v92, v93
    v_cvt_pk_bf16_f32 v151, v94, v95
    v_pk_max_i16 v144, v144, 0
    v_pk_max_i16 v145, v145, 0
    v_pk_max_i16 v146, v146, 0
    v_pk_max_i16 v147, v147, 0
    v_pk_max_i16 v148, v148, 0
    v_pk_max_i16 v149, v149, 0
    v_pk_max_i16 v150, v150, 0
    v_pk_max_i16 v151, v151, 0
    s_add_u32 s23, s21, 0
    buffer_store_dwordx4 v[144:147], v2, s[4:7], s23 offen sc1
    s_add_u32 s23, s21, 1024
    buffer_store_dwordx4 v[148:151], v2, s[4:7], s23 offen sc1
    v_pk_fma_f32 v[96:97], v[32:33], v[4:5], v[96:97] op_sel_hi:[1,0,1]
    v_pk_fma_f32 v[98:99], v[34:35], v[4:5], v[98:99] op_sel_hi:[1,0,1]
    v_pk_fma_f32 v[100:101], v[36:37], v[4:5], v[100:101] op_sel_hi:[1,0,1]
    v_pk_fma_f32 v[102:103], v[38:39], v[4:5], v[102:103] op_sel_hi:[1,0,1]
    v_pk_fma_f32 v[104:105], v[40:41], v[4:5], v[104:105] op_sel_hi:[1,0,1]
    v_pk_fma_f32 v[106:107], v[42:43], v[4:5], v[106:107] op_sel_hi:[1,0,1]
    v_pk_fma_f32 v[108:109], v[44:45], v[4:5], v[108:109] op_sel_hi:[1,0,1]
    v_pk_fma_f32 v[110:111], v[46:47], v[4:5], v[110:111] op_sel_hi:[1,0,1]
    v_pk_mul_f32 v[96:97], v[96:97], v[6:7] op_sel_hi:[1,0]
    v_pk_mul_f32 v[98:99], v[98:99], v[6:7] op_sel_hi:[1,0]
    v_pk_mul_f32 v[100:101], v[100:101], v[6:7] op_sel_hi:[1,0]
    v_pk_mul_f32 v[102:103], v[102:103], v[6:7] op_sel_hi:[1,0]
    v_pk_mul_f32 v[104:105], v[104:105], v[6:7] op_sel_hi:[1,0]
    v_pk_mul_f32 v[106:107], v[106:107], v[6:7] op_sel_hi:[1,0]
    v_pk_mul_f32 v[108:109], v[108:109], v[6:7] op_sel_hi:[1,0]
    v_pk_mul_f32 v[110:111], v[110:111], v[6:7] op_sel_hi:[1,0]
    v_cvt_pk_bf16_f32 v152, v96, v97
    v_cvt_pk_bf16_f32 v153, v98, v99
    v_cvt_pk_bf16_f32 v154, v100, v101
    v_cvt_pk_bf16_f32 v155, v102, v103
    v_cvt_pk_bf16_f32 v156, v104, v105
    v_cvt_pk_bf16_f32 v157, v106, v107
    v_cvt_pk_bf16_f32 v158, v108, v109
    v_cvt_pk_bf16_f32 v159, v110, v111
    v_pk_max_i16 v152, v152, 0
    v_pk_max_i16 v153, v153, 0
    v_pk_max_i16 v154, v154, 0
    v_pk_max_i16 v155, v155, 0
    v_pk_max_i16 v156, v156, 0
    v_pk_max_i16 v157, v157, 0
    v_pk_max_i16 v158, v158, 0
    v_pk_max_i16 v159, v159, 0
    s_add_u32 s23, s21, 2048
    buffer_store_dwordx4 v[152:155], v2, s[4:7], s23 offen sc1
    s_add_u32 s23, s21, 3072
    buffer_store_dwordx4 v[156:159], v2, s[4:7], s23 offen sc1
    v_pk_fma_f32 v[112:113], v[48:49], v[4:5], v[112:113] op_sel_hi:[1,0,1]
    v_pk_fma_f32 v[114:115], v[50:51], v[4:5], v[114:115] op_sel_hi:[1,0,1]
    v_pk_fma_f32 v[116:117], v[52:53], v[4:5], v[116:117] op_sel_hi:[1,0,1]
    v_pk_fma_f32 v[118:119], v[54:55], v[4:5], v[118:119] op_sel_hi:[1,0,1]
    v_pk_fma_f32 v[120:121], v[56:57], v[4:5], v[120:121] op_sel_hi:[1,0,1]
    v_pk_fma_f32 v[122:123], v[58:59], v[4:5], v[122:123] op_sel_hi:[1,0,1]
    v_pk_fma_f32 v[124:125], v[60:61], v[4:5], v[124:125] op_sel_hi:[1,0,1]
    v_pk_fma_f32 v[126:127], v[62:63], v[4:5], v[126:127] op_sel_hi:[1,0,1]
    v_pk_mul_f32 v[112:113], v[112:113], v[6:7] op_sel_hi:[1,0]
    v_pk_mul_f32 v[114:115], v[114:115], v[6:7] op_sel_hi:[1,0]
    v_pk_mul_f32 v[116:117], v[116:117], v[6:7] op_sel_hi:[1,0]
    v_pk_mul_f32 v[118:119], v[118:119], v[6:7] op_sel_hi:[1,0]
    v_pk_mul_f32 v[120:121], v[120:121], v[6:7] op_sel_hi:[1,0]
    v_pk_mul_f32 v[122:123], v[122:123], v[6:7] op_sel_hi:[1,0]
    v_pk_mul_f32 v[124:125], v[124:125], v[6:7] op_sel_hi:[1,0]
    v_pk_mul_f32 v[126:127], v[126:127], v[6:7] op_sel_hi:[1,0]
    v_cvt_pk_bf16_f32 v160, v112, v113
    v_cvt_pk_bf16_f32 v161, v114, v115
    v_cvt_pk_bf16_f32 v162, v116, v117
    v_cvt_pk_bf16_f32 v163, v118, v119
    v_cvt_pk_bf16_f32 v164, v120, v121
    v_cvt_pk_bf16_f32 v165, v122, v123
    v_cvt_pk_bf16_f32 v166, v124, v125
    v_cvt_pk_bf16_f32 v167, v126, v127
    v_pk_max_i16 v160, v160, 0
    v_pk_max_i16 v161, v161, 0
    v_pk_max_i16 v162, v162, 0
    v_pk_max_i16 v163, v163, 0
    v_pk_max_i16 v164, v164, 0
    v_pk_max_i16 v165, v165, 0
    v_pk_max_i16 v166, v166, 0
    v_pk_max_i16 v167, v167, 0
    s_add_u32 s23, s21, 4096
    buffer_store_dwordx4 v[160:163], v2, s[4:7], s23 offen sc1
    s_add_u32 s23, s21, 5120
    buffer_store_dwordx4 v[164:167], v2, s[4:7], s23 offen sc1
    v_pk_fma_f32 v[128:129], v[64:65], v[4:5], v[128:129] op_sel_hi:[1,0,1]
    v_pk_fma_f32 v[130:131], v[66:67], v[4:5], v[130:131] op_sel_hi:[1,0,1]
    v_pk_fma_f32 v[132:133], v[68:69], v[4:5], v[132:133] op_sel_hi:[1,0,1]
    v_pk_fma_f32 v[134:135], v[70:71], v[4:5], v[134:135] op_sel_hi:[1,0,1]
    v_pk_fma_f32 v[136:137], v[72:73], v[4:5], v[136:137] op_sel_hi:[1,0,1]
    v_pk_fma_f32 v[138:139], v[74:75], v[4:5], v[138:139] op_sel_hi:[1,0,1]
    v_pk_fma_f32 v[140:141], v[76:77], v[4:5], v[140:141] op_sel_hi:[1,0,1]
    v_pk_fma_f32 v[142:143], v[78:79], v[4:5], v[142:143] op_sel_hi:[1,0,1]
    v_pk_mul_f32 v[128:129], v[128:129], v[6:7] op_sel_hi:[1,0]
    v_pk_mul_f32 v[130:131], v[130:131], v[6:7] op_sel_hi:[1,0]
    v_pk_mul_f32 v[132:133], v[132:133], v[6:7] op_sel_hi:[1,0]
    v_pk_mul_f32 v[134:135], v[134:135], v[6:7] op_sel_hi:[1,0]
    v_pk_mul_f32 v[136:137], v[136:137], v[6:7] op_sel_hi:[1,0]
    v_pk_mul_f32 v[138:139], v[138:139], v[6:7] op_sel_hi:[1,0]
    v_pk_mul_f32 v[140:141], v[140:141], v[6:7] op_sel_hi:[1,0]
    v_pk_mul_f32 v[142:143], v[142:143], v[6:7] op_sel_hi:[1,0]
    v_cvt_pk_bf16_f32 v168, v128, v129
    v_cvt_pk_bf16_f32 v169, v130, v131
    v_cvt_pk_bf16_f32 v170, v132, v133
    v_cvt_pk_bf16_f32 v171, v134, v135
    v_cvt_pk_bf16_f32 v172, v136, v137
    v_cvt_pk_bf16_f32 v173, v138, v139
    v_cvt_pk_bf16_f32 v174, v140, v141
    v_cvt_pk_bf16_f32 v175, v142, v143
    v_pk_max_i16 v168, v168, 0
    v_pk_max_i16 v169, v169, 0
    v_pk_max_i16 v170, v170, 0
    v_pk_max_i16 v171, v171, 0
    v_pk_max_i16 v172, v172, 0
    v_pk_max_i16 v173, v173, 0
    v_pk_max_i16 v174, v174, 0
    v_pk_max_i16 v175, v175, 0
    s_add_u32 s23, s21, 6144
    buffer_store_dwordx4 v[168:171], v2, s[4:7], s23 offen sc1
    s_add_u32 s23, s21, 7168
    buffer_store_dwordx4 v[172:175], v2, s[4:7], s23 offen sc1
    s_setprio 0
L_ga_end_262:
    s_mul_i32 s35, s10, 5
    s_add_u32 s35, s35, 4
    s_add_u32 s34, s9, s35
    s_lshl_b32 s35, s35, 8
    s_add_u32 s35, s35, s36
    s_lshl_b32 s35, s35, 7
    s_add_u32 s35, s35, 51380224
    s_waitcnt vmcnt(0)
    s_barrier
    s_cmp_lg_u32 s8, 7
    s_cbranch_scc1 L_sig_263
    v_mov_b32 v4, s34
    v_mov_b32 v5, 0
    s_mov_b64 exec, 1
    s_cmp_eq_u32 s3, 0
    s_cbranch_scc1 L_sg_264
    buffer_store_dword v4, v5, s[4:7], s35 offen
    s_branch L_sg_265
L_sg_264:
    buffer_store_dword v4, v5, s[4:7], s35 offen sc1
L_sg_265:
    s_mov_b64 exec, -1
L_sig_263:
L_ga_skip_256:
    s_cmp_lt_u32 s12, 28
    s_cbranch_scc1 L_w1idle_266
    s_cmp_ge_u32 s8, 4
    s_cbranch_scc1 L_w_267
    s_lshr_b32 s40, s12, 2
    s_mul_i32 s41, s8, 12288
    s_mul_i32 s40, s40, 229376
    s_add_u32 s40, s40, s41
    s_add_u32 s40, s40, 12582912
    s_add_u32 s41, s40, 114688
    s_add_u32 s42, s40, 0
    buffer_load_dwordx4 v[196:199], v2, s[4:7], s42 offen offset:0
    s_add_u32 s42, s41, 0
    buffer_load_dwordx4 v[200:203], v2, s[4:7], s42 offen offset:0
    s_add_u32 s42, s40, 0
    buffer_load_dwordx4 v[204:207], v2, s[4:7], s42 offen offset:1024
    s_add_u32 s42, s41, 0
    buffer_load_dwordx4 v[208:211], v2, s[4:7], s42 offen offset:1024
    s_add_u32 s42, s40, 0
    buffer_load_dwordx4 v[212:215], v2, s[4:7], s42 offen offset:2048
    s_add_u32 s42, s41, 0
    buffer_load_dwordx4 v[216:219], v2, s[4:7], s42 offen offset:2048
    s_add_u32 s42, s40, 0
    buffer_load_dwordx4 v[220:223], v2, s[4:7], s42 offen offset:3072
    s_add_u32 s42, s41, 0
    buffer_load_dwordx4 v[224:227], v2, s[4:7], s42 offen offset:3072
    s_add_u32 s42, s40, 4096
    buffer_load_dwordx4 v[228:231], v2, s[4:7], s42 offen offset:0
    s_add_u32 s42, s41, 4096
    buffer_load_dwordx4 v[232:235], v2, s[4:7], s42 offen offset:0
    s_add_u32 s42, s40, 4096
    buffer_load_dwordx4 v[236:239], v2, s[4:7], s42 offen offset:1024
    s_add_u32 s42, s41, 4096
    buffer_load_dwordx4 v[240:243], v2, s[4:7], s42 offen offset:1024
    s_add_u32 s42, s40, 4096
    buffer_load_dwordx4 v[244:247], v2, s[4:7], s42 offen offset:2048
    s_add_u32 s42, s41, 4096
    buffer_load_dwordx4 v[248:251], v2, s[4:7], s42 offen offset:2048
L_w_267:
L_w1idle_266:
    s_and_b32 s13, s12, 3
    s_lshl_b32 s14, s11, 2
    s_add_u32 s13, s13, s14
    s_lshr_b32 s14, s12, 2
    s_cmp_lg_u32 s8, 7
    s_cbranch_scc1 L_w_268
    s_bfe_u32 s19, s12, 0x10001
    s_lshl_b32 s23, s11, 5
    s_add_u32 s19, s19, s23
    v_lshlrev_b32 v4, 1, v1
    v_add_u32 v4, s19, v4
    s_mul_i32 s20, s10, 5
    s_add_u32 s20, s20, 4
    s_mov_b32 s28, s20
    s_add_u32 s21, s9, s28
    s_lshl_b32 s20, s28, 15
    s_add_u32 s20, s20, 51380224
    v_lshlrev_b32 v4, 7, v4
    s_mov_b32 exec_lo, 0x3fff
    s_mov_b32 exec_hi, 0x0
    s_mov_b32 s22, 0
L_poll_269:
    buffer_load_dword v5, v4, s[4:7], s20 offen sc1
    s_waitcnt vmcnt(0)
    v_cmp_ne_u32 vcc, s21, v5
    s_cmp_eq_u64 vcc, 0
    s_cbranch_scc1 L_polld_270
    s_sleep 1
    s_add_u32 s22, s22, 1
    s_cmp_lt_u32 s22, 262144
    s_cbranch_scc1 L_poll_269
L_polld_270:
    s_mov_b64 exec, -1
L_w_268:
    s_barrier
    s_mov_b32 s44, s4
    s_mov_b32 s45, s5
    s_mov_b32 s47, 0x00020000
    s_cmp_eq_u32 s10, 0
    s_cselect_b32 s46, 58720256, 0
    s_lshr_b32 s30, s12, 1
    s_mul_i32 s31, s30, 98304
    s_add_u32 s31, s31, 8388608
    s_lshl_b32 s32, s8, 12
    s_add_u32 s31, s31, s32
    s_cmp_ge_u32 s8, 4
    s_cbranch_scc1 L_w2_hi
    s_mul_i32 s15, s8, 12288
    s_mul_i32 s16, s13, 229376
    s_add_u32 s16, s16, s15
    s_lshl_b32 s17, s10, 23
    s_add_u32 s16, s16, s17
    s_add_u32 s16, s16, 31457280
    s_add_u32 s17, s16, 114688
    buffer_load_dwordx4 v[120:123], v2, s[4:7], s16 offen offset:0
    buffer_load_dwordx4 v[124:127], v2, s[4:7], s17 offen offset:0
    buffer_load_dwordx4 v[128:131], v2, s[4:7], s16 offen offset:1024
    buffer_load_dwordx4 v[132:135], v2, s[4:7], s17 offen offset:1024
    s_lshr_b32 s40, s12, 2
    s_mul_i32 s41, s8, 12288
    s_mul_i32 s40, s40, 229376
    s_add_u32 s40, s40, s41
    s_add_u32 s40, s40, 12582912
    s_add_u32 s41, s40, 114688
    s_add_u32 s42, s40, 4096
    buffer_load_dwordx4 v[16:19], v2, s[4:7], s42 offen offset:3072
    s_add_u32 s42, s41, 4096
    buffer_load_dwordx4 v[20:23], v2, s[4:7], s42 offen offset:3072
    s_add_u32 s42, s40, 8192
    buffer_load_dwordx4 v[24:27], v2, s[4:7], s42 offen offset:0
    s_add_u32 s42, s41, 8192
    buffer_load_dwordx4 v[28:31], v2, s[4:7], s42 offen offset:0
    s_add_u32 s42, s40, 8192
    buffer_load_dwordx4 v[32:35], v2, s[4:7], s42 offen offset:1024
    s_add_u32 s42, s41, 8192
    buffer_load_dwordx4 v[36:39], v2, s[4:7], s42 offen offset:1024
    s_add_u32 s42, s40, 8192
    buffer_load_dwordx4 v[40:43], v2, s[4:7], s42 offen offset:2048
    s_add_u32 s42, s41, 8192
    buffer_load_dwordx4 v[44:47], v2, s[4:7], s42 offen offset:2048
    s_add_u32 s42, s40, 8192
    buffer_load_dwordx4 v[112:115], v2, s[4:7], s42 offen offset:3072
    s_add_u32 s42, s41, 8192
    buffer_load_dwordx4 v[116:119], v2, s[4:7], s42 offen offset:3072
    buffer_load_dwordx4 v[136:139], v2, s[4:7], s16 offen offset:2048
    buffer_load_dwordx4 v[140:143], v2, s[4:7], s17 offen offset:2048
    buffer_load_dwordx4 v[144:147], v2, s[4:7], s16 offen offset:3072
    buffer_load_dwordx4 v[148:151], v2, s[4:7], s17 offen offset:3072
    s_add_u32 s16, s16, 4096
    s_add_u32 s17, s17, 4096
    buffer_load_dwordx4 v[152:155], v2, s[4:7], s16 offen offset:0
    buffer_load_dwordx4 v[156:159], v2, s[4:7], s17 offen offset:0
    buffer_load_dwordx4 v[160:163], v2, s[4:7], s16 offen offset:1024
    buffer_load_dwordx4 v[164:167], v2, s[4:7], s17 offen offset:1024
    buffer_load_dwordx4 v[168:171], v2, s[4:7], s16 offen offset:2048
    buffer_load_dwordx4 v[172:175], v2, s[4:7], s17 offen offset:2048
    s_lshr_b32 s20, s8, 2
    s_lshl_b32 s22, s13, 1
    s_add_u32 s20, s22, s20
    s_and_b32 s21, s8, 3
    s_lshl_b32 s22, s14, 2
    s_add_u32 s21, s22, s21
    s_lshl_b32 s22, s20, 15
    s_lshl_b32 s23, s21, 10
    s_add_u32 s22, s22, s23
    s_lshl_b32 s23, s10, 22
    s_add_u32 s23, s23, s22
    s_add_u32 s23, s23, 2097152
    s_waitcnt vmcnt(10)
    v_mfma_f32_32x32x16_bf16 v[48:63], v[196:199], v[120:123], 0
    v_mfma_f32_32x32x16_bf16 v[64:79], v[200:203], v[120:123], 0
    v_mfma_f32_32x32x16_bf16 v[80:95], v[196:199], v[124:127], 0
    v_mfma_f32_32x32x16_bf16 v[96:111], v[200:203], v[124:127], 0
    buffer_load_dwordx4 v[120:123], v2, s[4:7], s16 offen offset:3072
    buffer_load_dwordx4 v[124:127], v2, s[4:7], s17 offen offset:3072
    v_mfma_f32_32x32x16_bf16 v[48:63], v[204:207], v[128:131], v[48:63]
    v_mfma_f32_32x32x16_bf16 v[64:79], v[208:211], v[128:131], v[64:79]
    v_mfma_f32_32x32x16_bf16 v[80:95], v[204:207], v[132:135], v[80:95]
    v_mfma_f32_32x32x16_bf16 v[96:111], v[208:211], v[132:135], v[96:111]
    s_add_u32 s16, s16, 4096
    s_add_u32 s17, s17, 4096
    buffer_load_dwordx4 v[128:131], v2, s[4:7], s16 offen offset:0
    buffer_load_dwordx4 v[132:135], v2, s[4:7], s17 offen offset:0
    s_waitcnt vmcnt(12)
    v_mfma_f32_32x32x16_bf16 v[48:63], v[212:215], v[136:139], v[48:63]
    v_mfma_f32_32x32x16_bf16 v[64:79], v[216:219], v[136:139], v[64:79]
    v_mfma_f32_32x32x16_bf16 v[80:95], v[212:215], v[140:143], v[80:95]
    v_mfma_f32_32x32x16_bf16 v[96:111], v[216:219], v[140:143], v[96:111]
    buffer_load_dwordx4 v[136:139], v2, s[4:7], s16 offen offset:1024
    buffer_load_dwordx4 v[140:143], v2, s[4:7], s17 offen offset:1024
    s_waitcnt vmcnt(12)
    v_mfma_f32_32x32x16_bf16 v[48:63], v[220:223], v[144:147], v[48:63]
    v_mfma_f32_32x32x16_bf16 v[64:79], v[224:227], v[144:147], v[64:79]
    v_mfma_f32_32x32x16_bf16 v[80:95], v[220:223], v[148:151], v[80:95]
    v_mfma_f32_32x32x16_bf16 v[96:111], v[224:227], v[148:151], v[96:111]
    buffer_load_dwordx4 v[144:147], v2, s[4:7], s16 offen offset:2048
    buffer_load_dwordx4 v[148:151], v2, s[4:7], s17 offen offset:2048
    s_waitcnt vmcnt(12)
    v_mfma_f32_32x32x16_bf16 v[48:63], v[228:231], v[152:155], v[48:63]
    v_mfma_f32_32x32x16_bf16 v[64:79], v[232:235], v[152:155], v[64:79]
    v_mfma_f32_32x32x16_bf16 v[80:95], v[228:231], v[156:159], v[80:95]
    v_mfma_f32_32x32x16_bf16 v[96:111], v[232:235], v[156:159], v[96:111]
    buffer_load_dwordx4 v[152:155], v2, s[4:7], s16 offen offset:3072
    buffer_load_dwordx4 v[156:159], v2, s[4:7], s17 offen offset:3072
    buffer_load_dwordx4 v[8:11], v2, s[4:7], s23 offen
    s_waitcnt vmcnt(13)
    v_mfma_f32_32x32x16_bf16 v[48:63], v[236:239], v[160:163], v[48:63]
    v_mfma_f32_32x32x16_bf16 v[64:79], v[240:243], v[160:163], v[64:79]
    v_mfma_f32_32x32x16_bf16 v[80:95], v[236:239], v[164:167], v[80:95]
    v_mfma_f32_32x32x16_bf16 v[96:111], v[240:243], v[164:167], v[96:111]
    s_add_u32 m0, s32, 0
    s_add_u32 s33, s31, 0
    buffer_load_dwordx4 v2, s[44:47], s33 offen offset:0 lds
    s_add_u32 m0, s32, 0
    s_add_u32 s33, s31, 0
    buffer_load_dwordx4 v2, s[44:47], s33 offen offset:1024 lds
    s_waitcnt vmcnt(13)
    v_mfma_f32_32x32x16_bf16 v[48:63], v[244:247], v[168:171], v[48:63]
    v_mfma_f32_32x32x16_bf16 v[64:79], v[248:251], v[168:171], v[64:79]
    v_mfma_f32_32x32x16_bf16 v[80:95], v[244:247], v[172:175], v[80:95]
    v_mfma_f32_32x32x16_bf16 v[96:111], v[248:251], v[172:175], v[96:111]
    s_add_u32 m0, s32, 0
    s_add_u32 s33, s31, 0
    buffer_load_dwordx4 v2, s[44:47], s33 offen offset:2048 lds
    s_add_u32 m0, s32, 0
    s_add_u32 s33, s31, 0
    buffer_load_dwordx4 v2, s[44:47], s33 offen offset:3072 lds
    s_waitcnt vmcnt(13)
    v_mfma_f32_32x32x16_bf16 v[48:63], v[16:19], v[120:123], v[48:63]
    v_mfma_f32_32x32x16_bf16 v[64:79], v[20:23], v[120:123], v[64:79]
    v_mfma_f32_32x32x16_bf16 v[80:95], v[16:19], v[124:127], v[80:95]
    v_mfma_f32_32x32x16_bf16 v[96:111], v[20:23], v[124:127], v[96:111]
    s_add_u32 m0, s32, 32768
    s_add_u32 s33, s31, 32768
    buffer_load_dwordx4 v2, s[44:47], s33 offen offset:0 lds
    s_add_u32 m0, s32, 32768
    s_add_u32 s33, s31, 32768
    buffer_load_dwordx4 v2, s[44:47], s33 offen offset:1024 lds
    s_waitcnt vmcnt(13)
    v_mfma_f32_32x32x16_bf16 v[48:63], v[24:27], v[128:131], v[48:63]
    v_mfma_f32_32x32x16_bf16 v[64:79], v[28:31], v[128:131], v[64:79]
    v_mfma_f32_32x32x16_bf16 v[80:95], v[24:27], v[132:135], v[80:95]
    v_mfma_f32_32x32x16_bf16 v[96:111], v[28:31], v[132:135], v[96:111]
    s_add_u32 m0, s32, 32768
    s_add_u32 s33, s31, 32768
    buffer_load_dwordx4 v2, s[44:47], s33 offen offset:2048 lds
    s_add_u32 m0, s32, 32768
    s_add_u32 s33, s31, 32768
    buffer_load_dwordx4 v2, s[44:47], s33 offen offset:3072 lds
    s_waitcnt vmcnt(13)
    v_mfma_f32_32x32x16_bf16 v[48:63], v[32:35], v[136:139], v[48:63]
    v_mfma_f32_32x32x16_bf16 v[64:79], v[36:39], v[136:139], v[64:79]
    v_mfma_f32_32x32x16_bf16 v[80:95], v[32:35], v[140:143], v[80:95]
    v_mfma_f32_32x32x16_bf16 v[96:111], v[36:39], v[140:143], v[96:111]
    s_add_u32 m0, s32, 65536
    s_add_u32 s33, s31, 65536
    buffer_load_dwordx4 v2, s[44:47], s33 offen offset:0 lds
    s_add_u32 m0, s32, 65536
    s_add_u32 s33, s31, 65536
    buffer_load_dwordx4 v2, s[44:47], s33 offen offset:1024 lds
    s_waitcnt vmcnt(13)
    v_mfma_f32_32x32x16_bf16 v[48:63], v[40:43], v[144:147], v[48:63]
    v_mfma_f32_32x32x16_bf16 v[64:79], v[44:47], v[144:147], v[64:79]
    v_mfma_f32_32x32x16_bf16 v[80:95], v[40:43], v[148:151], v[80:95]
    v_mfma_f32_32x32x16_bf16 v[96:111], v[44:47], v[148:151], v[96:111]
    s_add_u32 m0, s32, 65536
    s_add_u32 s33, s31, 65536
    buffer_load_dwordx4 v2, s[44:47], s33 offen offset:2048 lds
    s_add_u32 m0, s32, 65536
    s_add_u32 s33, s31, 65536
    buffer_load_dwordx4 v2, s[44:47], s33 offen offset:3072 lds
    s_waitcnt vmcnt(13)
    v_mfma_f32_32x32x16_bf16 v[48:63], v[112:115], v[152:155], v[48:63]
    v_mfma_f32_32x32x16_bf16 v[64:79], v[116:119], v[152:155], v[64:79]
    v_mfma_f32_32x32x16_bf16 v[80:95], v[112:115], v[156:159], v[80:95]
    v_mfma_f32_32x32x16_bf16 v[96:111], v[116:119], v[156:159], v[96:111]
    s_waitcnt vmcnt(12)
    s_branch L_w2_join
L_w2_hi:
    s_sub_u32 s15, s8, 4
    s_mul_i32 s15, s15, 16384
    s_add_u32 s15, s15, 49152
    s_mul_i32 s16, s13, 229376
    s_add_u32 s16, s16, s15
    s_lshl_b32 s17, s10, 23
    s_add_u32 s16, s16, s17
    s_add_u32 s16, s16, 31457280
    s_add_u32 s17, s16, 114688
    s_setprio 1
    buffer_load_dwordx4 v[80:83], v2, s[4:7], s16 offen offset:0
    buffer_load_dwordx4 v[84:87], v2, s[4:7], s17 offen offset:0
    buffer_load_dwordx4 v[88:91], v2, s[4:7], s16 offen offset:1024
    buffer_load_dwordx4 v[92:95], v2, s[4:7], s17 offen offset:1024
    buffer_load_dwordx4 v[96:99], v2, s[4:7], s16 offen offset:2048
    buffer_load_dwordx4 v[100:103], v2, s[4:7], s17 offen offset:2048
    buffer_load_dwordx4 v[104:107], v2, s[4:7], s16 offen offset:3072
    buffer_load_dwordx4 v[108:111], v2, s[4:7], s17 offen offset:3072
    s_lshr_b32 s20, s8, 2
    s_lshl_b32 s22, s13, 1
    s_add_u32 s20, s22, s20
    s_and_b32 s21, s8, 3
    s_lshl_b32 s22, s14, 2
    s_add_u32 s21, s22, s21
    s_lshl_b32 s22, s20, 15
    s_lshl_b32 s23, s21, 10
    s_add_u32 s22, s22, s23
    s_lshl_b32 s23, s10, 22
    s_add_u32 s23, s23, s22
    s_add_u32 s23, s23, 2097152
    s_waitcnt vmcnt(6)
    v_mfma_f32_32x32x16_bf16 v[16:31], v[124:127], v[80:83], 0
    v_mfma_f32_32x32x16_bf16 v[32:47], v[128:131], v[80:83], 0
    v_mfma_f32_32x32x16_bf16 v[48:63], v[124:127], v[84:87], 0
    v_mfma_f32_32x32x16_bf16 v[64:79], v[128:131], v[84:87], 0
    s_add_u32 s16, s16, 4096
    s_add_u32 s17, s17, 4096
    buffer_load_dwordx4 v[112:115], v2, s[4:7], s16 offen offset:0
    buffer_load_dwordx4 v[116:119], v2, s[4:7], s17 offen offset:0
    buffer_load_dwordx4 v[80:83], v2, s[4:7], s16 offen offset:1024
    buffer_load_dwordx4 v[84:87], v2, s[4:7], s17 offen offset:1024
    s_waitcnt vmcnt(8)
    v_mfma_f32_32x32x16_bf16 v[16:31], v[132:135], v[88:91], v[16:31]
    v_mfma_f32_32x32x16_bf16 v[32:47], v[136:139], v[88:91], v[32:47]
    v_mfma_f32_32x32x16_bf16 v[48:63], v[132:135], v[92:95], v[48:63]
    v_mfma_f32_32x32x16_bf16 v[64:79], v[136:139], v[92:95], v[64:79]
    buffer_load_dwordx4 v[88:91], v2, s[4:7], s16 offen offset:2048
    buffer_load_dwordx4 v[92:95], v2, s[4:7], s17 offen offset:2048
    s_waitcnt vmcnt(8)
    v_mfma_f32_32x32x16_bf16 v[16:31], v[140:143], v[96:99], v[16:31]
    v_mfma_f32_32x32x16_bf16 v[32:47], v[144:147], v[96:99], v[32:47]
    v_mfma_f32_32x32x16_bf16 v[48:63], v[140:143], v[100:103], v[48:63]
    v_mfma_f32_32x32x16_bf16 v[64:79], v[144:147], v[100:103], v[64:79]
    buffer_load_dwordx4 v[96:99], v2, s[4:7], s16 offen offset:3072
    buffer_load_dwordx4 v[100:103], v2, s[4:7], s17 offen offset:3072
    s_waitcnt vmcnt(8)
    v_mfma_f32_32x32x16_bf16 v[16:31], v[148:151], v[104:107], v[16:31]
    v_mfma_f32_32x32x16_bf16 v[32:47], v[152:155], v[104:107], v[32:47]
    v_mfma_f32_32x32x16_bf16 v[48:63], v[148:151], v[108:111], v[48:63]
    v_mfma_f32_32x32x16_bf16 v[64:79], v[152:155], v[108:111], v[64:79]
    s_add_u32 s16, s16, 4096
    s_add_u32 s17, s17, 4096
    buffer_load_dwordx4 v[104:107], v2, s[4:7], s16 offen offset:0
    buffer_load_dwordx4 v[108:111], v2, s[4:7], s17 offen offset:0
    s_waitcnt vmcnt(8)
    v_mfma_f32_32x32x16_bf16 v[16:31], v[156:159], v[112:115], v[16:31]
    v_mfma_f32_32x32x16_bf16 v[32:47], v[160:163], v[112:115], v[32:47]
    v_mfma_f32_32x32x16_bf16 v[48:63], v[156:159], v[116:119], v[48:63]
    v_mfma_f32_32x32x16_bf16 v[64:79], v[160:163], v[116:119], v[64:79]
    buffer_load_dwordx4 v[112:115], v2, s[4:7], s16 offen offset:1024
    buffer_load_dwordx4 v[116:119], v2, s[4:7], s17 offen offset:1024
    s_waitcnt vmcnt(8)
    v_mfma_f32_32x32x16_bf16 v[16:31], v[164:167], v[80:83], v[16:31]
    v_mfma_f32_32x32x16_bf16 v[32:47], v[168:171], v[80:83], v[32:47]
    v_mfma_f32_32x32x16_bf16 v[48:63], v[164:167], v[84:87], v[48:63]
    v_mfma_f32_32x32x16_bf16 v[64:79], v[168:171], v[84:87], v[64:79]
    buffer_load_dwordx4 v[80:83], v2, s[4:7], s16 offen offset:2048
    buffer_load_dwordx4 v[84:87], v2, s[4:7], s17 offen offset:2048
    s_waitcnt vmcnt(8)
    v_mfma_f32_32x32x16_bf16 v[16:31], v[172:175], v[88:91], v[16:31]
    v_mfma_f32_32x32x16_bf16 v[32:47], v[176:179], v[88:91], v[32:47]
    v_mfma_f32_32x32x16_bf16 v[48:63], v[172:175], v[92:95], v[48:63]
    v_mfma_f32_32x32x16_bf16 v[64:79], v[176:179], v[92:95], v[64:79]
    buffer_load_dwordx4 v[88:91], v2, s[4:7], s16 offen offset:3072
    buffer_load_dwordx4 v[92:95], v2, s[4:7], s17 offen offset:3072
    s_waitcnt vmcnt(8)
    v_mfma_f32_32x32x16_bf16 v[16:31], v[180:183], v[96:99], v[16:31]
    v_mfma_f32_32x32x16_bf16 v[32:47], v[184:187], v[96:99], v[32:47]
    v_mfma_f32_32x32x16_bf16 v[48:63], v[180:183], v[100:103], v[48:63]
    v_mfma_f32_32x32x16_bf16 v[64:79], v[184:187], v[100:103], v[64:79]
    s_add_u32 s16, s16, 4096
    s_add_u32 s17, s17, 4096
    buffer_load_dwordx4 v[96:99], v2, s[4:7], s16 offen offset:0
    buffer_load_dwordx4 v[100:103], v2, s[4:7], s17 offen offset:0
    s_waitcnt vmcnt(8)
    v_mfma_f32_32x32x16_bf16 v[16:31], v[188:191], v[104:107], v[16:31]
    v_mfma_f32_32x32x16_bf16 v[32:47], v[192:195], v[104:107], v[32:47]
    v_mfma_f32_32x32x16_bf16 v[48:63], v[188:191], v[108:111], v[48:63]
    v_mfma_f32_32x32x16_bf16 v[64:79], v[192:195], v[108:111], v[64:79]
    buffer_load_dwordx4 v[104:107], v2, s[4:7], s16 offen offset:1024
    buffer_load_dwordx4 v[108:111], v2, s[4:7], s17 offen offset:1024
    buffer_load_dwordx4 v[8:11], v2, s[4:7], s23 offen
    s_waitcnt vmcnt(9)
    v_mfma_f32_32x32x16_bf16 v[16:31], v[196:199], v[112:115], v[16:31]
    v_mfma_f32_32x32x16_bf16 v[32:47], v[200:203], v[112:115], v[32:47]
    v_mfma_f32_32x32x16_bf16 v[48:63], v[196:199], v[116:119], v[48:63]
    v_mfma_f32_32x32x16_bf16 v[64:79], v[200:203], v[116:119], v[64:79]
    buffer_load_dwordx4 v[112:115], v2, s[4:7], s16 offen offset:2048
    buffer_load_dwordx4 v[116:119], v2, s[4:7], s17 offen offset:2048
    s_add_u32 m0, s32, 0
    s_add_u32 s33, s31, 0
    buffer_load_dwordx4 v2, s[44:47], s33 offen offset:0 lds
    s_add_u32 m0, s32, 0
    s_add_u32 s33, s31, 0
    buffer_load_dwordx4 v2, s[44:47], s33 offen offset:1024 lds
    s_waitcnt vmcnt(11)
    v_mfma_f32_32x32x16_bf16 v[16:31], v[204:207], v[80:83], v[16:31]
    v_mfma_f32_32x32x16_bf16 v[32:47], v[208:211], v[80:83], v[32:47]
    v_mfma_f32_32x32x16_bf16 v[48:63], v[204:207], v[84:87], v[48:63]
    v_mfma_f32_32x32x16_bf16 v[64:79], v[208:211], v[84:87], v[64:79]
    buffer_load_dwordx4 v[80:83], v2, s[4:7], s16 offen offset:3072
    buffer_load_dwordx4 v[84:87], v2, s[4:7], s17 offen offset:3072
    s_add_u32 m0, s32, 0
    s_add_u32 s33, s31, 0
    buffer_load_dwordx4 v2, s[44:47], s33 offen offset:2048 lds
    s_add_u32 m0, s32, 0
    s_add_u32 s33, s31, 0
    buffer_load_dwordx4 v2, s[44:47], s33 offen offset:3072 lds
    s_waitcnt vmcnt(13)
    v_mfma_f32_32x32x16_bf16 v[16:31], v[212:215], v[88:91], v[16:31]
    v_mfma_f32_32x32x16_bf16 v[32:47], v[216:219], v[88:91], v[32:47]
    v_mfma_f32_32x32x16_bf16 v[48:63], v[212:215], v[92:95], v[48:63]
    v_mfma_f32_32x32x16_bf16 v[64:79], v[216:219], v[92:95], v[64:79]
    s_add_u32 m0, s32, 32768
    s_add_u32 s33, s31, 32768
    buffer_load_dwordx4 v2, s[44:47], s33 offen offset:0 lds
    s_add_u32 m0, s32, 32768
    s_add_u32 s33, s31, 32768
    buffer_load_dwordx4 v2, s[44:47], s33 offen offset:1024 lds
    s_waitcnt vmcnt(13)
    v_mfma_f32_32x32x16_bf16 v[16:31], v[220:223], v[96:99], v[16:31]
    v_mfma_f32_32x32x16_bf16 v[32:47], v[224:227], v[96:99], v[32:47]
    v_mfma_f32_32x32x16_bf16 v[48:63], v[220:223], v[100:103], v[48:63]
    v_mfma_f32_32x32x16_bf16 v[64:79], v[224:227], v[100:103], v[64:79]
    s_add_u32 m0, s32, 32768
    s_add_u32 s33, s31, 32768
    buffer_load_dwordx4 v2, s[44:47], s33 offen offset:2048 lds
    s_add_u32 m0, s32, 32768
    s_add_u32 s33, s31, 32768
    buffer_load_dwordx4 v2, s[44:47], s33 offen offset:3072 lds
    s_waitcnt vmcnt(13)
    v_mfma_f32_32x32x16_bf16 v[16:31], v[228:231], v[104:107], v[16:31]
    v_mfma_f32_32x32x16_bf16 v[32:47], v[232:235], v[104:107], v[32:47]
    v_mfma_f32_32x32x16_bf16 v[48:63], v[228:231], v[108:111], v[48:63]
    v_mfma_f32_32x32x16_bf16 v[64:79], v[232:235], v[108:111], v[64:79]
    s_add_u32 m0, s32, 65536
    s_add_u32 s33, s31, 65536
    buffer_load_dwordx4 v2, s[44:47], s33 offen offset:0 lds
    s_add_u32 m0, s32, 65536
    s_add_u32 s33, s31, 65536
    buffer_load_dwordx4 v2, s[44:47], s33 offen offset:1024 lds
    s_waitcnt vmcnt(12)
    v_mfma_f32_32x32x16_bf16 v[16:31], v[236:239], v[112:115], v[16:31]
    v_mfma_f32_32x32x16_bf16 v[32:47], v[240:243], v[112:115], v[32:47]
    v_mfma_f32_32x32x16_bf16 v[48:63], v[236:239], v[116:119], v[48:63]
    v_mfma_f32_32x32x16_bf16 v[64:79], v[240:243], v[116:119], v[64:79]
    s_add_u32 m0, s32, 65536
    s_add_u32 s33, s31, 65536
    buffer_load_dwordx4 v2, s[44:47], s33 offen offset:2048 lds
    s_add_u32 m0, s32, 65536
    s_add_u32 s33, s31, 65536
    buffer_load_dwordx4 v2, s[44:47], s33 offen offset:3072 lds
    s_waitcnt vmcnt(10)
    v_mfma_f32_32x32x16_bf16 v[16:31], v[244:247], v[80:83], v[16:31]
    v_mfma_f32_32x32x16_bf16 v[32:47], v[248:251], v[80:83], v[32:47]
    v_mfma_f32_32x32x16_bf16 v[48:63], v[244:247], v[84:87], v[48:63]
    v_mfma_f32_32x32x16_bf16 v[64:79], v[248:251], v[84:87], v[64:79]
    s_setprio 0
L_w2_join:
    s_nop 7
    s_nop 3
    s_lshl_b32 s26, s8, 13
    s_add_u32 s26, s26, 98304
    v_add_u32 v3, s26, v2
    s_xor_b32 s27, s8, 4
    s_lshl_b32 s27, s27, 13
    s_add_u32 s27, s27, 98304
    v_add_u32 v4, s27, v2
    s_and_b32 s28, s8, 4
    s_cmp_lg_u32 s28, 0
    s_cbranch_scc1 L_x1a_271
    ds_write_b128 v3, v[80:83] offset:0
    ds_write_b128 v3, v[84:87] offset:1024
    ds_write_b128 v3, v[88:91] offset:2048
    ds_write_b128 v3, v[92:95] offset:3072
    ds_write_b128 v3, v[96:99] offset:4096
    ds_write_b128 v3, v[100:103] offset:5120
    ds_write_b128 v3, v[104:107] offset:6144
    ds_write_b128 v3, v[108:111] offset:7168
    s_branch L_x1b_272
L_x1a_271:
    ds_write_b128 v3, v[16:19] offset:0
    ds_write_b128 v3, v[20:23] offset:1024
    ds_write_b128 v3, v[24:27] offset:2048
    ds_write_b128 v3, v[28:31] offset:3072
    ds_write_b128 v3, v[32:35] offset:4096
    ds_write_b128 v3, v[36:39] offset:5120
    ds_write_b128 v3, v[40:43] offset:6144
    ds_write_b128 v3, v[44:47] offset:7168
L_x1b_272:
    s_waitcnt lgkmcnt(0)
    s_barrier
    ds_read_b128 v[16:19], v4 offset:0
    ds_read_b128 v[20:23], v4 offset:1024
    ds_read_b128 v[24:27], v4 offset:2048
    ds_read_b128 v[28:31], v4 offset:3072
    ds_read_b128 v[32:35], v4 offset:4096
    ds_read_b128 v[36:39], v4 offset:5120
    ds_read_b128 v[40:43], v4 offset:6144
    ds_read_b128 v[44:47], v4 offset:7168
    s_waitcnt lgkmcnt(0)
    v_pk_add_f32 v[48:49], v[48:49], v[16:17]
    v_pk_add_f32 v[50:51], v[50:51], v[18:19]
    v_pk_add_f32 v[52:53], v[52:53], v[20:21]
    v_pk_add_f32 v[54:55], v[54:55], v[22:23]
    v_pk_add_f32 v[56:57], v[56:57], v[24:25]
    v_pk_add_f32 v[58:59], v[58:59], v[26:27]
    v_pk_add_f32 v[60:61], v[60:61], v[28:29]
    v_pk_add_f32 v[62:63], v[62:63], v[30:31]
    v_pk_add_f32 v[64:65], v[64:65], v[32:33]
    v_pk_add_f32 v[66:67], v[66:67], v[34:35]
    v_pk_add_f32 v[68:69], v[68:69], v[36:37]
    v_pk_add_f32 v[70:71], v[70:71], v[38:39]
    v_pk_add_f32 v[72:73], v[72:73], v[40:41]
    v_pk_add_f32 v[74:75], v[74:75], v[42:43]
    v_pk_add_f32 v[76:77], v[76:77], v[44:45]
    v_pk_add_f32 v[78:79], v[78:79], v[46:47]
    s_xor_b32 s27, s8, 6
    s_lshl_b32 s27, s27, 13
    s_add_u32 s27, s27, 98304
    v_add_u32 v5, s27, v2
    s_and_b32 s28, s8, 2
    s_cmp_lg_u32 s28, 0
    s_cbranch_scc1 L_x2a_273
    ds_write_b128 v4, v[64:67] offset:0
    ds_write_b128 v4, v[68:71] offset:1024
    ds_write_b128 v4, v[72:75] offset:2048
    ds_write_b128 v4, v[76:79] offset:3072
    v_pk_mov_b32 v[184:185], v[48:49], v[48:49] op_sel:[0,1]
    v_pk_mov_b32 v[186:187], v[50:51], v[50:51] op_sel:[0,1]
    v_pk_mov_b32 v[188:189], v[52:53], v[52:53] op_sel:[0,1]
    v_pk_mov_b32 v[190:191], v[54:55], v[54:55] op_sel:[0,1]
    v_pk_mov_b32 v[192:193], v[56:57], v[56:57] op_sel:[0,1]
    v_pk_mov_b32 v[194:195], v[58:59], v[58:59] op_sel:[0,1]
    v_pk_mov_b32 v[196:197], v[60:61], v[60:61] op_sel:[0,1]
    v_pk_mov_b32 v[198:199], v[62:63], v[62:63] op_sel:[0,1]
    s_branch L_x2b_274
L_x2a_273:
    ds_write_b128 v4, v[48:51] offset:0
    ds_write_b128 v4, v[52:55] offset:1024
    ds_write_b128 v4, v[56:59] offset:2048
    ds_write_b128 v4, v[60:63] offset:3072
    v_pk_mov_b32 v[184:185], v[64:65], v[64:65] op_sel:[0,1]
    v_pk_mov_b32 v[186:187], v[66:67], v[66:67] op_sel:[0,1]
    v_pk_mov_b32 v[188:189], v[68:69], v[68:69] op_sel:[0,1]
    v_pk_mov_b32 v[190:191], v[70:71], v[70:71] op_sel:[0,1]
    v_pk_mov_b32 v[192:193], v[72:73], v[72:73] op_sel:[0,1]
    v_pk_mov_b32 v[194:195], v[74:75], v[74:75] op_sel:[0,1]
    v_pk_mov_b32 v[196:197], v[76:77], v[76:77] op_sel:[0,1]
    v_pk_mov_b32 v[198:199], v[78:79], v[78:79] op_sel:[0,1]
L_x2b_274:
    s_waitcnt lgkmcnt(0)
    s_barrier
    ds_read_b128 v[16:19], v5 offset:0
    ds_read_b128 v[20:23], v5 offset:1024
    ds_read_b128 v[24:27], v5 offset:2048
    ds_read_b128 v[28:31], v5 offset:3072
    s_waitcnt lgkmcnt(0)
    v_pk_add_f32 v[184:185], v[184:185], v[16:17]
    v_pk_add_f32 v[186:187], v[186:187], v[18:19]
    v_pk_add_f32 v[188:189], v[188:189], v[20:21]
    v_pk_add_f32 v[190:191], v[190:191], v[22:23]
    v_pk_add_f32 v[192:193], v[192:193], v[24:25]
    v_pk_add_f32 v[194:195], v[194:195], v[26:27]
    v_pk_add_f32 v[196:197], v[196:197], v[28:29]
    v_pk_add_f32 v[198:199], v[198:199], v[30:31]
    s_xor_b32 s27, s8, 7
    s_lshl_b32 s27, s27, 13
    s_add_u32 s27, s27, 98304
    v_add_u32 v4, s27, v2
    s_and_b32 s28, s8, 1
    s_cmp_lg_u32 s28, 0
    s_cbranch_scc1 L_x3a_275
    ds_write_b128 v5, v[192:195] offset:0
    ds_write_b128 v5, v[196:199] offset:1024
    v_pk_mov_b32 v[200:201], v[184:185], v[184:185] op_sel:[0,1]
    v_pk_mov_b32 v[202:203], v[186:187], v[186:187] op_sel:[0,1]
    v_pk_mov_b32 v[204:205], v[188:189], v[188:189] op_sel:[0,1]
    v_pk_mov_b32 v[206:207], v[190:191], v[190:191] op_sel:[0,1]
    s_branch L_x3b_276
L_x3a_275:
    ds_write_b128 v5, v[184:187] offset:0
    ds_write_b128 v5, v[188:191] offset:1024
    v_pk_mov_b32 v[200:201], v[192:193], v[192:193] op_sel:[0,1]
    v_pk_mov_b32 v[202:203], v[194:195], v[194:195] op_sel:[0,1]
    v_pk_mov_b32 v[204:205], v[196:197], v[196:197] op_sel:[0,1]
    v_pk_mov_b32 v[206:207], v[198:199], v[198:199] op_sel:[0,1]
L_x3b_276:
    s_waitcnt lgkmcnt(0)
    s_barrier
    ds_read_b128 v[16:19], v4 offset:0
    ds_read_b128 v[20:23], v4 offset:1024
    v_lshlrev_b32 v24, 16, v8
    v_and_b32 v25, 0xffff0000, v8
    v_lshlrev_b32 v26, 16, v9
    v_and_b32 v27, 0xffff0000, v9
    v_lshlrev_b32 v28, 16, v10
    v_and_b32 v29, 0xffff0000, v10
    v_lshlrev_b32 v30, 16, v11
    v_and_b32 v31, 0xffff0000, v11
    v_pk_add_f32 v[200:201], v[200:201], v[24:25]
    v_pk_add_f32 v[202:203], v[202:203], v[26:27]
    v_pk_add_f32 v[204:205], v[204:205], v[28:29]
    v_pk_add_f32 v[206:207], v[206:207], v[30:31]
    s_waitcnt lgkmcnt(0)
    v_pk_add_f32 v[200:201], v[200:201], v[16:17]
    v_pk_add_f32 v[202:203], v[202:203], v[18:19]
    v_pk_add_f32 v[204:205], v[204:205], v[20:21]
    v_pk_add_f32 v[206:207], v[206:207], v[22:23]
    v_cvt_pk_bf16_f32 v32, v200, v201
    v_cvt_pk_bf16_f32 v33, v202, v203
    v_cvt_pk_bf16_f32 v34, v204, v205
    v_cvt_pk_bf16_f32 v35, v206, v207
    s_cmp_lg_u32 s10, 0
    s_cbranch_scc1 L_w2_fin_277
    s_add_u32 s23, s22, 4194304
    buffer_store_dwordx4 v[32:35], v2, s[4:7], s23 offen sc1
    v_mov_b32 v40, 0x3f803f80
    v_mov_b32 v36, 0
    v_mov_b32 v37, 0
    s_nop 0
    v_dot2_f32_bf16 v36, v32, v40, v36
    v_dot2_f32_bf16 v37, v32, v32, v37
    v_dot2_f32_bf16 v36, v33, v40, v36
    v_dot2_f32_bf16 v37, v33, v33, v37
    v_dot2_f32_bf16 v36, v34, v40, v36
    v_dot2_f32_bf16 v37, v34, v34, v37
    v_dot2_f32_bf16 v36, v35, v40, v36
    v_dot2_f32_bf16 v37, v35, v35, v37
    s_nop 2
    v_mov_b32 v38, v36
    v_mov_b32 v39, v37
    s_nop 1
    v_permlane32_swap_b32 v36, v38
    v_permlane32_swap_b32 v37, v39
    s_nop 1
    v_add_f32 v36, v36, v38
    v_add_f32 v37, v37, v39
    s_lshl_b32 s26, s21, 14
    s_lshl_b32 s27, s20, 8
    s_add_u32 s26, s26, s27
    s_add_u32 s26, s26, 49283072
    v_lshlrev_b32 v41, 3, v1
    s_mov_b32 exec_lo, 0xffffffff
    s_mov_b32 exec_hi, 0x0
    buffer_store_dwordx2 v[36:37], v41, s[4:7], s26 offen sc1
    s_mov_b64 exec, -1
    s_mul_i32 s35, s10, 5
    s_add_u32 s35, s35, 5
    s_add_u32 s34, s9, s35
    s_lshl_b32 s35, s35, 8
    s_add_u32 s35, s35, s36
    s_lshl_b32 s35, s35, 7
    s_add_u32 s35, s35, 51380224
    s_waitcnt vmcnt(0)
    s_barrier
    s_cmp_lg_u32 s8, 7
    s_cbranch_scc1 L_sig_279
    v_mov_b32 v4, s34
    v_mov_b32 v5, 0
    s_mov_b64 exec, 1
    s_cmp_eq_u32 s3, 0
    s_cbranch_scc1 L_sg_280
    buffer_store_dword v4, v5, s[4:7], s35 offen
    s_branch L_sg_281
L_sg_280:
    buffer_store_dword v4, v5, s[4:7], s35 offen sc1
L_sg_281:
    s_mov_b64 exec, -1
L_sig_279:
    s_branch L_w2_end_278
L_w2_fin_277:
    s_load_dwordx2 s[24:25], s[0:1], 48
    s_waitcnt lgkmcnt(0)
    s_and_b32 s25, s25, 0xffff
    s_mov_b32 s26, 2097152
    s_mov_b32 s27, 0x00020000
    v_permlane32_swap_b32 v32, v34
    v_permlane32_swap_b32 v33, v35
    v_and_b32 v36, 31, v1
    v_lshlrev_b32 v36, 10, v36
    v_lshrrev_b32 v37, 5, v1
    v_lshl_add_u32 v36, v37, 4, v36
    s_lshl_b32 s28, s20, 15
    s_lshl_b32 s29, s21, 5
    s_add_u32 s28, s28, s29
    buffer_store_dwordx4 v[32:35], v36, s[24:27], s28 offen sc1
L_w2_end_278:
    s_add_u32 s10, s10, 1
    s_cmp_lt_u32 s10, 2
    s_cbranch_scc1 L_layer
L_end:
    s_endpgm
.section .rodata,"a"
.p2align 6
.amdhsa_kernel interleave_layers__mha_block__dense_activation_relu__prompt_kernel
  .amdhsa_next_free_vgpr 256
  .amdhsa_next_free_sgpr 96
  .amdhsa_accum_offset 256
  .amdhsa_group_segment_fixed_size 0
  .amdhsa_kernarg_size 72
  .amdhsa_user_sgpr_count 2
  .amdhsa_user_sgpr_kernarg_segment_ptr 1
  .amdhsa_system_sgpr_workgroup_id_x 1
  .amdhsa_float_denorm_mode_32 3
.end_amdhsa_kernel
```
